```python
import torch

def _softmax(x, axis=-1):
    return torch.softmax(x, dim=axis)
def _gelu(x):
    return torch.nn.functional.gelu(x, approximate="tanh")
def _silu(x):
    return torch.nn.functional.silu(x)
def _sigmoid(x):
    return torch.sigmoid(x)
def _layernorm(x, axis=-1, eps=1e-5):
    m = x.mean(dim=axis, keepdim=True)
    v = x.var(dim=axis, keepdim=True, unbiased=False)
    return (x - m) / torch.sqrt(v + eps)
def _scatter_add(tgt, idx, src, axis=0):
    return tgt.clone().index_add_(axis, idx, src)
def _segment_sum(src, seg, n):
    out = torch.zeros((n,) + src.shape[1:], dtype=src.dtype)
    return out.index_add_(0, seg, src)
def _pad(x, pw):
    flat = tuple(v for pair in reversed(pw) for v in pair)
    return torch.nn.functional.pad(x, flat)

kernel_name = 'interleave_layers__mha_block__glu_gated_reglu__prompt'

def setup_inputs():

    _w = (lambda a: (lambda t: t.to(torch.bfloat16) if t.is_floating_point() else t)(torch.as_tensor(a)))
    def _A_setup():
        B, S, D, H = 1, 2048, 640, 32
        return {
            "x": _w((lambda *s: torch.randn(*s, dtype=torch.bfloat16) * 0.05)(B, S, D)),
            "wqkv": _w((lambda *s: torch.randn(*s, dtype=torch.bfloat16) * 0.05)(D, 3 * D)),
            "wo": _w((lambda *s: torch.randn(*s, dtype=torch.bfloat16) * 0.05)(D, D)),
        }
    _A_in = _A_setup()

    def _B_setup():
        B, S, D, F = 1, 2048, 640, 1728
        return {
            "x": _w((lambda *s: torch.randn(*s, dtype=torch.bfloat16) * 0.05)(B, S, D)),
            "W_gate": _w((lambda *s: torch.randn(*s, dtype=torch.bfloat16) * 0.8)(D, F) * (2.0 / D) ** 0.5),
            "W_up": _w((lambda *s: torch.randn(*s, dtype=torch.bfloat16) * 0.8)(D, F) * (2.0 / D) ** 0.5),
            "W_down": _w((lambda *s: torch.randn(*s, dtype=torch.bfloat16) * 0.8)(F, D) * (1.0 / F) ** 0.5),
        }
    _B_in = _B_setup()

    return {
        "A_x": _A_in["x"],
        "A_wqkv": _A_in["wqkv"],
        "A_wo": _A_in["wo"],
        "B_x": _B_in["x"],
        "B_W_gate": _B_in["W_gate"],
        "B_W_up": _B_in["W_up"],
        "B_W_down": _B_in["W_down"],
    }

def reference(A_x, A_wqkv, A_wo, B_x, B_W_gate, B_W_up, B_W_down):
    def _A_ref(x, wqkv, wo):
        B, S, D = x.shape
        H = 32
        Dh = D // H
        qkv = (lambda x, *d: x.permute(*d))((x @ wqkv).reshape(B, S, 3, H, Dh), 2, 0, 3, 1, 4)
        q, k, v = qkv[0], qkv[1], qkv[2]
        scores = torch.einsum("bhqd,bhkd->bhqk", q, k) * (Dh ** -0.5)
        p = _softmax(scores, axis=-1)
        o = torch.einsum("bhqk,bhkd->bhqd", p, v)
        return (lambda x, *d: x.permute(*d))(o, 0, 2, 1, 3).reshape(B, S, D) @ wo

    def _B_ref(x, W_gate, W_up, W_down):
        gate = torch.einsum("bsd,df->bsf", x, W_gate)
        up = torch.einsum("bsd,df->bsf", x, W_up)
        gate = gate * (lambda x, dt: x.to(dt))(gate > 0, gate.dtype)
        h = gate * up
        return torch.einsum("bsf,fd->bsd", h, W_down)

    x = A_x
    x = x + _A_ref(_layernorm(x, axis=-1), A_wqkv, A_wo)
    x = x + _B_ref(_layernorm(x, axis=-1), B_W_gate, B_W_up, B_W_down)
    x = x + _A_ref(_layernorm(x, axis=-1), A_wqkv, A_wo)
    x = x + _B_ref(_layernorm(x, axis=-1), B_W_gate, B_W_up, B_W_down)
    return x
```

```asm
; @launch kernel=mega_kernel grid=(256,1,1) block=(512,1,1) lds=163840
.amdgcn_target "amdgcn-amd-amdhsa--gfx950"
.text
.globl mega_kernel
.p2align 8
.type mega_kernel,@function
mega_kernel:
    s_cmp_ge_u32 s2, 256
    s_cbranch_scc1 L_mega_kernel_end_1
    s_load_dwordx2 s[48:49], s[0:1], 72
    s_load_dwordx2 s[46:47], s[0:1], 56
    s_load_dwordx4 s[24:27], s[0:1], 0
    s_load_dwordx2 s[28:29], s[0:1], 64
    s_memrealtime s[20:21]
    v_lshrrev_b32 v2, 6, v0
    v_and_b32 v1, 63, v0
    v_lshlrev_b32 v3, 4, v1
    v_readfirstlane_b32 s22, v2
    v_add_u32 v4, 0x10000, v3
    v_add_u32 v5, 0x20000, v3
    v_and_b32 v7, 15, v1
    v_lshrrev_b32 v8, 4, v1
    v_lshlrev_b32 v6, 9, v8
    v_lshl_add_u32 v6, v7, 4, v6
    s_and_b32 s23, s22, 3
    s_and_b32 s50, s2, 7
    s_lshr_b32 s51, s2, 3
    s_and_b32 s17, s51, 7
    s_lshr_b32 s51, s51, 3
    s_lshr_b32 s12, s50, 2
    s_lshl_b32 s12, s12, 3
    s_add_u32 s12, s12, s17
    s_and_b32 s13, s50, 3
    s_lshl_b32 s13, s13, 2
    s_add_u32 s13, s13, s51
    s_lshr_b32 s14, s50, 1
    s_lshl_b32 s14, s14, 3
    s_add_u32 s14, s14, s17
    s_and_b32 s15, s50, 1
    s_lshl_b32 s15, s15, 2
    s_add_u32 s15, s15, s51
    s_lshl_b32 s16, s50, 2
    s_add_u32 s16, s16, s51
    s_mov_b32 s18, 0
    s_mov_b32 s19, 0
    s_lshl_b32 s31, s23, 10
    s_mov_b32 s45, 7
    s_cmp_lt_u32 s22, 4
    s_cselect_b32 s44, 0x10001, 1
    s_mov_b32 s32, -1
    s_mov_b32 s33, 0
    s_mov_b32 s34, 0
    s_mov_b32 s35, -1
    s_mov_b32 s36, 0xffff
    s_mov_b32 s37, 0xffff
    s_mov_b32 s38, 0
    s_mov_b32 s39, 0xffff
    s_mov_b32 s40, 0
    s_mov_b32 s41, 0xffff0000
    s_waitcnt lgkmcnt(0)
    s_mov_b32 s4, s48
    s_and_b32 s5, s49, 0xffff
    s_mov_b32 s6, 59047936
    s_mov_b32 s7, 0x00020000
    s_mov_b32 s8, s46
    s_and_b32 s9, s47, 0xffff
    s_mov_b32 s10, 2621440
    s_mov_b32 s11, 0x00020000
    s_mov_b32 s56, s4
    s_mov_b32 s57, s5
    s_mov_b32 s58, 0
    s_mov_b32 s59, 0x00020000
    s_mov_b32 s60, 0
    s_mov_b32 s61, 0
    v_mov_b32 v16, 0
    v_mov_b32 v19, 0
    v_mov_b32 v22, 0
    s_mov_b32 s3, 0
    s_or_b32 s50, s2, s22
    s_cmp_lg_u32 s50, 0
    s_cbranch_scc1 L_mega_kernel_nn_3
    s_mov_b32 s52, s28
    s_and_b32 s53, s29, 0xffff
    s_mov_b32 s54, 256
    s_mov_b32 s55, 0x00020000
    s_or_b32 s50, s20, 1
    v_mov_b32 v26, s50
    s_mov_b64 exec, 1
    buffer_store_dword v26, off, s[52:55], 0 sc1
    s_mov_b64 exec, -1
L_mega_kernel_nn_3:
    s_cmp_lt_u32 s22, 4
    s_cbranch_scc1 L_mega_kernel_L0_6
    s_mov_b32 s56, s26
    s_and_b32 s57, s27, 0xffff
    s_mov_b32 s96, s28
    s_and_b32 s97, s29, 0xffff
    s_mov_b32 s58, 2457600
    s_mov_b32 s98, 256
    s_mov_b32 s99, 0x00020000
    s_lshl_b32 s25, s23, 4
    s_add_u32 s25, s25, s12
    s_mov_b32 s24, s13
    s_lshl_b32 s26, s23, 13
    s_cmp_ge_u32 s25, 20
    s_cbranch_scc1 L_mega_kernel_nt_7
    v_mul_u32_u24 v43, 4370, v1
    v_lshrrev_b32 v43, 16, v43
    v_mul_u32_u24 v44, 15, v43
    v_sub_u32 v44, v1, v44
    v_mul_u32_u24 v45, 13108, v44
    v_lshrrev_b32 v45, 16, v45
    v_mul_u32_u24 v45, 1200, v45
    v_lshl_add_u32 v44, v44, 4, v45
    s_mul_i32 s50, s24, 80
    v_cmp_gt_u32 s[52:53], 4, v43
    s_lshl_b32 s51, s25, 5
    v_mul_u32_u24 v50, 3840, v43
    v_add_u32 v50, v50, v44
    s_mul_i32 s51, s51, 3840
    s_add_u32 s50, s50, s51
    s_mov_b64 exec, s[52:53]
    s_add_u32 m0, s26, 0
    s_nop 0
    buffer_load_dwordx4 v50, s[56:59], s50 offen lds
    s_add_u32 s50, s50, 15360
    s_add_u32 m0, s26, 960
    s_nop 0
    buffer_load_dwordx4 v50, s[56:59], s50 offen lds
    s_add_u32 s50, s50, 15360
    s_add_u32 m0, s26, 1920
    s_nop 0
    buffer_load_dwordx4 v50, s[56:59], s50 offen lds
    s_add_u32 s50, s50, 15360
    s_add_u32 m0, s26, 2880
    s_nop 0
    buffer_load_dwordx4 v50, s[56:59], s50 offen lds
    s_add_u32 s50, s50, 15360
    s_add_u32 m0, s26, 3840
    s_nop 0
    buffer_load_dwordx4 v50, s[56:59], s50 offen lds
    s_add_u32 s50, s50, 15360
    s_add_u32 m0, s26, 4800
    s_nop 0
    buffer_load_dwordx4 v50, s[56:59], s50 offen lds
    s_add_u32 s50, s50, 15360
    s_add_u32 m0, s26, 5760
    s_nop 0
    buffer_load_dwordx4 v50, s[56:59], s50 offen lds
    s_add_u32 s50, s50, 15360
    s_add_u32 m0, s26, 6720
    s_nop 0
    buffer_load_dwordx4 v50, s[56:59], s50 offen lds
    s_add_u32 s50, s50, 15360
    s_mov_b64 exec, -1
    v_bfe_u32 v40, v1, 2, 2
    v_and_b32 v41, 3, v1
    v_lshrrev_b32 v42, 4, v1
    v_lshl_add_u32 v42, v42, 3, v40
    v_mul_u32_u24 v48, 240, v42
    v_add_u32 v48, s26, v48
    v_and_b32 v50, 1, v41
    v_lshlrev_b32 v50, 4, v50
    v_lshrrev_b32 v51, 1, v41
    v_mul_u32_u24 v51, 80, v51
    v_add3_u32 v50, v50, v51, v48
    v_lshlrev_b32 v51, 4, v41
    v_add_u32 v51, 160, v51
    v_add_u32 v52, 8, v51
    v_cmp_eq_u32 vcc, 3, v41
    v_mov_b32 v45, 112
    s_nop 0
    v_cndmask_b32 v51, v51, 32, vcc
    v_cndmask_b32 v52, v52, v45, vcc
    v_cmp_eq_u32 vcc, 2, v41
    v_mov_b32 v45, 192
    s_nop 0
    v_cndmask_b32 v52, v52, v45, vcc
    v_add_u32 v51, v51, v48
    v_add_u32 v52, v52, v48
    s_mul_i32 s27, s24, 20
    s_add_u32 s27, s27, s25
    s_mul_i32 s27, s27, 8
    s_lshl_b32 s27, s27, 10
    s_add_u32 s27, s27, 56360960
    s_add_u32 s28, s27, 4096
    s_add_u32 s29, s27, 8192
    s_waitcnt vmcnt(0)
    s_buffer_load_dword s3, s[96:99], 0
    ds_read_b64_tr_b16 v[64:65], v50 offset:0
    ds_read_b64_tr_b16 v[66:67], v50 offset:960
    ds_read_b64_tr_b16 v[68:69], v50 offset:8
    ds_read_b64_tr_b16 v[70:71], v50 offset:968
    ds_read_b64_tr_b16 v[72:73], v51 offset:0
    ds_read_b64_tr_b16 v[74:75], v51 offset:960
    ds_read_b64_tr_b16 v[76:77], v52 offset:0
    ds_read_b64_tr_b16 v[78:79], v52 offset:960
    ds_read_b64_tr_b16 v[80:81], v50 offset:40
    ds_read_b64_tr_b16 v[82:83], v50 offset:1000
    ds_read_b64_tr_b16 v[84:85], v50 offset:48
    ds_read_b64_tr_b16 v[86:87], v50 offset:1008
    s_waitcnt lgkmcnt(2)
    ds_read_b64_tr_b16 v[88:89], v51 offset:40
    ds_read_b64_tr_b16 v[90:91], v51 offset:1000
    ds_read_b64_tr_b16 v[92:93], v52 offset:40
    ds_read_b64_tr_b16 v[94:95], v52 offset:1000
    s_waitcnt lgkmcnt(0)
    s_cmp_ge_u32 s25, 10
    s_cbranch_scc1 L_mega_kernel_tl_9
    buffer_store_dwordx4 v[64:67], v3, s[4:7], s27 offen offset:0 sc1
    buffer_store_dwordx4 v[68:71], v3, s[4:7], s27 offen offset:1024 sc1
    buffer_store_dwordx4 v[72:75], v3, s[4:7], s27 offen offset:2048 sc1
    buffer_store_dwordx4 v[76:79], v3, s[4:7], s27 offen offset:3072 sc1
    buffer_store_dwordx4 v[80:83], v3, s[4:7], s28 offen offset:0 sc1
    buffer_store_dwordx4 v[84:87], v3, s[4:7], s28 offen offset:1024 sc1
    buffer_store_dwordx4 v[88:91], v3, s[4:7], s28 offen offset:2048 sc1
    buffer_store_dwordx4 v[92:95], v3, s[4:7], s28 offen offset:3072 sc1
    s_branch L_mega_kernel_td_10
L_mega_kernel_tl_9:
    s_mul_i32 s27, s24, 163840
    s_lshl_b32 s28, s25, 11
    s_add_u32 s27, s27, s28
    s_add_u32 s28, s27, 56422400
    buffer_store_dwordx4 v[64:67], v3, s[4:7], s28 offen offset:0 sc1
    buffer_store_dwordx4 v[68:71], v3, s[4:7], s28 offen offset:1024 sc1
    s_add_u32 s28, s27, 56463360
    buffer_store_dwordx4 v[72:75], v3, s[4:7], s28 offen offset:0 sc1
    buffer_store_dwordx4 v[76:79], v3, s[4:7], s28 offen offset:1024 sc1
    s_add_u32 s28, s27, 56442880
    buffer_store_dwordx4 v[80:83], v3, s[4:7], s28 offen offset:0 sc1
    buffer_store_dwordx4 v[84:87], v3, s[4:7], s28 offen offset:1024 sc1
    s_add_u32 s28, s27, 56483840
    buffer_store_dwordx4 v[88:91], v3, s[4:7], s28 offen offset:0 sc1
    buffer_store_dwordx4 v[92:95], v3, s[4:7], s28 offen offset:1024 sc1
L_mega_kernel_td_10:
    s_mov_b32 s50, 0x3f803f80
    v_mov_b32 v40, 0
    v_mov_b32 v41, 0
    v_mov_b32 v42, 0
    v_mov_b32 v43, 0
    v_mov_b32 v44, 0
    v_mov_b32 v45, 0
    v_mov_b32 v46, 0
    v_mov_b32 v47, 0
    v_dot2c_f32_bf16 v40, s50, v64
    v_dot2c_f32_bf16 v41, s50, v68
    v_dot2c_f32_bf16 v42, s50, v72
    v_dot2c_f32_bf16 v43, s50, v76
    v_dot2c_f32_bf16 v44, s50, v80
    v_dot2c_f32_bf16 v45, s50, v84
    v_dot2c_f32_bf16 v46, s50, v88
    v_dot2c_f32_bf16 v47, s50, v92
    v_dot2c_f32_bf16 v40, s50, v65
    v_dot2c_f32_bf16 v41, s50, v69
    v_dot2c_f32_bf16 v42, s50, v73
    v_dot2c_f32_bf16 v43, s50, v77
    v_dot2c_f32_bf16 v44, s50, v81
    v_dot2c_f32_bf16 v45, s50, v85
    v_dot2c_f32_bf16 v46, s50, v89
    v_dot2c_f32_bf16 v47, s50, v93
    v_dot2c_f32_bf16 v40, s50, v66
    v_dot2c_f32_bf16 v41, s50, v70
    v_dot2c_f32_bf16 v42, s50, v74
    v_dot2c_f32_bf16 v43, s50, v78
    v_dot2c_f32_bf16 v44, s50, v82
    v_dot2c_f32_bf16 v45, s50, v86
    v_dot2c_f32_bf16 v46, s50, v90
    v_dot2c_f32_bf16 v47, s50, v94
    v_dot2c_f32_bf16 v40, s50, v67
    v_dot2c_f32_bf16 v41, s50, v71
    v_dot2c_f32_bf16 v42, s50, v75
    v_dot2c_f32_bf16 v43, s50, v79
    v_dot2c_f32_bf16 v44, s50, v83
    v_dot2c_f32_bf16 v45, s50, v87
    v_dot2c_f32_bf16 v46, s50, v91
    v_dot2c_f32_bf16 v47, s50, v95
    s_lshl_b32 s27, s25, 4
    s_add_u32 s27, s27, s24
    s_mul_i32 s27, s27, 512
    s_add_u32 s27, s27, 55869440
    v_permlane32_swap_b32 v40, v42
    v_permlane32_swap_b32 v41, v43
    s_nop 0
    v_add_f32 v40, v40, v42
    v_add_f32 v41, v41, v43
    s_nop 1
    v_permlane16_swap_b32 v40, v41
    s_nop 0
    v_add_f32 v40, v40, v41
    v_permlane32_swap_b32 v44, v46
    v_permlane32_swap_b32 v45, v47
    s_nop 0
    v_add_f32 v44, v44, v46
    v_add_f32 v45, v45, v47
    s_nop 1
    v_permlane16_swap_b32 v44, v45
    s_nop 0
    v_add_f32 v44, v44, v45
    v_lshlrev_b32 v50, 2, v1
    buffer_store_dword v40, v50, s[4:7], s27 offen sc1
    buffer_store_dword v44, v50, s[4:7], s27 offen offset:256 sc1
    s_mov_b64 exec, -1
    s_cmp_lg_u32 s3, 0
    s_cbranch_scc1 L_mega_kernel_gn_11
    s_mov_b32 s52, 0x100000
L_mega_kernel_sp_13:
    s_sub_u32 s52, s52, 1
    buffer_load_dword v26, off, s[96:99], 0 sc1
    s_cmp_eq_u32 s52, 0
    s_cbranch_scc1 L_mega_kernel_po_15
    s_waitcnt vmcnt(0)
    v_readfirstlane_b32 s51, v26
    s_cmp_eq_u32 s51, 0
    s_cbranch_scc1 L_mega_kernel_sp_13
L_mega_kernel_po_15:
    s_mov_b32 s3, s51
L_mega_kernel_gn_11:
    s_cmp_lg_u32 s22, 4
    s_cbranch_scc1 L_mega_kernel_ib_12
    v_lshrrev_b32 v26, 3, v1
    v_cmp_lt_u32 vcc, 3, v26
    v_mov_b32 v27, 23953408
    v_lshlrev_b32 v26, 15, v26
    v_cndmask_b32 v27, 0, v27, vcc
    v_and_b32 v28, 0x70, v3
    v_add3_u32 v26, v26, v27, v28
    v_mov_b32 v30, s3
    v_mov_b32 v31, s3
    v_mov_b32 v32, s3
    v_mov_b32 v33, s3
    s_lshl_b32 s50, s13, 4
    s_add_u32 s50, s50, s12
    s_lshl_b32 s50, s50, 7
    s_add_u32 s50, s50, 23887872
    s_add_u32 s51, s50, 24215552
    buffer_store_dwordx4 v[30:33], v26, s[4:7], s50 offen sc1
    s_mov_b64 exec, 0xff
    buffer_store_dwordx4 v[30:33], v3, s[4:7], s51 offen sc1
    s_mov_b64 exec, -1
    v_mov_b32 v26, 148896
    ds_write_b32 v26, v30
L_mega_kernel_ib_12:
    s_lshl_b32 s50, s13, 7
    s_lshl_b32 s51, s25, 2
    s_add_u32 s50, s50, s51
    s_add_u32 s50, s50, 23855104
    v_lshlrev_b32 v26, 11, v1
    v_mov_b32 v27, s3
    s_waitcnt vmcnt(0)
    s_mov_b64 exec, 0xffff
    buffer_store_dword v27, v26, s[4:7], s50 offen sc1
    s_mov_b64 exec, -1
    s_setprio 0
    s_cmp_lg_u32 s22, 4
    s_cbranch_scc1 L_mega_kernel_w_8
    s_lshl_b32 s53, s12, 4
    s_add_u32 s53, s53, s13
    s_lshl_b32 s50, s53, 7
    s_add_u32 s50, s50, 23855104
    v_lshlrev_b32 v28, 2, v1
    s_mov_b32 s52, 0x100000
    s_mov_b64 exec, 0xfffff
    s_mov_b32 s53, 64
    s_add_u32 s51, s50, 32
    s_add_u32 s54, s50, 64
L_mega_kernel_fs_18:
    s_buffer_load_dwordx8 s[72:79], s[4:7], s50 glc
    s_buffer_load_dwordx8 s[88:95], s[4:7], s51 glc
    s_buffer_load_dwordx4 s[80:83], s[4:7], s54 glc
    s_sub_u32 s53, s53, 1
    s_waitcnt lgkmcnt(0)
    s_cbranch_scc1 L_mega_kernel_fp_16
    s_cmp_lg_u32 s72, s3
    s_cbranch_scc1 L_mega_kernel_fs_18
    s_cmp_lg_u32 s73, s3
    s_cbranch_scc1 L_mega_kernel_fs_18
    s_cmp_lg_u32 s74, s3
    s_cbranch_scc1 L_mega_kernel_fs_18
    s_cmp_lg_u32 s75, s3
    s_cbranch_scc1 L_mega_kernel_fs_18
    s_cmp_lg_u32 s76, s3
    s_cbranch_scc1 L_mega_kernel_fs_18
    s_cmp_lg_u32 s77, s3
    s_cbranch_scc1 L_mega_kernel_fs_18
    s_cmp_lg_u32 s78, s3
    s_cbranch_scc1 L_mega_kernel_fs_18
    s_cmp_lg_u32 s79, s3
    s_cbranch_scc1 L_mega_kernel_fs_18
    s_cmp_lg_u32 s80, s3
    s_cbranch_scc1 L_mega_kernel_fs_18
    s_cmp_lg_u32 s81, s3
    s_cbranch_scc1 L_mega_kernel_fs_18
    s_cmp_lg_u32 s82, s3
    s_cbranch_scc1 L_mega_kernel_fs_18
    s_cmp_lg_u32 s83, s3
    s_cbranch_scc1 L_mega_kernel_fs_18
    s_cmp_lg_u32 s88, s3
    s_cbranch_scc1 L_mega_kernel_fs_18
    s_cmp_lg_u32 s89, s3
    s_cbranch_scc1 L_mega_kernel_fs_18
    s_cmp_lg_u32 s90, s3
    s_cbranch_scc1 L_mega_kernel_fs_18
    s_cmp_lg_u32 s91, s3
    s_cbranch_scc1 L_mega_kernel_fs_18
    s_cmp_lg_u32 s92, s3
    s_cbranch_scc1 L_mega_kernel_fs_18
    s_cmp_lg_u32 s93, s3
    s_cbranch_scc1 L_mega_kernel_fs_18
    s_cmp_lg_u32 s94, s3
    s_cbranch_scc1 L_mega_kernel_fs_18
    s_cmp_lg_u32 s95, s3
    s_cbranch_scc1 L_mega_kernel_fs_18
    s_branch L_mega_kernel_fo_17
L_mega_kernel_fp_16:
    buffer_load_dword v26, v28, s[4:7], s50 offen sc1
    s_sub_u32 s52, s52, 1
    s_cbranch_scc1 L_mega_kernel_fo_17
    s_waitcnt vmcnt(0)
    v_cmp_ne_u32 vcc, s3, v26
    s_cbranch_vccnz L_mega_kernel_fp_16
L_mega_kernel_fo_17:
    s_mov_b64 exec, -1
    s_waitcnt lgkmcnt(0)
    s_branch L_mega_kernel_w_8
L_mega_kernel_nt_7:
    s_cmp_lg_u32 s22, 6
    s_cbranch_scc1 L_mega_kernel_w7_19
    s_lshr_b32 s50, s2, 3
    s_getpc_b64 s[56:57]
L_mega_kernel_pc_21:
    s_add_u32 s56, s56, mega_kernel-L_mega_kernel_pc_21
    s_addc_u32 s57, s57, -1
    s_and_b32 s57, s57, 0xffff
    s_mov_b32 s58, mega_end-mega_kernel
    s_mov_b32 s59, 0x00020000
    s_mul_i32 s62, s50, 3072
    buffer_load_dwordx4 v[64:67], v3, s[56:59], s62 offen offset:0
    buffer_load_dwordx4 v[68:71], v3, s[56:59], s62 offen offset:1024
    buffer_load_dwordx4 v[72:75], v3, s[56:59], s62 offen offset:2048
    v_mov_b32 v60, 0
    s_lshl_b32 s50, s13, 7
    s_lshl_b32 s51, s12, 2
    s_add_u32 s50, s50, s51
    s_lshl_b32 s51, s50, 10
    s_add_u32 s51, s51, 2752512
    v_writelane_b32 v60, s51, 0
    s_add_u32 s51, s51, 65536
    v_writelane_b32 v60, s51, 1
    s_mul_i32 s51, s50, 3072
    s_add_u32 s51, s51, 4849664
    v_writelane_b32 v60, s51, 2
    s_add_u32 s51, s51, 196608
    v_writelane_b32 v60, s51, 3
    s_mul_i32 s51, s17, 327680
    s_lshl_b32 s52, s16, 10
    s_add_u32 s51, s51, s52
    s_add_u32 s51, s51, 11141120
    v_writelane_b32 v60, s51, 4
    s_mul_i32 s51, s12, 458752
    s_lshl_b32 s52, s13, 12
    s_add_u32 s51, s51, s52
    s_cmp_lt_u32 s13, 3
    s_cselect_b32 s52, 0, 46080
    s_add_u32 s51, s51, s52
    s_add_u32 s51, s51, 16515072
    v_writelane_b32 v60, s51, 5
    s_mul_i32 s51, s14, 81920
    s_mul_i32 s52, s15, 5120
    s_add_u32 s51, s51, s52
    s_add_u32 s52, s51, 13762560
    v_writelane_b32 v60, s52, 6
    s_add_u32 s52, s51, 0
    v_writelane_b32 v60, s52, 8
    s_lshl_b32 s51, s15, 14
    s_lshl_b32 s52, s14, 9
    s_add_u32 s51, s51, s52
    s_add_u32 s52, s51, 16384000
    v_writelane_b32 v60, s52, 7
    s_add_u32 s52, s51, 2621440
    v_writelane_b32 v60, s52, 9
    s_mov_b64 exec, 0xff
    buffer_store_dword v60, v60, s[4:7], 0 offen sc1
    s_mov_b32 s51, 24117248
    s_mov_b64 exec, 0x3ff
    buffer_store_dword v60, v60, s[4:7], s51 offen sc1
    v_add_u32 v10, 147456, v3
    v_mov_b32 v56, 0
    v_mov_b32 v57, 0
    v_mov_b32 v58, 0
    v_mov_b32 v59, 0
    s_mov_b64 exec, 3
    ds_write_b128 v10, v[56:59] offset:1408
    s_mov_b64 exec, -1
L_mega_kernel_w7_19:
L_mega_kernel_w_8:
    s_setprio 0
    s_mul_i32 s30, s13, 163840
    s_add_u32 s30, s30, 56360960
    s_add_u32 s30, s30, s31
    s_mul_i32 s50, s23, 5
    s_lshl_b32 s50, s50, 4
    s_add_u32 s50, s50, s13
    s_lshl_b32 s21, s50, 9
    s_add_u32 s21, s21, 55869440
    v_lshlrev_b32 v11, 3, v1
    s_barrier
    s_add_u32 m0, s31, 0
    s_nop 0
    buffer_load_dwordx4 v3, s[4:7], s30 offen sc1 lds
    s_add_u32 s30, s30, 4096
    s_add_u32 m0, s31, 4096
    s_nop 0
    buffer_load_dwordx4 v3, s[4:7], s30 offen sc1 lds
    s_add_u32 s30, s30, 4096
    s_add_u32 m0, s31, 8192
    s_nop 0
    buffer_load_dwordx4 v3, s[4:7], s30 offen sc1 lds
    s_add_u32 s30, s30, 4096
    s_add_u32 m0, s31, 12288
    s_nop 0
    buffer_load_dwordx4 v3, s[4:7], s30 offen sc1 lds
    s_add_u32 s30, s30, 4096
    s_add_u32 m0, s31, 16384
    s_nop 0
    buffer_load_dwordx4 v3, s[4:7], s30 offen sc1 lds
    s_add_u32 s30, s30, 4096
    s_add_u32 m0, s31, 20480
    s_nop 0
    buffer_load_dwordx4 v3, s[4:7], s30 offen sc1 lds
    s_add_u32 s30, s30, 4096
    s_add_u32 m0, s31, 24576
    s_nop 0
    buffer_load_dwordx4 v3, s[4:7], s30 offen sc1 lds
    s_add_u32 s30, s30, 4096
    s_add_u32 m0, s31, 28672
    s_nop 0
    buffer_load_dwordx4 v3, s[4:7], s30 offen sc1 lds
    s_add_u32 s30, s30, 4096
    buffer_load_dwordx2 v[80:81], v11, s[4:7], s21 offen sc1
    s_add_u32 s21, s21, 8192
    buffer_load_dwordx2 v[82:83], v11, s[4:7], s21 offen sc1
    s_add_u32 s21, s21, 8192
    buffer_load_dwordx2 v[84:85], v11, s[4:7], s21 offen sc1
    s_add_u32 s21, s21, 8192
    buffer_load_dwordx2 v[86:87], v11, s[4:7], s21 offen sc1
    s_add_u32 s21, s21, 8192
    buffer_load_dwordx2 v[88:89], v11, s[4:7], s21 offen sc1
    s_add_u32 s21, s21, 8192
    s_waitcnt vmcnt(9)
    s_barrier
    s_add_u32 m0, s31, 32768
    s_nop 0
    buffer_load_dwordx4 v3, s[4:7], s30 offen sc1 lds
    s_add_u32 s30, s30, 4096
    s_add_u32 m0, s31, 36864
    s_nop 0
    buffer_load_dwordx4 v3, s[4:7], s30 offen sc1 lds
    s_add_u32 s30, s30, 4096
    s_add_u32 m0, s31, 40960
    s_nop 0
    buffer_load_dwordx4 v3, s[4:7], s30 offen sc1 lds
    s_add_u32 s30, s30, 4096
    s_add_u32 m0, s31, 45056
    s_nop 0
    buffer_load_dwordx4 v3, s[4:7], s30 offen sc1 lds
    s_add_u32 s30, s30, 4096
    s_add_u32 m0, s31, 49152
    s_nop 0
    buffer_load_dwordx4 v3, s[4:7], s30 offen sc1 lds
    s_add_u32 s30, s30, 4096
    s_add_u32 m0, s31, 53248
    s_nop 0
    buffer_load_dwordx4 v3, s[4:7], s30 offen sc1 lds
    s_add_u32 s30, s30, 4096
    s_add_u32 m0, s31, 57344
    s_nop 0
    buffer_load_dwordx4 v3, s[4:7], s30 offen sc1 lds
    s_add_u32 s30, s30, 4096
    s_waitcnt vmcnt(12)
    s_barrier
    s_add_u32 m0, s31, 61440
    s_nop 0
    buffer_load_dwordx4 v3, s[4:7], s30 offen sc1 lds
    s_add_u32 s30, s30, 4096
    s_add_u32 m0, s31, 65536
    s_nop 0
    buffer_load_dwordx4 v3, s[4:7], s30 offen sc1 lds
    s_add_u32 s30, s30, 4096
    s_add_u32 m0, s31, 69632
    s_nop 0
    buffer_load_dwordx4 v3, s[4:7], s30 offen sc1 lds
    s_add_u32 s30, s30, 4096
    s_add_u32 m0, s31, 73728
    s_nop 0
    buffer_load_dwordx4 v3, s[4:7], s30 offen sc1 lds
    s_add_u32 s30, s30, 4096
    s_add_u32 m0, s31, 77824
    s_nop 0
    buffer_load_dwordx4 v3, s[4:7], s30 offen sc1 lds
    s_add_u32 s30, s30, 4096
    s_add_u32 m0, s31, 81920
    s_nop 0
    buffer_load_dwordx4 v3, s[4:7], s30 offen sc1 lds
    s_add_u32 s30, s30, 4096
    s_add_u32 m0, s31, 86016
    s_nop 0
    buffer_load_dwordx4 v3, s[4:7], s30 offen sc1 lds
    s_add_u32 s30, s30, 4096
    s_waitcnt vmcnt(10)
    s_barrier
    s_add_u32 m0, s31, 90112
    s_nop 0
    buffer_load_dwordx4 v3, s[4:7], s30 offen sc1 lds
    s_add_u32 s30, s30, 4096
    s_add_u32 m0, s31, 94208
    s_nop 0
    buffer_load_dwordx4 v3, s[4:7], s30 offen sc1 lds
    s_add_u32 s30, s30, 4096
    s_add_u32 m0, s31, 0
    s_nop 0
    buffer_load_dwordx4 v3, s[4:7], s30 offen sc1 lds
    s_add_u32 s30, s30, 4096
    s_add_u32 m0, s31, 4096
    s_nop 0
    buffer_load_dwordx4 v3, s[4:7], s30 offen sc1 lds
    s_add_u32 s30, s30, 4096
    s_add_u32 m0, s31, 8192
    s_nop 0
    buffer_load_dwordx4 v3, s[4:7], s30 offen sc1 lds
    s_add_u32 s30, s30, 4096
    s_add_u32 m0, s31, 12288
    s_nop 0
    buffer_load_dwordx4 v3, s[4:7], s30 offen sc1 lds
    s_add_u32 s30, s30, 4096
    s_lshl_b32 s50, s23, 9
    s_add_u32 s50, s50, 149504
    v_add_u32 v12, s50, v11
    v_pk_add_f32 v[80:81], v[80:81], v[82:83]
    v_pk_add_f32 v[80:81], v[80:81], v[84:85]
    v_pk_add_f32 v[80:81], v[80:81], v[86:87]
    v_pk_add_f32 v[80:81], v[80:81], v[88:89]
    ds_write_b64 v12, v[80:81]
    s_waitcnt lgkmcnt(0)
    s_waitcnt vmcnt(12)
    s_barrier
    s_add_u32 m0, s31, 16384
    s_nop 0
    buffer_load_dwordx4 v3, s[4:7], s30 offen sc1 lds
    s_add_u32 s30, s30, 4096
    s_add_u32 m0, s31, 20480
    s_nop 0
    buffer_load_dwordx4 v3, s[4:7], s30 offen sc1 lds
    s_add_u32 s30, s30, 4096
    s_add_u32 m0, s31, 24576
    s_nop 0
    buffer_load_dwordx4 v3, s[4:7], s30 offen sc1 lds
    s_add_u32 s30, s30, 4096
    s_add_u32 m0, s31, 28672
    s_nop 0
    buffer_load_dwordx4 v3, s[4:7], s30 offen sc1 lds
    s_add_u32 s30, s30, 4096
    v_add_u32 v12, 147456, v11
    ds_read_b64 v[80:81], v12 offset:2048
    ds_read_b64 v[82:83], v12 offset:2560
    ds_read_b64 v[84:85], v12 offset:3072
    ds_read_b64 v[86:87], v12 offset:3584
    s_waitcnt lgkmcnt(0)
    v_pk_add_f32 v[80:81], v[80:81], v[82:83]
    v_pk_add_f32 v[80:81], v[80:81], v[84:85]
    v_pk_add_f32 v[80:81], v[80:81], v[86:87]
    ds_write_b64 v12, v[80:81]
    s_waitcnt lgkmcnt(0)
    s_waitcnt vmcnt(12)
    s_barrier
    s_add_u32 m0, s31, 32768
    s_nop 0
    buffer_load_dwordx4 v3, s[4:7], s30 offen sc1 lds
    s_add_u32 s30, s30, 4096
    s_add_u32 m0, s31, 36864
    s_nop 0
    buffer_load_dwordx4 v3, s[4:7], s30 offen sc1 lds
    s_add_u32 s30, s30, 4096
    s_add_u32 m0, s31, 40960
    s_nop 0
    buffer_load_dwordx4 v3, s[4:7], s30 offen sc1 lds
    s_add_u32 s30, s30, 4096
    s_add_u32 m0, s31, 45056
    s_nop 0
    buffer_load_dwordx4 v3, s[4:7], s30 offen sc1 lds
    s_add_u32 s30, s30, 4096
    s_waitcnt vmcnt(12)
    s_barrier
    s_add_u32 m0, s31, 49152
    s_nop 0
    buffer_load_dwordx4 v3, s[4:7], s30 offen sc1 lds
    s_add_u32 s30, s30, 4096
    s_add_u32 m0, s31, 53248
    s_nop 0
    buffer_load_dwordx4 v3, s[4:7], s30 offen sc1 lds
    s_add_u32 s30, s30, 4096
    s_add_u32 m0, s31, 57344
    s_nop 0
    buffer_load_dwordx4 v3, s[4:7], s30 offen sc1 lds
    s_add_u32 s30, s30, 4096
    s_add_u32 m0, s31, 61440
    s_nop 0
    buffer_load_dwordx4 v3, s[4:7], s30 offen sc1 lds
    s_add_u32 s30, s30, 4096
    s_waitcnt vmcnt(12)
    s_barrier
    s_waitcnt vmcnt(8)
    s_barrier
    s_waitcnt vmcnt(4)
    s_barrier
    s_waitcnt vmcnt(0)
    s_barrier
    s_and_b32 s97, s23, 1
    s_mul_i32 s97, s97, 12288
    s_lshr_b32 s50, s23, 1
    s_mul_i32 s50, s50, 73728
    s_add_u32 s97, s97, s50
    s_lshl_b32 s50, s2, 1
    s_add_u32 s50, s50, s23
    s_cmp_lt_u32 s23, 2
    s_cbranch_scc1 L_mega_kernel_g2_25
    s_mov_b32 s50, s2
    s_cmp_eq_u32 s23, 3
    s_cbranch_scc1 L_mega_kernel_pj_23
    s_add_u32 s50, s2, 128
    s_cmp_ge_u32 s2, 128
    s_cbranch_scc1 L_mega_kernel_pj_23
    s_add_u32 s50, s2, 512
L_mega_kernel_g2_25:
    s_cmp_ge_u32 s50, 320
    s_cselect_b32 s21, 7, 0
    s_cselect_b32 s51, 320, 0
    s_cselect_b32 s52, 40, 32
    s_sub_u32 s50, s50, s51
    s_load_dwordx2 s[56:57], s[0:1], s52
    s_and_b32 s24, s50, 15
    s_lshr_b32 s25, s50, 4
    s_mov_b32 s58, 2211840
    s_waitcnt lgkmcnt(0)
    s_and_b32 s57, s57, 0xffff
    v_mul_u32_u24 v20, 4682, v1
    v_lshrrev_b32 v20, 16, v20
    v_mul_u32_u24 v21, 14, v20
    v_sub_u32 v21, v1, v21
    v_cmp_gt_u32 s[98:99], 4, v20
    v_mul_u32_u24 v16, 3456, v20
    v_lshl_add_u32 v16, v21, 4, v16
    s_mul_i32 s96, s24, 224
    s_lshl_b32 s30, s25, 3
    v_bfe_u32 v20, v1, 2, 2
    v_and_b32 v21, 3, v1
    v_lshl_add_u32 v20, v8, 3, v20
    v_mul_u32_u24 v20, 224, v20
    v_add_u32 v20, s97, v20
    v_lshl_add_u32 v17, v21, 4, v20
    v_lshl_add_u32 v18, v21, 3, v20
    v_lshlrev_b32 v19, 4, v8
    v_lshl_add_u32 v19, v7, 6, v19
    v_and_b32 v20, 31, v1
    v_lshrrev_b32 v20, 2, v20
    v_add_u32 v20, s30, v20
    v_lshl_add_u32 v20, v20, 2, v21
    v_mul_u32_u24 v22, 3456, v20
    s_mul_i32 s100, s24, 20
    s_add_u32 s100, s100, s25
    s_mul_i32 s100, s100, 14
    s_add_u32 s100, s100, s21
    s_lshl_b32 s100, s100, 10
    s_add_u32 s100, s100, 48234496
    s_lshl_b32 s101, s25, 4
    s_add_u32 s101, s101, s24
    s_mul_i32 s101, s101, 896
    s_lshl_b32 s50, s21, 6
    s_add_u32 s101, s101, s50
    s_add_u32 s101, s101, 56033280
    v_mov_b32 v20, 0x3f803f80
    v_cmp_eq_u32 vcc, 0, v7
    s_nop 1
    v_cndmask_b32 v21, 0, v20, vcc
    v_accvgpr_write_b32 a44, v21
    v_accvgpr_write_b32 a45, v21
    v_accvgpr_write_b32 a46, v21
    v_accvgpr_write_b32 a47, v21
    v_cmp_eq_u32 vcc, 1, v7
    s_nop 1
    v_cndmask_b32 v21, 0, v20, vcc
    v_accvgpr_write_b32 a48, v21
    v_accvgpr_write_b32 a49, v21
    v_accvgpr_write_b32 a50, v21
    v_accvgpr_write_b32 a51, v21
    v_cmp_eq_u32 vcc, 2, v7
    s_nop 1
    v_cndmask_b32 v21, 0, v20, vcc
    v_accvgpr_write_b32 a52, v21
    v_accvgpr_write_b32 a53, v21
    v_accvgpr_write_b32 a54, v21
    v_accvgpr_write_b32 a55, v21
    v_cmp_eq_u32 vcc, 3, v7
    s_nop 1
    v_cndmask_b32 v21, 0, v20, vcc
    v_accvgpr_write_b32 a56, v21
    v_accvgpr_write_b32 a57, v21
    v_accvgpr_write_b32 a58, v21
    v_accvgpr_write_b32 a59, v21
    v_cmp_eq_u32 vcc, 4, v7
    s_nop 1
    v_cndmask_b32 v21, 0, v20, vcc
    v_accvgpr_write_b32 a60, v21
    v_accvgpr_write_b32 a61, v21
    v_accvgpr_write_b32 a62, v21
    v_accvgpr_write_b32 a63, v21
    v_cmp_eq_u32 vcc, 5, v7
    s_nop 1
    v_cndmask_b32 v21, 0, v20, vcc
    v_accvgpr_write_b32 a64, v21
    v_accvgpr_write_b32 a65, v21
    v_accvgpr_write_b32 a66, v21
    v_accvgpr_write_b32 a67, v21
    v_cmp_eq_u32 vcc, 6, v7
    s_nop 1
    v_cndmask_b32 v21, 0, v20, vcc
    v_accvgpr_write_b32 a68, v21
    v_accvgpr_write_b32 a69, v21
    v_accvgpr_write_b32 a70, v21
    v_accvgpr_write_b32 a71, v21
    s_mov_b32 s61, 1
    s_mov_b32 s60, 1
    s_mul_i32 s50, s24, 286720
    s_add_u32 s50, s50, 48234496
    s_lshl_b32 s51, s25, 1
    s_min_u32 s52, s21, 1
    s_add_u32 s51, s51, s52
    s_or_b32 s50, s50, s51
    s_cmp_ge_u32 s25, 14
    s_cselect_b32 s100, s50, s100
    s_branch L_mega_kernel_cvd_22
L_mega_kernel_pj_23:
    s_and_b32 s24, s50, 7
    s_lshr_b32 s25, s50, 3
    s_lshl_b32 s25, s25, 1
    s_cmp_ge_u32 s50, 296
    s_cbranch_scc1 L_mega_kernel_cvd_22
    s_cmp_ge_u32 s50, 216
    s_cbranch_scc1 L_mega_kernel_cwo_24
    s_load_dwordx2 s[56:57], s[0:1], 48
    s_mov_b32 s58, 2211840
    s_waitcnt lgkmcnt(0)
    s_and_b32 s57, s57, 0xffff
    v_mul_u32_u24 v20, 6554, v1
    v_lshrrev_b32 v20, 16, v20
    v_mul_u32_u24 v21, 10, v20
    v_sub_u32 v21, v1, v21
    v_cmp_gt_u32 s[98:99], 4, v20
    v_mul_u32_u24 v16, 1280, v20
    v_lshl_add_u32 v16, v21, 4, v16
    s_mul_i32 s96, s24, 160
    s_lshl_b32 s30, s25, 3
    v_bfe_u32 v20, v1, 2, 2
    v_and_b32 v21, 3, v1
    v_lshl_add_u32 v20, v8, 3, v20
    v_mul_u32_u24 v20, 160, v20
    v_add_u32 v20, s97, v20
    v_lshl_add_u32 v17, v21, 4, v20
    v_lshl_add_u32 v18, v21, 3, v20
    v_lshlrev_b32 v19, 4, v8
    v_lshl_add_u32 v19, v7, 6, v19
    v_and_b32 v20, 63, v1
    v_lshrrev_b32 v20, 2, v20
    v_add_u32 v20, s30, v20
    v_subrev_u32 v25, 48, v20
    v_mul_u32_u24 v22, 5462, v25
    v_lshrrev_b32 v22, 16, v22
    v_lshlrev_b32 v22, 4, v22
    v_add3_u32 v22, v22, v25, 16
    v_subrev_u32 v23, 180, v20
    v_cmp_gt_u32 vcc, 48, v20
    s_nop 1
    v_cndmask_b32 v23, v23, v20, vcc
    v_lshrrev_b32 v24, 4, v23
    v_mul_u32_u24 v24, 12, v24
    v_add_u32 v23, v23, v24
    v_cmp_gt_u32 vcc, 180, v25
    s_nop 1
    v_cndmask_b32 v20, v23, v22, vcc
    v_lshl_add_u32 v20, v20, 2, v21
    v_mul_u32_u24 v22, 1280, v20
    s_mul_i32 s100, s24, 54
    s_add_u32 s100, s100, s25
    s_mul_i32 s100, s100, 5
    s_lshl_b32 s100, s100, 10
    s_add_u32 s100, s100, 53641216
    s_mov_b32 s61, 2
    s_mov_b32 s60, 1
    s_branch L_mega_kernel_cvd_22
L_mega_kernel_cwo_24:
    s_sub_u32 s25, s25, 54
    s_load_dwordx2 s[56:57], s[0:1], 16
    s_mov_b32 s58, 819200
    s_waitcnt lgkmcnt(0)
    s_and_b32 s57, s57, 0xffff
    v_mul_u32_u24 v20, 6554, v1
    v_lshrrev_b32 v20, 16, v20
    v_mul_u32_u24 v21, 10, v20
    v_sub_u32 v21, v1, v21
    v_cmp_gt_u32 s[98:99], 4, v20
    v_mul_u32_u24 v16, 1280, v20
    v_lshl_add_u32 v16, v21, 4, v16
    s_mul_i32 s96, s24, 160
    s_lshl_b32 s30, s25, 3
    v_bfe_u32 v20, v1, 2, 2
    v_and_b32 v21, 3, v1
    v_lshl_add_u32 v20, v8, 3, v20
    v_mul_u32_u24 v20, 160, v20
    v_add_u32 v20, s97, v20
    v_lshl_add_u32 v17, v21, 4, v20
    v_lshl_add_u32 v18, v21, 3, v20
    v_lshlrev_b32 v19, 4, v8
    v_lshl_add_u32 v19, v7, 6, v19
    v_and_b32 v20, 63, v1
    v_lshrrev_b32 v20, 2, v20
    v_add_u32 v20, s30, v20
    v_lshrrev_b32 v22, 2, v20
    v_add_u32 v22, v22, v20
    v_subrev_u32 v22, 40, v22
    v_mul_u32_u24 v23, 5, v20
    v_add_u32 v23, 4, v23
    v_cmp_gt_u32 vcc, 32, v20
    s_nop 1
    v_cndmask_b32 v20, v22, v23, vcc
    v_lshl_add_u32 v20, v20, 2, v21
    v_mul_u32_u24 v22, 1280, v20
    s_mul_i32 s100, s24, 20
    s_add_u32 s100, s100, s25
    s_mul_i32 s100, s100, 5
    s_lshl_b32 s100, s100, 10
    s_add_u32 s100, s100, 52822016
    s_mov_b32 s61, 3
    s_mov_b32 s60, 1
    s_branch L_mega_kernel_cvd_22
L_mega_kernel_cvd_22:
    s_lshl_b32 s50, s13, 11
    s_add_u32 s50, s50, s18
    s_add_u32 s50, s50, 23920704
    v_lshlrev_b32 v10, 7, v1
    v_mov_b32 v11, 1
    s_waitcnt lgkmcnt(0)
    s_barrier
    s_cmp_lg_u32 s22, 5
    s_cbranch_scc1 L_mega_kernel_es_26
    s_mov_b64 exec, 0xffff
    buffer_atomic_add v11, v10, s[4:7], s50 offen sc1
    s_mov_b64 exec, -1
L_mega_kernel_es_26:
    s_branch L_mega_kernel_att_2
L_mega_kernel_L0_6:
    s_mov_b32 s96, s24
    s_and_b32 s97, s25, 0xffff
    s_mov_b32 s98, 2621440
    s_mov_b32 s99, 0x00020000
    s_lshl_b32 s24, s14, 1
    s_lshr_b32 s25, s23, 1
    s_add_u32 s24, s24, s25
    s_and_b32 s25, s23, 1
    s_lshl_b32 s25, s25, 8
    s_mul_i32 s20, s24, 40960
    s_add_u32 s20, s20, s25
    s_add_u32 s20, s20, s18
    s_add_u32 s20, s20, 11141120
    v_mul_u32_u24 v10, 1280, v7
    v_lshl_add_u32 v11, v8, 4, v10
    v_lshl_add_u32 v12, v8, 3, v10
    s_lshl_b32 s26, s24, 5
    s_lshr_b32 s27, s25, 4
    s_add_u32 s26, s26, s27
    s_mul_i32 s26, s26, 1280
    s_mul_i32 s27, s15, 160
    s_add_u32 s26, s26, s27
    buffer_load_dwordx4 v[16:19], v11, s[96:99], s26 offen
    buffer_load_dwordx4 v[20:23], v11, s[96:99], s26 offen offset:64
    buffer_load_dwordx2 v[24:25], v12, s[96:99], s26 offen offset:128
    s_setprio 2
    v_lshrrev_b32 v26, 3, v1
    v_and_b32 v27, 7, v1
    v_xor_b32 v27, v27, v26
    v_mul_u32_u24 v39, 1280, v26
    v_lshl_add_u32 v39, v27, 4, v39
    s_lshl_b32 s30, s12, 2
    s_add_u32 s30, s30, s23
    s_mul_i32 s30, s30, 40960
    s_lshl_b32 s21, s23, 12
    s_add_u32 m0, s21, 98304
    s_add_u32 s50, s30, 0
    buffer_load_dwordx4 v39, s[96:99], s50 offen lds
    s_add_u32 m0, s21, 99328
    s_add_u32 s50, s30, 10240
    buffer_load_dwordx4 v39, s[96:99], s50 offen lds
    s_add_u32 m0, s21, 100352
    s_add_u32 s50, s30, 20480
    buffer_load_dwordx4 v39, s[96:99], s50 offen lds
    s_add_u32 m0, s21, 101376
    s_add_u32 s50, s30, 30720
    buffer_load_dwordx4 v39, s[96:99], s50 offen lds
    s_add_u32 m0, s21, 114688
    s_add_u32 s50, s30, 128
    buffer_load_dwordx4 v39, s[96:99], s50 offen lds
    s_add_u32 m0, s21, 115712
    s_add_u32 s50, s30, 10368
    buffer_load_dwordx4 v39, s[96:99], s50 offen lds
    s_add_u32 m0, s21, 116736
    s_add_u32 s50, s30, 20608
    buffer_load_dwordx4 v39, s[96:99], s50 offen lds
    s_add_u32 m0, s21, 117760
    s_add_u32 s50, s30, 30848
    buffer_load_dwordx4 v39, s[96:99], s50 offen lds
    s_add_u32 m0, s21, 16384
    s_add_u32 s50, s30, 256
    buffer_load_dwordx4 v39, s[96:99], s50 offen lds
    s_add_u32 m0, s21, 17408
    s_add_u32 s50, s30, 10496
    buffer_load_dwordx4 v39, s[96:99], s50 offen lds
    s_add_u32 m0, s21, 18432
    s_add_u32 s50, s30, 20736
    buffer_load_dwordx4 v39, s[96:99], s50 offen lds
    s_add_u32 m0, s21, 19456
    s_add_u32 s50, s30, 30976
    buffer_load_dwordx4 v39, s[96:99], s50 offen lds
    s_add_u32 m0, s21, 32768
    s_add_u32 s50, s30, 384
    buffer_load_dwordx4 v39, s[96:99], s50 offen lds
    s_add_u32 m0, s21, 33792
    s_add_u32 s50, s30, 10624
    buffer_load_dwordx4 v39, s[96:99], s50 offen lds
    s_add_u32 m0, s21, 34816
    s_add_u32 s50, s30, 20864
    buffer_load_dwordx4 v39, s[96:99], s50 offen lds
    s_add_u32 m0, s21, 35840
    s_add_u32 s50, s30, 31104
    buffer_load_dwordx4 v39, s[96:99], s50 offen lds
    s_add_u32 m0, s21, 49152
    s_add_u32 s50, s30, 512
    buffer_load_dwordx4 v39, s[96:99], s50 offen lds
    s_add_u32 m0, s21, 50176
    s_add_u32 s50, s30, 10752
    buffer_load_dwordx4 v39, s[96:99], s50 offen lds
    s_add_u32 m0, s21, 51200
    s_add_u32 s50, s30, 20992
    buffer_load_dwordx4 v39, s[96:99], s50 offen lds
    s_add_u32 m0, s21, 52224
    s_add_u32 s50, s30, 31232
    buffer_load_dwordx4 v39, s[96:99], s50 offen lds
    s_add_u32 m0, s21, 65536
    s_add_u32 s50, s30, 640
    buffer_load_dwordx4 v39, s[96:99], s50 offen lds
    s_add_u32 m0, s21, 66560
    s_add_u32 s50, s30, 10880
    buffer_load_dwordx4 v39, s[96:99], s50 offen lds
    s_add_u32 m0, s21, 67584
    s_add_u32 s50, s30, 21120
    buffer_load_dwordx4 v39, s[96:99], s50 offen lds
    s_add_u32 m0, s21, 68608
    s_add_u32 s50, s30, 31360
    buffer_load_dwordx4 v39, s[96:99], s50 offen lds
    s_add_u32 m0, s21, 81920
    s_add_u32 s50, s30, 768
    buffer_load_dwordx4 v39, s[96:99], s50 offen lds
    s_add_u32 m0, s21, 82944
    s_add_u32 s50, s30, 11008
    buffer_load_dwordx4 v39, s[96:99], s50 offen lds
    s_add_u32 m0, s21, 83968
    s_add_u32 s50, s30, 21248
    buffer_load_dwordx4 v39, s[96:99], s50 offen lds
    s_add_u32 m0, s21, 84992
    s_add_u32 s50, s30, 31488
    buffer_load_dwordx4 v39, s[96:99], s50 offen lds
    s_add_u32 m0, s21, 131072
    s_add_u32 s50, s30, 896
    buffer_load_dwordx4 v39, s[96:99], s50 offen lds
    s_add_u32 m0, s21, 132096
    s_add_u32 s50, s30, 11136
    buffer_load_dwordx4 v39, s[96:99], s50 offen lds
    s_add_u32 m0, s21, 133120
    s_add_u32 s50, s30, 21376
    buffer_load_dwordx4 v39, s[96:99], s50 offen lds
    s_add_u32 m0, s21, 134144
    s_add_u32 s50, s30, 31616
    buffer_load_dwordx4 v39, s[96:99], s50 offen lds
    s_lshl_b32 s24, s12, 2
    s_add_u32 s24, s24, s23
    s_mul_i32 s20, s24, 40960
    s_add_u32 s20, s20, s18
    s_add_u32 s20, s20, 0
    v_lshlrev_b32 v13, 4, v8
    v_add_u32 v13, 147456, v13
    s_lshl_b32 s26, s13, 7
    s_add_u32 s26, s26, s24
    s_lshl_b32 s28, s26, 10
    s_add_u32 s28, s28, 2752512
    s_mul_i32 s26, s26, 3072
    s_add_u32 s29, s26, 4848640
    v_mov_b32 v14, s29
    v_mov_b32 v15, s28
    v_cndmask_b32 v14, v14, v15, s[32:33]
    v_add_u32 v14, v14, v6
    v_mov_b32 v15, 196608
    v_mov_b32 v10, 65536
    v_cndmask_b32 v15, v15, v10, s[32:33]
    v_add_u32 v15, v15, v14
    s_add_u32 s26, s26, s18
    s_add_u32 s26, s26, 4850688
    s_add_u32 s27, s26, 196608
    v_mov_b32 v12, 0x3f80
    v_and_b32 v30, 7, v1
    v_xor_b32 v31, v8, v30
    v_lshlrev_b32 v32, 7, v7
    s_add_u32 s50, s21, 16384
    v_add_u32 v32, s50, v32
    v_lshl_add_u32 v34, v31, 4, v32
    v_xor_b32 v35, 64, v34
    v_add_u32 v36, 0x10000, v34
    v_add_u32 v37, 0x10000, v35
    v_mov_b32 v30, 0x3f803f80
    v_accvgpr_write_b32 a36, v30
    v_accvgpr_write_b32 a37, v30
    v_accvgpr_write_b32 a38, v30
    v_accvgpr_write_b32 a39, v30
    s_waitcnt vmcnt(28)
    ds_read_b128 a[40:43], v36 offset:16384
    ds_read_b128 a[44:47], v36 offset:18432
    ds_read_b128 a[48:51], v37 offset:16384
    ds_read_b128 a[52:55], v37 offset:18432
    s_waitcnt lgkmcnt(0)
    s_add_u32 m0, s21, 98304
    s_add_u32 s50, s30, 1024
    buffer_load_dwordx4 v39, s[96:99], s50 offen lds
    s_add_u32 m0, s21, 99328
    s_add_u32 s50, s30, 11264
    buffer_load_dwordx4 v39, s[96:99], s50 offen lds
    s_add_u32 m0, s21, 100352
    s_add_u32 s50, s30, 21504
    buffer_load_dwordx4 v39, s[96:99], s50 offen lds
    s_add_u32 m0, s21, 101376
    s_add_u32 s50, s30, 31744
    buffer_load_dwordx4 v39, s[96:99], s50 offen lds
    v_mfma_f32_16x16x32_bf16 v[40:43], a[36:39], a[40:43], 0
    v_mfma_f32_16x16x32_bf16 v[48:51], a[40:43], a[40:43], 0
    v_mfma_f32_16x16x32_bf16 v[44:47], a[36:39], a[44:47], 0
    v_mfma_f32_16x16x32_bf16 v[52:55], a[44:47], a[44:47], 0
    v_mfma_f32_16x16x32_bf16 v[40:43], a[36:39], a[48:51], v[40:43]
    v_mfma_f32_16x16x32_bf16 v[48:51], a[48:51], a[48:51], v[48:51]
    v_mfma_f32_16x16x32_bf16 v[44:47], a[36:39], a[52:55], v[44:47]
    v_mfma_f32_16x16x32_bf16 v[52:55], a[52:55], a[52:55], v[52:55]
    s_waitcnt vmcnt(28)
    ds_read_b128 a[56:59], v36 offset:32768
    ds_read_b128 a[60:63], v36 offset:34816
    ds_read_b128 a[64:67], v37 offset:32768
    ds_read_b128 a[68:71], v37 offset:34816
    s_waitcnt lgkmcnt(0)
    s_add_u32 m0, s21, 114688
    s_add_u32 s50, s30, 1152
    buffer_load_dwordx4 v39, s[96:99], s50 offen lds
    s_add_u32 m0, s21, 115712
    s_add_u32 s50, s30, 11392
    buffer_load_dwordx4 v39, s[96:99], s50 offen lds
    s_add_u32 m0, s21, 116736
    s_add_u32 s50, s30, 21632
    buffer_load_dwordx4 v39, s[96:99], s50 offen lds
    s_add_u32 m0, s21, 117760
    s_add_u32 s50, s30, 31872
    buffer_load_dwordx4 v39, s[96:99], s50 offen lds
    v_mfma_f32_16x16x32_bf16 v[40:43], a[36:39], a[56:59], v[40:43]
    v_mfma_f32_16x16x32_bf16 v[48:51], a[56:59], a[56:59], v[48:51]
    v_mfma_f32_16x16x32_bf16 v[44:47], a[36:39], a[60:63], v[44:47]
    v_mfma_f32_16x16x32_bf16 v[52:55], a[60:63], a[60:63], v[52:55]
    v_mfma_f32_16x16x32_bf16 v[40:43], a[36:39], a[64:67], v[40:43]
    v_mfma_f32_16x16x32_bf16 v[48:51], a[64:67], a[64:67], v[48:51]
    v_mfma_f32_16x16x32_bf16 v[44:47], a[36:39], a[68:71], v[44:47]
    v_mfma_f32_16x16x32_bf16 v[52:55], a[68:71], a[68:71], v[52:55]
    s_waitcnt vmcnt(28)
    ds_read_b128 a[72:75], v34 offset:0
    ds_read_b128 a[76:79], v34 offset:2048
    ds_read_b128 a[80:83], v35 offset:0
    ds_read_b128 a[84:87], v35 offset:2048
    s_waitcnt lgkmcnt(0)
    v_mfma_f32_16x16x32_bf16 v[40:43], a[36:39], a[72:75], v[40:43]
    v_mfma_f32_16x16x32_bf16 v[48:51], a[72:75], a[72:75], v[48:51]
    v_mfma_f32_16x16x32_bf16 v[44:47], a[36:39], a[76:79], v[44:47]
    v_mfma_f32_16x16x32_bf16 v[52:55], a[76:79], a[76:79], v[52:55]
    v_mfma_f32_16x16x32_bf16 v[40:43], a[36:39], a[80:83], v[40:43]
    v_mfma_f32_16x16x32_bf16 v[48:51], a[80:83], a[80:83], v[48:51]
    v_mfma_f32_16x16x32_bf16 v[44:47], a[36:39], a[84:87], v[44:47]
    v_mfma_f32_16x16x32_bf16 v[52:55], a[84:87], a[84:87], v[52:55]
    s_waitcnt vmcnt(24)
    ds_read_b128 a[88:91], v34 offset:16384
    ds_read_b128 a[92:95], v34 offset:18432
    ds_read_b128 v[104:107], v35 offset:16384
    ds_read_b128 v[108:111], v35 offset:18432
    s_waitcnt lgkmcnt(0)
    v_mfma_f32_16x16x32_bf16 v[40:43], a[36:39], a[88:91], v[40:43]
    v_mfma_f32_16x16x32_bf16 v[48:51], a[88:91], a[88:91], v[48:51]
    v_mfma_f32_16x16x32_bf16 v[44:47], a[36:39], a[92:95], v[44:47]
    v_mfma_f32_16x16x32_bf16 v[52:55], a[92:95], a[92:95], v[52:55]
    v_mfma_f32_16x16x32_bf16 v[40:43], a[36:39], v[104:107], v[40:43]
    v_mfma_f32_16x16x32_bf16 v[48:51], v[104:107], v[104:107], v[48:51]
    v_mfma_f32_16x16x32_bf16 v[44:47], a[36:39], v[108:111], v[44:47]
    v_mfma_f32_16x16x32_bf16 v[52:55], v[108:111], v[108:111], v[52:55]
    s_waitcnt vmcnt(20)
    ds_read_b128 v[112:115], v34 offset:32768
    ds_read_b128 v[116:119], v34 offset:34816
    ds_read_b128 v[120:123], v35 offset:32768
    ds_read_b128 v[124:127], v35 offset:34816
    s_waitcnt lgkmcnt(0)
    v_mfma_f32_16x16x32_bf16 v[40:43], a[36:39], v[112:115], v[40:43]
    v_mfma_f32_16x16x32_bf16 v[48:51], v[112:115], v[112:115], v[48:51]
    v_mfma_f32_16x16x32_bf16 v[44:47], a[36:39], v[116:119], v[44:47]
    v_mfma_f32_16x16x32_bf16 v[52:55], v[116:119], v[116:119], v[52:55]
    v_mfma_f32_16x16x32_bf16 v[40:43], a[36:39], v[120:123], v[40:43]
    v_mfma_f32_16x16x32_bf16 v[48:51], v[120:123], v[120:123], v[48:51]
    v_mfma_f32_16x16x32_bf16 v[44:47], a[36:39], v[124:127], v[44:47]
    v_mfma_f32_16x16x32_bf16 v[52:55], v[124:127], v[124:127], v[52:55]
    s_waitcnt vmcnt(16)
    ds_read_b128 v[128:131], v34 offset:49152
    ds_read_b128 v[132:135], v34 offset:51200
    ds_read_b128 v[136:139], v35 offset:49152
    ds_read_b128 v[140:143], v35 offset:51200
    s_waitcnt lgkmcnt(0)
    v_mfma_f32_16x16x32_bf16 v[40:43], a[36:39], v[128:131], v[40:43]
    v_mfma_f32_16x16x32_bf16 v[48:51], v[128:131], v[128:131], v[48:51]
    v_mfma_f32_16x16x32_bf16 v[44:47], a[36:39], v[132:135], v[44:47]
    v_mfma_f32_16x16x32_bf16 v[52:55], v[132:135], v[132:135], v[52:55]
    v_mfma_f32_16x16x32_bf16 v[40:43], a[36:39], v[136:139], v[40:43]
    v_mfma_f32_16x16x32_bf16 v[48:51], v[136:139], v[136:139], v[48:51]
    v_mfma_f32_16x16x32_bf16 v[44:47], a[36:39], v[140:143], v[44:47]
    v_mfma_f32_16x16x32_bf16 v[52:55], v[140:143], v[140:143], v[52:55]
    s_waitcnt vmcnt(12)
    ds_read_b128 v[144:147], v36 offset:0
    ds_read_b128 v[148:151], v36 offset:2048
    ds_read_b128 v[152:155], v37 offset:0
    ds_read_b128 v[156:159], v37 offset:2048
    s_waitcnt lgkmcnt(0)
    v_mfma_f32_16x16x32_bf16 v[40:43], a[36:39], v[144:147], v[40:43]
    v_mfma_f32_16x16x32_bf16 v[48:51], v[144:147], v[144:147], v[48:51]
    v_mfma_f32_16x16x32_bf16 v[44:47], a[36:39], v[148:151], v[44:47]
    v_mfma_f32_16x16x32_bf16 v[52:55], v[148:151], v[148:151], v[52:55]
    v_mfma_f32_16x16x32_bf16 v[40:43], a[36:39], v[152:155], v[40:43]
    v_mfma_f32_16x16x32_bf16 v[48:51], v[152:155], v[152:155], v[48:51]
    v_mfma_f32_16x16x32_bf16 v[44:47], a[36:39], v[156:159], v[44:47]
    v_mfma_f32_16x16x32_bf16 v[52:55], v[156:159], v[156:159], v[52:55]
    s_waitcnt vmcnt(8)
    ds_read_b128 v[56:59], v36 offset:49152
    ds_read_b128 v[60:63], v36 offset:51200
    ds_read_b128 v[64:67], v37 offset:49152
    ds_read_b128 v[68:71], v37 offset:51200
    s_waitcnt lgkmcnt(0)
    v_mfma_f32_16x16x32_bf16 v[40:43], a[36:39], v[56:59], v[40:43]
    v_mfma_f32_16x16x32_bf16 v[48:51], v[56:59], v[56:59], v[48:51]
    v_mfma_f32_16x16x32_bf16 v[44:47], a[36:39], v[60:63], v[44:47]
    v_mfma_f32_16x16x32_bf16 v[52:55], v[60:63], v[60:63], v[52:55]
    v_mfma_f32_16x16x32_bf16 v[40:43], a[36:39], v[64:67], v[40:43]
    v_mfma_f32_16x16x32_bf16 v[48:51], v[64:67], v[64:67], v[48:51]
    v_mfma_f32_16x16x32_bf16 v[44:47], a[36:39], v[68:71], v[44:47]
    v_mfma_f32_16x16x32_bf16 v[52:55], v[68:71], v[68:71], v[52:55]
    s_waitcnt vmcnt(4)
    ds_read_b128 v[56:59], v36 offset:16384
    ds_read_b128 v[60:63], v36 offset:18432
    ds_read_b128 v[64:67], v37 offset:16384
    ds_read_b128 v[68:71], v37 offset:18432
    s_waitcnt lgkmcnt(0)
    v_mfma_f32_16x16x32_bf16 v[40:43], a[36:39], v[56:59], v[40:43]
    v_mfma_f32_16x16x32_bf16 v[48:51], v[56:59], v[56:59], v[48:51]
    v_mfma_f32_16x16x32_bf16 v[44:47], a[36:39], v[60:63], v[44:47]
    v_mfma_f32_16x16x32_bf16 v[52:55], v[60:63], v[60:63], v[52:55]
    v_mfma_f32_16x16x32_bf16 v[40:43], a[36:39], v[64:67], v[40:43]
    v_mfma_f32_16x16x32_bf16 v[48:51], v[64:67], v[64:67], v[48:51]
    v_mfma_f32_16x16x32_bf16 v[44:47], a[36:39], v[68:71], v[44:47]
    v_mfma_f32_16x16x32_bf16 v[52:55], v[68:71], v[68:71], v[52:55]
    s_waitcnt vmcnt(0)
    ds_read_b128 v[56:59], v36 offset:32768
    ds_read_b128 v[60:63], v36 offset:34816
    ds_read_b128 v[64:67], v37 offset:32768
    ds_read_b128 v[68:71], v37 offset:34816
    s_waitcnt lgkmcnt(0)
    v_mfma_f32_16x16x32_bf16 v[40:43], a[36:39], v[56:59], v[40:43]
    v_mfma_f32_16x16x32_bf16 v[48:51], v[56:59], v[56:59], v[48:51]
    v_mfma_f32_16x16x32_bf16 v[44:47], a[36:39], v[60:63], v[44:47]
    v_mfma_f32_16x16x32_bf16 v[52:55], v[60:63], v[60:63], v[52:55]
    v_mfma_f32_16x16x32_bf16 v[40:43], a[36:39], v[64:67], v[40:43]
    v_mfma_f32_16x16x32_bf16 v[48:51], v[64:67], v[64:67], v[48:51]
    v_mfma_f32_16x16x32_bf16 v[44:47], a[36:39], v[68:71], v[44:47]
    v_mfma_f32_16x16x32_bf16 v[52:55], v[68:71], v[68:71], v[52:55]
    v_lshlrev_b32 v38, 2, v8
    v_sub_u32 v38, v7, v38
    v_mov_b32 v73, 0
    v_mov_b32 v74, 0
    v_mov_b32 v75, 0
    v_mov_b32 v77, 0
    v_mov_b32 v78, 0
    v_mov_b32 v79, 0
    v_mul_f32 v72, 0x3e800000, v40
    v_mul_f32 v76, 0x3e800000, v44
    v_cmp_eq_u32 vcc, 0, v38
    s_nop 1
    v_cndmask_b32 v73, v73, v48, vcc
    v_cndmask_b32 v77, v77, v52, vcc
    v_cmp_eq_u32 vcc, 1, v38
    s_nop 1
    v_cndmask_b32 v73, v73, v49, vcc
    v_cndmask_b32 v77, v77, v53, vcc
    v_cmp_eq_u32 vcc, 2, v38
    s_nop 1
    v_cndmask_b32 v73, v73, v50, vcc
    v_cndmask_b32 v77, v77, v54, vcc
    v_cmp_eq_u32 vcc, 3, v38
    s_nop 1
    v_cndmask_b32 v73, v73, v51, vcc
    v_cndmask_b32 v77, v77, v55, vcc
    v_add_f32 v26, v72, v74
    v_add_f32 v28, v73, v75
    v_add_f32 v27, v76, v78
    v_add_f32 v29, v77, v79
    v_mov_b32 v72, v26
    v_mov_b32 v73, v27
    v_mov_b32 v74, v28
    v_mov_b32 v75, v29
    s_nop 0
    v_permlane32_swap_b32 v72, v26
    v_permlane32_swap_b32 v73, v27
    v_permlane32_swap_b32 v74, v28
    v_permlane32_swap_b32 v75, v29
    s_nop 0
    v_add_f32 v26, v26, v72
    v_add_f32 v27, v27, v73
    v_add_f32 v28, v28, v74
    v_add_f32 v29, v29, v75
    v_mov_b32 v72, v26
    v_mov_b32 v73, v27
    v_mov_b32 v74, v28
    v_mov_b32 v75, v29
    s_nop 0
    v_permlane16_swap_b32 v72, v26
    v_permlane16_swap_b32 v73, v27
    v_permlane16_swap_b32 v74, v28
    v_permlane16_swap_b32 v75, v29
    s_nop 0
    v_add_f32 v26, v26, v72
    v_add_f32 v27, v27, v73
    v_add_f32 v28, v28, v74
    v_add_f32 v29, v29, v75
    v_mul_f32 v26, 0x3acccccd, v26
    v_mul_f32 v27, 0x3acccccd, v27
    v_mul_f32 v28, 0x3acccccd, v28
    v_mul_f32 v29, 0x3acccccd, v29
    v_fma_f32 v28, -v26, v26, v28
    v_max_f32 v28, 0, v28
    v_add_f32 v28, 0x3727c5ac, v28
    v_fma_f32 v29, -v27, v27, v29
    v_max_f32 v29, 0, v29
    v_add_f32 v29, 0x3727c5ac, v29
    v_rsq_f32 v31, v28
    v_rsq_f32 v33, v29
    v_sub_f32 v26, 0, v26
    v_sub_f32 v27, 0, v27
    v_mul_f32 v30, 0x3f1166db, v31
    v_mul_f32 v32, 0x3f1166db, v33
    v_cndmask_b32 v31, v31, v30, s[40:41]
    v_cndmask_b32 v33, v33, v32, s[40:41]
    s_barrier
    v_mov_b32 v9, 148896
    ds_read_b32 v9, v9
    s_waitcnt lgkmcnt(0)
    v_readfirstlane_b32 s3, v9
    s_barrier
    ds_read_b128 a[0:3], v3 offset:0
    ds_read_b128 a[4:7], v3 offset:1024
    ds_read_b128 a[8:11], v3 offset:2048
    ds_read_b128 a[12:15], v3 offset:3072
    ds_read_b128 a[16:19], v3 offset:4096
    ds_read_b128 a[20:23], v3 offset:5120
    ds_read_b128 a[24:27], v3 offset:6144
    ds_read_b128 a[28:31], v3 offset:7168
    s_waitcnt lgkmcnt(7)
    v_mfma_f32_16x16x32_bf16 v[40:43], a[0:3], a[40:43], 0
    ds_read_b128 a[32:35], v3 offset:8192
    v_mfma_f32_16x16x32_bf16 v[72:75], a[0:3], a[44:47], 0
    s_waitcnt lgkmcnt(7)
    v_mfma_f32_16x16x32_bf16 v[44:47], a[4:7], a[40:43], 0
    ds_read_b128 a[0:3], v3 offset:9216
    v_mfma_f32_16x16x32_bf16 v[76:79], a[4:7], a[44:47], 0
    s_waitcnt lgkmcnt(7)
    v_mfma_f32_16x16x32_bf16 v[48:51], a[8:11], a[40:43], 0
    ds_read_b128 a[4:7], v3 offset:10240
    v_mfma_f32_16x16x32_bf16 v[80:83], a[8:11], a[44:47], 0
    s_waitcnt lgkmcnt(7)
    v_mfma_f32_16x16x32_bf16 v[52:55], a[12:15], a[40:43], 0
    ds_read_b128 a[8:11], v3 offset:11264
    v_mfma_f32_16x16x32_bf16 v[84:87], a[12:15], a[44:47], 0
    s_waitcnt lgkmcnt(7)
    v_mfma_f32_16x16x32_bf16 v[56:59], a[16:19], a[40:43], 0
    ds_read_b128 a[12:15], v3 offset:12288
    v_mfma_f32_16x16x32_bf16 v[88:91], a[16:19], a[44:47], 0
    s_waitcnt lgkmcnt(7)
    v_mfma_f32_16x16x32_bf16 v[60:63], a[20:23], a[40:43], 0
    ds_read_b128 a[16:19], v3 offset:13312
    v_mfma_f32_16x16x32_bf16 v[92:95], a[20:23], a[44:47], 0
    s_waitcnt lgkmcnt(7)
    v_mfma_f32_16x16x32_bf16 v[64:67], a[24:27], a[40:43], 0
    ds_read_b128 a[20:23], v3 offset:14336
    v_mfma_f32_16x16x32_bf16 v[96:99], a[24:27], a[44:47], 0
    s_waitcnt lgkmcnt(7)
    v_mfma_f32_16x16x32_bf16 v[68:71], a[28:31], a[40:43], 0
    ds_read_b128 a[24:27], v3 offset:15360
    v_mfma_f32_16x16x32_bf16 v[100:103], a[28:31], a[44:47], 0
    s_waitcnt lgkmcnt(7)
    v_mfma_f32_16x16x32_bf16 v[40:43], a[32:35], a[48:51], v[40:43]
    s_barrier
    ds_read_b128 a[28:31], v3 offset:16384
    v_mfma_f32_16x16x32_bf16 v[72:75], a[32:35], a[52:55], v[72:75]
    s_waitcnt lgkmcnt(7)
    v_mfma_f32_16x16x32_bf16 v[44:47], a[0:3], a[48:51], v[44:47]
    ds_read_b128 a[32:35], v3 offset:17408
    v_mfma_f32_16x16x32_bf16 v[76:79], a[0:3], a[52:55], v[76:79]
    s_waitcnt lgkmcnt(7)
    v_mfma_f32_16x16x32_bf16 v[48:51], a[4:7], a[48:51], v[48:51]
    ds_read_b128 a[0:3], v3 offset:18432
    v_mfma_f32_16x16x32_bf16 v[80:83], a[4:7], a[52:55], v[80:83]
    s_waitcnt lgkmcnt(7)
    v_mfma_f32_16x16x32_bf16 v[52:55], a[8:11], a[48:51], v[52:55]
    ds_read_b128 a[4:7], v3 offset:19456
    v_mfma_f32_16x16x32_bf16 v[84:87], a[8:11], a[52:55], v[84:87]
    s_waitcnt lgkmcnt(7)
    v_mfma_f32_16x16x32_bf16 v[56:59], a[12:15], a[48:51], v[56:59]
    ds_read_b128 a[8:11], v3 offset:20480
    v_mfma_f32_16x16x32_bf16 v[88:91], a[12:15], a[52:55], v[88:91]
    s_waitcnt lgkmcnt(7)
    v_mfma_f32_16x16x32_bf16 v[60:63], a[16:19], a[48:51], v[60:63]
    ds_read_b128 a[12:15], v3 offset:21504
    v_mfma_f32_16x16x32_bf16 v[92:95], a[16:19], a[52:55], v[92:95]
    s_waitcnt lgkmcnt(7)
    v_mfma_f32_16x16x32_bf16 v[64:67], a[20:23], a[48:51], v[64:67]
    ds_read_b128 a[16:19], v3 offset:22528
    v_mfma_f32_16x16x32_bf16 v[96:99], a[20:23], a[52:55], v[96:99]
    s_waitcnt lgkmcnt(7)
    v_mfma_f32_16x16x32_bf16 v[68:71], a[24:27], a[48:51], v[68:71]
    ds_read_b128 a[20:23], v3 offset:23552
    v_mfma_f32_16x16x32_bf16 v[100:103], a[24:27], a[52:55], v[100:103]
    s_waitcnt lgkmcnt(7)
    v_mfma_f32_16x16x32_bf16 v[40:43], a[28:31], a[56:59], v[40:43]
    ds_read_b128 a[24:27], v3 offset:24576
    v_mfma_f32_16x16x32_bf16 v[72:75], a[28:31], a[60:63], v[72:75]
    s_waitcnt lgkmcnt(7)
    v_mfma_f32_16x16x32_bf16 v[44:47], a[32:35], a[56:59], v[44:47]
    ds_read_b128 a[28:31], v3 offset:25600
    v_mfma_f32_16x16x32_bf16 v[76:79], a[32:35], a[60:63], v[76:79]
    s_waitcnt lgkmcnt(7)
    v_mfma_f32_16x16x32_bf16 v[48:51], a[0:3], a[56:59], v[48:51]
    ds_read_b128 a[32:35], v3 offset:26624
    v_mfma_f32_16x16x32_bf16 v[80:83], a[0:3], a[60:63], v[80:83]
    s_waitcnt lgkmcnt(7)
    v_mfma_f32_16x16x32_bf16 v[52:55], a[4:7], a[56:59], v[52:55]
    ds_read_b128 a[0:3], v3 offset:27648
    v_mfma_f32_16x16x32_bf16 v[84:87], a[4:7], a[60:63], v[84:87]
    s_waitcnt lgkmcnt(7)
    v_mfma_f32_16x16x32_bf16 v[56:59], a[8:11], a[56:59], v[56:59]
    ds_read_b128 a[4:7], v3 offset:28672
    v_mfma_f32_16x16x32_bf16 v[88:91], a[8:11], a[60:63], v[88:91]
    s_waitcnt lgkmcnt(7)
    v_mfma_f32_16x16x32_bf16 v[60:63], a[12:15], a[56:59], v[60:63]
    ds_read_b128 a[8:11], v3 offset:29696
    v_mfma_f32_16x16x32_bf16 v[92:95], a[12:15], a[60:63], v[92:95]
    s_waitcnt lgkmcnt(7)
    v_mfma_f32_16x16x32_bf16 v[64:67], a[16:19], a[56:59], v[64:67]
    ds_read_b128 a[12:15], v3 offset:30720
    v_mfma_f32_16x16x32_bf16 v[96:99], a[16:19], a[60:63], v[96:99]
    s_waitcnt lgkmcnt(7)
    v_mfma_f32_16x16x32_bf16 v[68:71], a[20:23], a[56:59], v[68:71]
    ds_read_b128 a[16:19], v3 offset:31744
    v_mfma_f32_16x16x32_bf16 v[100:103], a[20:23], a[60:63], v[100:103]
    s_waitcnt lgkmcnt(7)
    v_mfma_f32_16x16x32_bf16 v[40:43], a[24:27], a[64:67], v[40:43]
    s_barrier
    ds_read_b128 a[20:23], v3 offset:32768
    v_mfma_f32_16x16x32_bf16 v[72:75], a[24:27], a[68:71], v[72:75]
    s_waitcnt lgkmcnt(7)
    v_mfma_f32_16x16x32_bf16 v[44:47], a[28:31], a[64:67], v[44:47]
    ds_read_b128 a[24:27], v3 offset:33792
    v_mfma_f32_16x16x32_bf16 v[76:79], a[28:31], a[68:71], v[76:79]
    s_waitcnt lgkmcnt(7)
    v_mfma_f32_16x16x32_bf16 v[48:51], a[32:35], a[64:67], v[48:51]
    ds_read_b128 a[28:31], v3 offset:34816
    v_mfma_f32_16x16x32_bf16 v[80:83], a[32:35], a[68:71], v[80:83]
    s_waitcnt lgkmcnt(7)
    v_mfma_f32_16x16x32_bf16 v[52:55], a[0:3], a[64:67], v[52:55]
    ds_read_b128 a[32:35], v3 offset:35840
    v_mfma_f32_16x16x32_bf16 v[84:87], a[0:3], a[68:71], v[84:87]
    s_waitcnt lgkmcnt(7)
    v_mfma_f32_16x16x32_bf16 v[56:59], a[4:7], a[64:67], v[56:59]
    ds_read_b128 a[0:3], v3 offset:36864
    v_mfma_f32_16x16x32_bf16 v[88:91], a[4:7], a[68:71], v[88:91]
    s_waitcnt lgkmcnt(7)
    v_mfma_f32_16x16x32_bf16 v[60:63], a[8:11], a[64:67], v[60:63]
    ds_read_b128 a[4:7], v3 offset:37888
    v_mfma_f32_16x16x32_bf16 v[92:95], a[8:11], a[68:71], v[92:95]
    s_waitcnt lgkmcnt(7)
    v_mfma_f32_16x16x32_bf16 v[64:67], a[12:15], a[64:67], v[64:67]
    ds_read_b128 a[8:11], v3 offset:38912
    v_mfma_f32_16x16x32_bf16 v[96:99], a[12:15], a[68:71], v[96:99]
    s_waitcnt lgkmcnt(7)
    v_mfma_f32_16x16x32_bf16 v[68:71], a[16:19], a[64:67], v[68:71]
    ds_read_b128 a[12:15], v3 offset:39936
    v_mfma_f32_16x16x32_bf16 v[100:103], a[16:19], a[68:71], v[100:103]
    s_waitcnt lgkmcnt(7)
    v_mfma_f32_16x16x32_bf16 v[40:43], a[20:23], a[72:75], v[40:43]
    ds_read_b128 a[16:19], v3 offset:40960
    v_mfma_f32_16x16x32_bf16 v[72:75], a[20:23], a[76:79], v[72:75]
    s_waitcnt lgkmcnt(7)
    v_mfma_f32_16x16x32_bf16 v[44:47], a[24:27], a[72:75], v[44:47]
    ds_read_b128 a[20:23], v3 offset:41984
    v_mfma_f32_16x16x32_bf16 v[76:79], a[24:27], a[76:79], v[76:79]
    s_waitcnt lgkmcnt(7)
    v_mfma_f32_16x16x32_bf16 v[48:51], a[28:31], a[72:75], v[48:51]
    ds_read_b128 a[24:27], v3 offset:43008
    v_mfma_f32_16x16x32_bf16 v[80:83], a[28:31], a[76:79], v[80:83]
    s_waitcnt lgkmcnt(7)
    v_mfma_f32_16x16x32_bf16 v[52:55], a[32:35], a[72:75], v[52:55]
    ds_read_b128 a[28:31], v3 offset:44032
    v_mfma_f32_16x16x32_bf16 v[84:87], a[32:35], a[76:79], v[84:87]
    s_waitcnt lgkmcnt(7)
    v_mfma_f32_16x16x32_bf16 v[56:59], a[0:3], a[72:75], v[56:59]
    ds_read_b128 a[32:35], v3 offset:45056
    v_mfma_f32_16x16x32_bf16 v[88:91], a[0:3], a[76:79], v[88:91]
    s_waitcnt lgkmcnt(7)
    v_mfma_f32_16x16x32_bf16 v[60:63], a[4:7], a[72:75], v[60:63]
    ds_read_b128 a[0:3], v3 offset:46080
    v_mfma_f32_16x16x32_bf16 v[92:95], a[4:7], a[76:79], v[92:95]
    s_waitcnt lgkmcnt(7)
    v_mfma_f32_16x16x32_bf16 v[64:67], a[8:11], a[72:75], v[64:67]
    ds_read_b128 a[4:7], v3 offset:47104
    v_mfma_f32_16x16x32_bf16 v[96:99], a[8:11], a[76:79], v[96:99]
    s_waitcnt lgkmcnt(7)
    v_mfma_f32_16x16x32_bf16 v[68:71], a[12:15], a[72:75], v[68:71]
    ds_read_b128 a[8:11], v3 offset:48128
    v_mfma_f32_16x16x32_bf16 v[100:103], a[12:15], a[76:79], v[100:103]
    s_waitcnt lgkmcnt(7)
    v_mfma_f32_16x16x32_bf16 v[40:43], a[16:19], a[80:83], v[40:43]
    s_barrier
    ds_read_b128 a[12:15], v3 offset:49152
    v_mfma_f32_16x16x32_bf16 v[72:75], a[16:19], a[84:87], v[72:75]
    s_waitcnt lgkmcnt(7)
    v_mfma_f32_16x16x32_bf16 v[44:47], a[20:23], a[80:83], v[44:47]
    ds_read_b128 a[16:19], v3 offset:50176
    v_mfma_f32_16x16x32_bf16 v[76:79], a[20:23], a[84:87], v[76:79]
    s_waitcnt lgkmcnt(7)
    v_mfma_f32_16x16x32_bf16 v[48:51], a[24:27], a[80:83], v[48:51]
    ds_read_b128 a[20:23], v3 offset:51200
    v_mfma_f32_16x16x32_bf16 v[80:83], a[24:27], a[84:87], v[80:83]
    s_waitcnt lgkmcnt(7)
    v_mfma_f32_16x16x32_bf16 v[52:55], a[28:31], a[80:83], v[52:55]
    ds_read_b128 a[24:27], v3 offset:52224
    v_mfma_f32_16x16x32_bf16 v[84:87], a[28:31], a[84:87], v[84:87]
    s_waitcnt lgkmcnt(7)
    v_mfma_f32_16x16x32_bf16 v[56:59], a[32:35], a[80:83], v[56:59]
    ds_read_b128 a[28:31], v3 offset:53248
    v_mfma_f32_16x16x32_bf16 v[88:91], a[32:35], a[84:87], v[88:91]
    s_waitcnt lgkmcnt(7)
    v_mfma_f32_16x16x32_bf16 v[60:63], a[0:3], a[80:83], v[60:63]
    ds_read_b128 a[32:35], v3 offset:54272
    v_mfma_f32_16x16x32_bf16 v[92:95], a[0:3], a[84:87], v[92:95]
    s_waitcnt lgkmcnt(7)
    v_mfma_f32_16x16x32_bf16 v[64:67], a[4:7], a[80:83], v[64:67]
    ds_read_b128 a[0:3], v3 offset:55296
    v_mfma_f32_16x16x32_bf16 v[96:99], a[4:7], a[84:87], v[96:99]
    s_waitcnt lgkmcnt(7)
    v_mfma_f32_16x16x32_bf16 v[68:71], a[8:11], a[80:83], v[68:71]
    ds_read_b128 a[4:7], v3 offset:56320
    v_mfma_f32_16x16x32_bf16 v[100:103], a[8:11], a[84:87], v[100:103]
    s_waitcnt lgkmcnt(7)
    v_mfma_f32_16x16x32_bf16 v[40:43], a[12:15], a[88:91], v[40:43]
    ds_read_b128 a[8:11], v3 offset:57344
    ds_read_b128 a[40:43], v36 offset:49152
    v_mfma_f32_16x16x32_bf16 v[72:75], a[12:15], a[92:95], v[72:75]
    s_waitcnt lgkmcnt(8)
    v_mfma_f32_16x16x32_bf16 v[44:47], a[16:19], a[88:91], v[44:47]
    ds_read_b128 a[12:15], v3 offset:58368
    ds_read_b128 a[44:47], v36 offset:51200
    v_mfma_f32_16x16x32_bf16 v[76:79], a[16:19], a[92:95], v[76:79]
    s_waitcnt lgkmcnt(9)
    v_mfma_f32_16x16x32_bf16 v[48:51], a[20:23], a[88:91], v[48:51]
    ds_read_b128 a[16:19], v3 offset:59392
    ds_read_b128 a[48:51], v37 offset:49152
    v_mfma_f32_16x16x32_bf16 v[80:83], a[20:23], a[92:95], v[80:83]
    s_waitcnt lgkmcnt(10)
    v_mfma_f32_16x16x32_bf16 v[52:55], a[24:27], a[88:91], v[52:55]
    ds_read_b128 a[20:23], v3 offset:60416
    ds_read_b128 a[52:55], v37 offset:51200
    v_mfma_f32_16x16x32_bf16 v[84:87], a[24:27], a[92:95], v[84:87]
    s_waitcnt lgkmcnt(11)
    v_mfma_f32_16x16x32_bf16 v[56:59], a[28:31], a[88:91], v[56:59]
    ds_read_b128 a[24:27], v3 offset:61440
    ds_read_b128 a[56:59], v36 offset:16384
    v_mfma_f32_16x16x32_bf16 v[88:91], a[28:31], a[92:95], v[88:91]
    s_waitcnt lgkmcnt(12)
    v_mfma_f32_16x16x32_bf16 v[60:63], a[32:35], a[88:91], v[60:63]
    ds_read_b128 a[28:31], v3 offset:62464
    ds_read_b128 a[60:63], v36 offset:18432
    v_mfma_f32_16x16x32_bf16 v[92:95], a[32:35], a[92:95], v[92:95]
    s_waitcnt lgkmcnt(12)
    v_mfma_f32_16x16x32_bf16 v[64:67], a[0:3], a[88:91], v[64:67]
    ds_read_b128 a[32:35], v3 offset:63488
    ds_read_b128 a[64:67], v37 offset:16384
    v_mfma_f32_16x16x32_bf16 v[96:99], a[0:3], a[92:95], v[96:99]
    s_waitcnt lgkmcnt(12)
    v_mfma_f32_16x16x32_bf16 v[68:71], a[4:7], a[88:91], v[68:71]
    ds_read_b128 a[0:3], v3 offset:64512
    ds_read_b128 a[68:71], v37 offset:18432
    v_mfma_f32_16x16x32_bf16 v[100:103], a[4:7], a[92:95], v[100:103]
    s_waitcnt lgkmcnt(12)
    v_mfma_f32_16x16x32_bf16 v[40:43], a[8:11], v[104:107], v[40:43]
    s_barrier
    ds_read_b128 a[4:7], v4 offset:0
    ds_read_b128 a[72:75], v36 offset:32768
    v_mfma_f32_16x16x32_bf16 v[72:75], a[8:11], v[108:111], v[72:75]
    s_waitcnt lgkmcnt(12)
    v_mfma_f32_16x16x32_bf16 v[44:47], a[12:15], v[104:107], v[44:47]
    ds_read_b128 a[8:11], v4 offset:1024
    ds_read_b128 a[76:79], v36 offset:34816
    v_mfma_f32_16x16x32_bf16 v[76:79], a[12:15], v[108:111], v[76:79]
    s_waitcnt lgkmcnt(12)
    v_mfma_f32_16x16x32_bf16 v[48:51], a[16:19], v[104:107], v[48:51]
    ds_read_b128 a[12:15], v4 offset:2048
    ds_read_b128 a[80:83], v37 offset:32768
    v_mfma_f32_16x16x32_bf16 v[80:83], a[16:19], v[108:111], v[80:83]
    s_waitcnt lgkmcnt(12)
    v_mfma_f32_16x16x32_bf16 v[52:55], a[20:23], v[104:107], v[52:55]
    ds_read_b128 a[16:19], v4 offset:3072
    ds_read_b128 a[84:87], v37 offset:34816
    v_mfma_f32_16x16x32_bf16 v[84:87], a[20:23], v[108:111], v[84:87]
    s_waitcnt lgkmcnt(12)
    v_mfma_f32_16x16x32_bf16 v[56:59], a[24:27], v[104:107], v[56:59]
    ds_read_b128 a[20:23], v4 offset:4096
    v_mfma_f32_16x16x32_bf16 v[88:91], a[24:27], v[108:111], v[88:91]
    s_waitcnt lgkmcnt(12)
    v_mfma_f32_16x16x32_bf16 v[60:63], a[28:31], v[104:107], v[60:63]
    ds_read_b128 a[24:27], v4 offset:5120
    v_mfma_f32_16x16x32_bf16 v[92:95], a[28:31], v[108:111], v[92:95]
    s_waitcnt lgkmcnt(12)
    v_mfma_f32_16x16x32_bf16 v[64:67], a[32:35], v[104:107], v[64:67]
    ds_read_b128 a[28:31], v4 offset:6144
    v_mfma_f32_16x16x32_bf16 v[96:99], a[32:35], v[108:111], v[96:99]
    s_waitcnt lgkmcnt(12)
    v_mfma_f32_16x16x32_bf16 v[68:71], a[0:3], v[104:107], v[68:71]
    ds_read_b128 a[32:35], v4 offset:7168
    v_mfma_f32_16x16x32_bf16 v[100:103], a[0:3], v[108:111], v[100:103]
    s_waitcnt lgkmcnt(11)
    v_mfma_f32_16x16x32_bf16 v[40:43], a[4:7], v[112:115], v[40:43]
    ds_read_b128 a[0:3], v4 offset:8192
    ds_read_b128 v[104:107], v13 offset:0
    v_mfma_f32_16x16x32_bf16 v[72:75], a[4:7], v[116:119], v[72:75]
    s_waitcnt lgkmcnt(11)
    v_mfma_f32_16x16x32_bf16 v[44:47], a[8:11], v[112:115], v[44:47]
    ds_read_b128 a[4:7], v4 offset:9216
    v_mfma_f32_16x16x32_bf16 v[76:79], a[8:11], v[116:119], v[76:79]
    s_waitcnt lgkmcnt(10)
    v_mfma_f32_16x16x32_bf16 v[48:51], a[12:15], v[112:115], v[48:51]
    ds_read_b128 a[8:11], v4 offset:10240
    v_mfma_f32_16x16x32_bf16 v[80:83], a[12:15], v[116:119], v[80:83]
    s_waitcnt lgkmcnt(9)
    v_mfma_f32_16x16x32_bf16 v[52:55], a[16:19], v[112:115], v[52:55]
    ds_read_b128 a[12:15], v4 offset:11264
    v_mfma_f32_16x16x32_bf16 v[84:87], a[16:19], v[116:119], v[84:87]
    s_waitcnt lgkmcnt(8)
    v_mfma_f32_16x16x32_bf16 v[56:59], a[20:23], v[112:115], v[56:59]
    ds_read_b128 a[16:19], v4 offset:12288
    ds_read_b128 v[108:111], v13 offset:256
    v_mfma_f32_16x16x32_bf16 v[88:91], a[20:23], v[116:119], v[88:91]
    s_waitcnt lgkmcnt(9)
    v_mfma_f32_16x16x32_bf16 v[60:63], a[24:27], v[112:115], v[60:63]
    ds_read_b128 a[20:23], v4 offset:13312
    v_mfma_f32_16x16x32_bf16 v[92:95], a[24:27], v[116:119], v[92:95]
    s_waitcnt lgkmcnt(9)
    v_mfma_f32_16x16x32_bf16 v[64:67], a[28:31], v[112:115], v[64:67]
    ds_read_b128 a[24:27], v4 offset:14336
    v_mfma_f32_16x16x32_bf16 v[96:99], a[28:31], v[116:119], v[96:99]
    s_waitcnt lgkmcnt(9)
    v_mfma_f32_16x16x32_bf16 v[68:71], a[32:35], v[112:115], v[68:71]
    ds_read_b128 a[28:31], v4 offset:15360
    v_mfma_f32_16x16x32_bf16 v[100:103], a[32:35], v[116:119], v[100:103]
    s_waitcnt lgkmcnt(9)
    v_mfma_f32_16x16x32_bf16 v[40:43], a[0:3], v[120:123], v[40:43]
    s_barrier
    ds_read_b128 a[32:35], v4 offset:16384
    v_mfma_f32_16x16x32_bf16 v[72:75], a[0:3], v[124:127], v[72:75]
    s_waitcnt lgkmcnt(8)
    v_mfma_f32_16x16x32_bf16 v[44:47], a[4:7], v[120:123], v[44:47]
    ds_read_b128 a[0:3], v4 offset:17408
    v_mfma_f32_16x16x32_bf16 v[76:79], a[4:7], v[124:127], v[76:79]
    s_waitcnt lgkmcnt(8)
    v_mfma_f32_16x16x32_bf16 v[48:51], a[8:11], v[120:123], v[48:51]
    ds_read_b128 a[4:7], v4 offset:18432
    v_mfma_f32_16x16x32_bf16 v[80:83], a[8:11], v[124:127], v[80:83]
    s_waitcnt lgkmcnt(8)
    v_mfma_f32_16x16x32_bf16 v[52:55], a[12:15], v[120:123], v[52:55]
    ds_read_b128 a[8:11], v4 offset:19456
    v_fmac_f32 v40, v104, v26
    v_mfma_f32_16x16x32_bf16 v[84:87], a[12:15], v[124:127], v[84:87]
    v_fmac_f32 v41, v105, v26
    s_waitcnt lgkmcnt(8)
    v_mfma_f32_16x16x32_bf16 v[56:59], a[16:19], v[120:123], v[56:59]
    ds_read_b128 a[12:15], v4 offset:20480
    v_fmac_f32 v42, v106, v26
    v_mfma_f32_16x16x32_bf16 v[88:91], a[16:19], v[124:127], v[88:91]
    v_fmac_f32 v43, v107, v26
    s_waitcnt lgkmcnt(7)
    v_mfma_f32_16x16x32_bf16 v[60:63], a[20:23], v[120:123], v[60:63]
    ds_read_b128 a[16:19], v4 offset:21504
    v_fmac_f32 v72, v104, v27
    v_mfma_f32_16x16x32_bf16 v[92:95], a[20:23], v[124:127], v[92:95]
    v_fmac_f32 v73, v105, v27
    s_waitcnt lgkmcnt(7)
    v_mfma_f32_16x16x32_bf16 v[64:67], a[24:27], v[120:123], v[64:67]
    ds_read_b128 a[20:23], v4 offset:22528
    v_fmac_f32 v74, v106, v27
    v_mfma_f32_16x16x32_bf16 v[96:99], a[24:27], v[124:127], v[96:99]
    v_fmac_f32 v75, v107, v27
    s_waitcnt lgkmcnt(7)
    v_mfma_f32_16x16x32_bf16 v[68:71], a[28:31], v[120:123], v[68:71]
    ds_read_b128 a[24:27], v4 offset:23552
    v_fmac_f32 v56, v108, v26
    v_fmac_f32 v57, v109, v26
    v_mfma_f32_16x16x32_bf16 v[100:103], a[28:31], v[124:127], v[100:103]
    ds_read_b128 v[104:107], v13 offset:320
    s_waitcnt lgkmcnt(8)
    v_mfma_f32_16x16x32_bf16 v[40:43], a[32:35], v[128:131], v[40:43]
    ds_read_b128 a[28:31], v4 offset:24576
    v_fmac_f32 v58, v110, v26
    v_mfma_f32_16x16x32_bf16 v[72:75], a[32:35], v[132:135], v[72:75]
    v_fmac_f32 v59, v111, v26
    s_waitcnt lgkmcnt(8)
    v_mfma_f32_16x16x32_bf16 v[44:47], a[0:3], v[128:131], v[44:47]
    ds_read_b128 a[32:35], v4 offset:25600
    v_fmac_f32 v88, v108, v27
    v_mfma_f32_16x16x32_bf16 v[76:79], a[0:3], v[132:135], v[76:79]
    v_fmac_f32 v89, v109, v27
    s_waitcnt lgkmcnt(8)
    v_mfma_f32_16x16x32_bf16 v[40:43], a[4:7], v[136:139], v[40:43]
    ds_read_b128 a[0:3], v4 offset:26624
    v_fmac_f32 v90, v110, v27
    v_mfma_f32_16x16x32_bf16 v[72:75], a[4:7], v[140:143], v[72:75]
    v_fmac_f32 v91, v111, v27
    s_waitcnt lgkmcnt(8)
    v_mfma_f32_16x16x32_bf16 v[44:47], a[8:11], v[136:139], v[44:47]
    ds_read_b128 a[4:7], v4 offset:27648
    ds_read_b128 v[108:111], v13 offset:128
    v_mfma_f32_16x16x32_bf16 v[76:79], a[8:11], v[140:143], v[76:79]
    s_waitcnt lgkmcnt(9)
    v_mfma_f32_16x16x32_bf16 v[40:43], a[12:15], v[144:147], v[40:43]
    ds_read_b128 a[8:11], v4 offset:28672
    v_mfma_f32_16x16x32_bf16 v[72:75], a[12:15], v[148:151], v[72:75]
    s_waitcnt lgkmcnt(9)
    v_mfma_f32_16x16x32_bf16 v[44:47], a[16:19], v[144:147], v[44:47]
    ds_read_b128 a[12:15], v4 offset:29696
    v_mfma_f32_16x16x32_bf16 v[76:79], a[16:19], v[148:151], v[76:79]
    s_waitcnt lgkmcnt(9)
    v_mfma_f32_16x16x32_bf16 v[40:43], a[20:23], v[152:155], v[40:43]
    ds_read_b128 a[16:19], v4 offset:30720
    v_mfma_f32_16x16x32_bf16 v[72:75], a[20:23], v[156:159], v[72:75]
    s_waitcnt lgkmcnt(9)
    v_mfma_f32_16x16x32_bf16 v[44:47], a[24:27], v[152:155], v[44:47]
    ds_read_b128 a[20:23], v4 offset:31744
    v_mfma_f32_16x16x32_bf16 v[76:79], a[24:27], v[156:159], v[76:79]
    s_waitcnt lgkmcnt(8)
    v_mfma_f32_16x16x32_bf16 v[40:43], a[28:31], a[40:43], v[40:43]
    s_barrier
    ds_read_b128 a[24:27], v3 offset:0
    v_mfma_f32_16x16x32_bf16 v[72:75], a[28:31], a[44:47], v[72:75]
    s_waitcnt lgkmcnt(8)
    v_mfma_f32_16x16x32_bf16 v[44:47], a[32:35], a[40:43], v[44:47]
    ds_read_b128 a[28:31], v3 offset:1024
    v_mfma_f32_16x16x32_bf16 v[76:79], a[32:35], a[44:47], v[76:79]
    s_waitcnt lgkmcnt(8)
    v_mfma_f32_16x16x32_bf16 v[40:43], a[0:3], a[48:51], v[40:43]
    ds_read_b128 a[32:35], v3 offset:2048
    v_fmac_f32 v60, v104, v26
    v_mfma_f32_16x16x32_bf16 v[72:75], a[0:3], a[52:55], v[72:75]
    v_fmac_f32 v61, v105, v26
    s_waitcnt lgkmcnt(8)
    v_mfma_f32_16x16x32_bf16 v[44:47], a[4:7], a[48:51], v[44:47]
    ds_read_b128 a[0:3], v3 offset:3072
    v_fmac_f32 v62, v106, v26
    v_mfma_f32_16x16x32_bf16 v[76:79], a[4:7], a[52:55], v[76:79]
    v_fmac_f32 v63, v107, v26
    s_waitcnt lgkmcnt(7)
    v_mfma_f32_16x16x32_bf16 v[40:43], a[8:11], a[56:59], v[40:43]
    ds_read_b128 a[4:7], v3 offset:4096
    v_fmac_f32 v92, v104, v27
    v_mfma_f32_16x16x32_bf16 v[72:75], a[8:11], a[60:63], v[72:75]
    v_fmac_f32 v93, v105, v27
    s_waitcnt lgkmcnt(7)
    v_mfma_f32_16x16x32_bf16 v[44:47], a[12:15], a[56:59], v[44:47]
    ds_read_b128 a[8:11], v3 offset:5120
    v_fmac_f32 v94, v106, v27
    v_mfma_f32_16x16x32_bf16 v[76:79], a[12:15], a[60:63], v[76:79]
    v_fmac_f32 v95, v107, v27
    s_waitcnt lgkmcnt(7)
    v_mfma_f32_16x16x32_bf16 v[40:43], a[16:19], a[64:67], v[40:43]
    ds_read_b128 a[12:15], v3 offset:6144
    v_fmac_f32 v48, v108, v26
    v_fmac_f32 v49, v109, v26
    v_mfma_f32_16x16x32_bf16 v[72:75], a[16:19], a[68:71], v[72:75]
    ds_read_b128 v[104:107], v13 offset:64
    s_waitcnt lgkmcnt(8)
    v_mfma_f32_16x16x32_bf16 v[44:47], a[20:23], a[64:67], v[44:47]
    ds_read_b128 a[16:19], v3 offset:7168
    v_fmac_f32 v50, v110, v26
    v_mfma_f32_16x16x32_bf16 v[76:79], a[20:23], a[68:71], v[76:79]
    v_fmac_f32 v51, v111, v26
    s_waitcnt lgkmcnt(8)
    v_mfma_f32_16x16x32_bf16 v[40:43], a[24:27], a[72:75], v[40:43]
    ds_read_b128 a[20:23], v3 offset:8192
    v_fmac_f32 v80, v108, v27
    v_mfma_f32_16x16x32_bf16 v[72:75], a[24:27], a[76:79], v[72:75]
    v_fmac_f32 v81, v109, v27
    s_waitcnt lgkmcnt(8)
    v_mfma_f32_16x16x32_bf16 v[44:47], a[28:31], a[72:75], v[44:47]
    ds_read_b128 a[24:27], v3 offset:9216
    v_fmac_f32 v82, v110, v27
    v_mfma_f32_16x16x32_bf16 v[76:79], a[28:31], a[76:79], v[76:79]
    v_fmac_f32 v83, v111, v27
    s_waitcnt lgkmcnt(8)
    v_mfma_f32_16x16x32_bf16 v[40:43], a[32:35], a[80:83], v[40:43]
    ds_read_b128 a[28:31], v3 offset:10240
    ds_read_b128 v[108:111], v13 offset:192
    v_mfma_f32_16x16x32_bf16 v[72:75], a[32:35], a[84:87], v[72:75]
    s_waitcnt lgkmcnt(9)
    v_mfma_f32_16x16x32_bf16 v[44:47], a[0:3], a[80:83], v[44:47]
    ds_read_b128 a[32:35], v3 offset:11264
    v_mfma_f32_16x16x32_bf16 v[76:79], a[0:3], a[84:87], v[76:79]
    s_waitcnt lgkmcnt(9)
    v_mfma_f32_16x16x32_bf16 v[56:59], a[4:7], v[128:131], v[56:59]
    ds_read_b128 a[0:3], v3 offset:12288
    v_mfma_f32_16x16x32_bf16 v[88:91], a[4:7], v[132:135], v[88:91]
    s_waitcnt lgkmcnt(9)
    v_mfma_f32_16x16x32_bf16 v[60:63], a[8:11], v[128:131], v[60:63]
    ds_read_b128 a[4:7], v3 offset:13312
    v_mfma_f32_16x16x32_bf16 v[92:95], a[8:11], v[132:135], v[92:95]
    s_waitcnt lgkmcnt(9)
    v_mfma_f32_16x16x32_bf16 v[56:59], a[12:15], v[136:139], v[56:59]
    ds_read_b128 a[8:11], v3 offset:14336
    v_mfma_f32_16x16x32_bf16 v[88:91], a[12:15], v[140:143], v[88:91]
    s_waitcnt lgkmcnt(8)
    v_mfma_f32_16x16x32_bf16 v[60:63], a[16:19], v[136:139], v[60:63]
    ds_read_b128 a[12:15], v3 offset:15360
    v_mfma_f32_16x16x32_bf16 v[92:95], a[16:19], v[140:143], v[92:95]
    s_waitcnt lgkmcnt(8)
    v_mfma_f32_16x16x32_bf16 v[56:59], a[20:23], v[144:147], v[56:59]
    s_barrier
    ds_read_b128 a[16:19], v3 offset:16384
    v_mfma_f32_16x16x32_bf16 v[88:91], a[20:23], v[148:151], v[88:91]
    s_waitcnt lgkmcnt(8)
    v_mfma_f32_16x16x32_bf16 v[60:63], a[24:27], v[144:147], v[60:63]
    ds_read_b128 a[20:23], v3 offset:17408
    v_fmac_f32 v44, v104, v26
    v_mfma_f32_16x16x32_bf16 v[92:95], a[24:27], v[148:151], v[92:95]
    v_fmac_f32 v45, v105, v26
    s_waitcnt lgkmcnt(8)
    v_mfma_f32_16x16x32_bf16 v[56:59], a[28:31], v[152:155], v[56:59]
    ds_read_b128 a[24:27], v3 offset:18432
    v_fmac_f32 v46, v106, v26
    v_mfma_f32_16x16x32_bf16 v[88:91], a[28:31], v[156:159], v[88:91]
    v_fmac_f32 v47, v107, v26
    s_waitcnt lgkmcnt(7)
    v_mfma_f32_16x16x32_bf16 v[60:63], a[32:35], v[152:155], v[60:63]
    ds_read_b128 a[28:31], v3 offset:19456
    v_fmac_f32 v76, v104, v27
    v_mfma_f32_16x16x32_bf16 v[92:95], a[32:35], v[156:159], v[92:95]
    v_fmac_f32 v77, v105, v27
    s_waitcnt lgkmcnt(7)
    v_mfma_f32_16x16x32_bf16 v[56:59], a[0:3], a[40:43], v[56:59]
    ds_read_b128 a[32:35], v3 offset:20480
    v_fmac_f32 v78, v106, v27
    v_mfma_f32_16x16x32_bf16 v[88:91], a[0:3], a[44:47], v[88:91]
    v_fmac_f32 v79, v107, v27
    s_waitcnt lgkmcnt(7)
    v_mfma_f32_16x16x32_bf16 v[60:63], a[4:7], a[40:43], v[60:63]
    ds_read_b128 a[0:3], v3 offset:21504
    v_fmac_f32 v52, v108, v26
    v_fmac_f32 v53, v109, v26
    v_mfma_f32_16x16x32_bf16 v[92:95], a[4:7], a[44:47], v[92:95]
    ds_read_b128 v[104:107], v13 offset:384
    s_waitcnt lgkmcnt(8)
    v_mfma_f32_16x16x32_bf16 v[56:59], a[8:11], a[48:51], v[56:59]
    ds_read_b128 a[4:7], v3 offset:22528
    v_fmac_f32 v54, v110, v26
    v_fmac_f32 v55, v111, v26
    v_mfma_f32_16x16x32_bf16 v[88:91], a[8:11], a[52:55], v[88:91]
    v_mul_f32 v40, v40, v30
    s_waitcnt lgkmcnt(8)
    v_mfma_f32_16x16x32_bf16 v[60:63], a[12:15], a[48:51], v[60:63]
    ds_read_b128 a[8:11], v3 offset:23552
    v_fmac_f32 v84, v108, v27
    v_fmac_f32 v85, v109, v27
    v_mfma_f32_16x16x32_bf16 v[92:95], a[12:15], a[52:55], v[92:95]
    v_mul_f32 v41, v41, v30
    s_waitcnt lgkmcnt(8)
    v_mfma_f32_16x16x32_bf16 v[56:59], a[16:19], a[56:59], v[56:59]
    ds_read_b128 a[12:15], v3 offset:24576
    v_fmac_f32 v86, v110, v27
    v_fmac_f32 v87, v111, v27
    v_mfma_f32_16x16x32_bf16 v[88:91], a[16:19], a[60:63], v[88:91]
    v_mul_f32 v42, v42, v30
    s_waitcnt lgkmcnt(8)
    v_mfma_f32_16x16x32_bf16 v[60:63], a[20:23], a[56:59], v[60:63]
    ds_read_b128 a[16:19], v3 offset:25600
    ds_read_b128 v[108:111], v13 offset:448
    v_mul_f32 v43, v43, v30
    v_mfma_f32_16x16x32_bf16 v[92:95], a[20:23], a[60:63], v[92:95]
    v_mul_f32 v44, v44, v30
    s_waitcnt lgkmcnt(9)
    v_mfma_f32_16x16x32_bf16 v[56:59], a[24:27], a[64:67], v[56:59]
    ds_read_b128 a[20:23], v3 offset:26624
    v_mul_f32 v45, v45, v30
    v_mul_f32 v46, v46, v30
    v_mfma_f32_16x16x32_bf16 v[88:91], a[24:27], a[68:71], v[88:91]
    v_mul_f32 v47, v47, v30
    s_waitcnt lgkmcnt(9)
    v_mfma_f32_16x16x32_bf16 v[60:63], a[28:31], a[64:67], v[60:63]
    ds_read_b128 a[24:27], v3 offset:27648
    v_cvt_pk_bf16_f32 v40, v40, v41
    v_cvt_pk_bf16_f32 v41, v42, v43
    v_mfma_f32_16x16x32_bf16 v[92:95], a[28:31], a[68:71], v[92:95]
    v_cvt_pk_bf16_f32 v42, v44, v45
    s_waitcnt lgkmcnt(9)
    v_mfma_f32_16x16x32_bf16 v[56:59], a[32:35], a[72:75], v[56:59]
    ds_read_b128 a[28:31], v3 offset:28672
    v_cvt_pk_bf16_f32 v43, v46, v47
    buffer_store_dwordx4 v[40:43], v14, s[4:7], s18 offen offset:0 sc1
    v_mfma_f32_16x16x32_bf16 v[88:91], a[32:35], a[76:79], v[88:91]
    v_mul_f32 v72, v72, v32
    s_waitcnt lgkmcnt(9)
    v_mfma_f32_16x16x32_bf16 v[60:63], a[0:3], a[72:75], v[60:63]
    ds_read_b128 a[32:35], v3 offset:29696
    v_mul_f32 v73, v73, v32
    v_mul_f32 v74, v74, v32
    v_mfma_f32_16x16x32_bf16 v[92:95], a[0:3], a[76:79], v[92:95]
    v_mul_f32 v75, v75, v32
    s_waitcnt lgkmcnt(8)
    v_mfma_f32_16x16x32_bf16 v[56:59], a[4:7], a[80:83], v[56:59]
    ds_read_b128 a[0:3], v3 offset:30720
    v_mul_f32 v76, v76, v32
    v_mul_f32 v77, v77, v32
    v_mfma_f32_16x16x32_bf16 v[88:91], a[4:7], a[84:87], v[88:91]
    v_mul_f32 v78, v78, v32
    s_waitcnt lgkmcnt(8)
    v_mfma_f32_16x16x32_bf16 v[60:63], a[8:11], a[80:83], v[60:63]
    ds_read_b128 a[4:7], v3 offset:31744
    v_mul_f32 v79, v79, v32
    v_cvt_pk_bf16_f32 v72, v72, v73
    v_mfma_f32_16x16x32_bf16 v[92:95], a[8:11], a[84:87], v[92:95]
    v_cvt_pk_bf16_f32 v73, v74, v75
    s_waitcnt lgkmcnt(8)
    v_mfma_f32_16x16x32_bf16 v[48:51], a[12:15], v[128:131], v[48:51]
    s_barrier
    ds_read_b128 a[8:11], v3 offset:32768
    v_fmac_f32 v64, v104, v26
    v_fmac_f32 v65, v105, v26
    v_mfma_f32_16x16x32_bf16 v[80:83], a[12:15], v[132:135], v[80:83]
    v_cvt_pk_bf16_f32 v74, v76, v77
    s_waitcnt lgkmcnt(8)
    v_mfma_f32_16x16x32_bf16 v[52:55], a[16:19], v[128:131], v[52:55]
    ds_read_b128 a[12:15], v3 offset:33792
    v_fmac_f32 v66, v106, v26
    v_fmac_f32 v67, v107, v26
    v_mfma_f32_16x16x32_bf16 v[84:87], a[16:19], v[132:135], v[84:87]
    v_cvt_pk_bf16_f32 v75, v78, v79
    s_waitcnt lgkmcnt(7)
    v_mfma_f32_16x16x32_bf16 v[48:51], a[20:23], v[136:139], v[48:51]
    ds_read_b128 a[16:19], v3 offset:34816
    v_fmac_f32 v96, v104, v27
    v_fmac_f32 v97, v105, v27
    v_mfma_f32_16x16x32_bf16 v[80:83], a[20:23], v[140:143], v[80:83]
    buffer_store_dwordx4 v[72:75], v14, s[4:7], s18 offen offset:256 sc1
    s_waitcnt lgkmcnt(7)
    v_mfma_f32_16x16x32_bf16 v[52:55], a[24:27], v[136:139], v[52:55]
    ds_read_b128 a[20:23], v3 offset:35840
    v_fmac_f32 v98, v106, v27
    v_fmac_f32 v99, v107, v27
    v_mfma_f32_16x16x32_bf16 v[84:87], a[24:27], v[140:143], v[84:87]
    v_mul_f32 v56, v56, v30
    s_waitcnt lgkmcnt(7)
    v_mfma_f32_16x16x32_bf16 v[48:51], a[28:31], v[144:147], v[48:51]
    ds_read_b128 a[24:27], v3 offset:36864
    v_fmac_f32 v68, v108, v26
    v_fmac_f32 v69, v109, v26
    v_mfma_f32_16x16x32_bf16 v[80:83], a[28:31], v[148:151], v[80:83]
    v_mul_f32 v57, v57, v30
    s_waitcnt lgkmcnt(7)
    v_mfma_f32_16x16x32_bf16 v[52:55], a[32:35], v[144:147], v[52:55]
    ds_read_b128 a[28:31], v3 offset:37888
    v_fmac_f32 v70, v110, v26
    v_fmac_f32 v71, v111, v26
    v_mfma_f32_16x16x32_bf16 v[84:87], a[32:35], v[148:151], v[84:87]
    v_mul_f32 v58, v58, v30
    s_waitcnt lgkmcnt(7)
    v_mfma_f32_16x16x32_bf16 v[48:51], a[0:3], v[152:155], v[48:51]
    ds_read_b128 a[32:35], v3 offset:38912
    v_fmac_f32 v100, v108, v27
    v_fmac_f32 v101, v109, v27
    v_mfma_f32_16x16x32_bf16 v[80:83], a[0:3], v[156:159], v[80:83]
    v_mul_f32 v59, v59, v30
    s_waitcnt lgkmcnt(7)
    v_mfma_f32_16x16x32_bf16 v[52:55], a[4:7], v[152:155], v[52:55]
    ds_read_b128 a[0:3], v3 offset:39936
    v_fmac_f32 v102, v110, v27
    v_fmac_f32 v103, v111, v27
    v_mfma_f32_16x16x32_bf16 v[84:87], a[4:7], v[156:159], v[84:87]
    v_mul_f32 v60, v60, v30
    s_waitcnt lgkmcnt(7)
    v_mfma_f32_16x16x32_bf16 v[48:51], a[8:11], a[40:43], v[48:51]
    ds_read_b128 a[4:7], v3 offset:40960
    v_mul_f32 v61, v61, v30
    v_mul_f32 v62, v62, v30
    v_mfma_f32_16x16x32_bf16 v[80:83], a[8:11], a[44:47], v[80:83]
    v_mul_f32 v63, v63, v30
    s_waitcnt lgkmcnt(7)
    v_mfma_f32_16x16x32_bf16 v[52:55], a[12:15], a[40:43], v[52:55]
    ds_read_b128 a[8:11], v3 offset:41984
    v_cvt_pk_bf16_f32 v56, v56, v57
    v_cvt_pk_bf16_f32 v57, v58, v59
    v_mfma_f32_16x16x32_bf16 v[84:87], a[12:15], a[44:47], v[84:87]
    v_cvt_pk_bf16_f32 v58, v60, v61
    s_waitcnt lgkmcnt(7)
    v_mfma_f32_16x16x32_bf16 v[48:51], a[16:19], a[48:51], v[48:51]
    ds_read_b128 a[12:15], v3 offset:43008
    v_cvt_pk_bf16_f32 v59, v62, v63
    buffer_store_dwordx4 v[56:59], v15, s[4:7], s18 offen offset:0 sc1
    v_mfma_f32_16x16x32_bf16 v[80:83], a[16:19], a[52:55], v[80:83]
    v_mul_f32 v88, v88, v32
    s_waitcnt lgkmcnt(7)
    v_mfma_f32_16x16x32_bf16 v[52:55], a[20:23], a[48:51], v[52:55]
    ds_read_b128 a[16:19], v3 offset:44032
    v_mul_f32 v89, v89, v32
    v_mul_f32 v90, v90, v32
    v_mfma_f32_16x16x32_bf16 v[84:87], a[20:23], a[52:55], v[84:87]
    v_mul_f32 v91, v91, v32
    s_waitcnt lgkmcnt(7)
    v_mfma_f32_16x16x32_bf16 v[48:51], a[24:27], a[56:59], v[48:51]
    ds_read_b128 a[20:23], v3 offset:45056
    v_mul_f32 v92, v92, v32
    v_mul_f32 v93, v93, v32
    v_mfma_f32_16x16x32_bf16 v[80:83], a[24:27], a[60:63], v[80:83]
    v_mul_f32 v94, v94, v32
    s_waitcnt lgkmcnt(7)
    v_mfma_f32_16x16x32_bf16 v[52:55], a[28:31], a[56:59], v[52:55]
    ds_read_b128 a[24:27], v3 offset:46080
    v_mul_f32 v95, v95, v32
    v_cvt_pk_bf16_f32 v88, v88, v89
    v_mfma_f32_16x16x32_bf16 v[84:87], a[28:31], a[60:63], v[84:87]
    v_cvt_pk_bf16_f32 v89, v90, v91
    s_waitcnt lgkmcnt(7)
    v_mfma_f32_16x16x32_bf16 v[48:51], a[32:35], a[64:67], v[48:51]
    ds_read_b128 a[28:31], v3 offset:47104
    v_cvt_pk_bf16_f32 v90, v92, v93
    v_cvt_pk_bf16_f32 v91, v94, v95
    v_mfma_f32_16x16x32_bf16 v[80:83], a[32:35], a[68:71], v[80:83]
    buffer_store_dwordx4 v[88:91], v15, s[4:7], s18 offen offset:256 sc1
    s_waitcnt lgkmcnt(7)
    v_mfma_f32_16x16x32_bf16 v[52:55], a[0:3], a[64:67], v[52:55]
    ds_read_b128 a[32:35], v3 offset:48128
    v_mfma_f32_16x16x32_bf16 v[84:87], a[0:3], a[68:71], v[84:87]
    s_waitcnt lgkmcnt(7)
    v_mfma_f32_16x16x32_bf16 v[48:51], a[4:7], a[72:75], v[48:51]
    s_barrier
    ds_read_b128 a[0:3], v3 offset:49152
    v_mfma_f32_16x16x32_bf16 v[80:83], a[4:7], a[76:79], v[80:83]
    s_waitcnt lgkmcnt(7)
    v_mfma_f32_16x16x32_bf16 v[52:55], a[8:11], a[72:75], v[52:55]
    ds_read_b128 a[4:7], v3 offset:50176
    v_mfma_f32_16x16x32_bf16 v[84:87], a[8:11], a[76:79], v[84:87]
    s_waitcnt lgkmcnt(7)
    v_mfma_f32_16x16x32_bf16 v[48:51], a[12:15], a[80:83], v[48:51]
    ds_read_b128 a[8:11], v3 offset:51200
    v_mfma_f32_16x16x32_bf16 v[80:83], a[12:15], a[84:87], v[80:83]
    s_waitcnt lgkmcnt(7)
    v_mfma_f32_16x16x32_bf16 v[52:55], a[16:19], a[80:83], v[52:55]
    ds_read_b128 a[12:15], v3 offset:52224
    v_mfma_f32_16x16x32_bf16 v[84:87], a[16:19], a[84:87], v[84:87]
    s_waitcnt lgkmcnt(7)
    v_mfma_f32_16x16x32_bf16 v[64:67], a[20:23], v[128:131], v[64:67]
    ds_read_b128 a[16:19], v3 offset:53248
    v_mfma_f32_16x16x32_bf16 v[96:99], a[20:23], v[132:135], v[96:99]
    s_waitcnt lgkmcnt(7)
    v_mfma_f32_16x16x32_bf16 v[68:71], a[24:27], v[128:131], v[68:71]
    ds_read_b128 a[20:23], v3 offset:54272
    v_mfma_f32_16x16x32_bf16 v[100:103], a[24:27], v[132:135], v[100:103]
    s_waitcnt lgkmcnt(7)
    v_mfma_f32_16x16x32_bf16 v[64:67], a[28:31], v[136:139], v[64:67]
    ds_read_b128 a[24:27], v3 offset:55296
    v_mul_f32 v48, v48, v31
    v_mul_f32 v49, v49, v31
    v_mfma_f32_16x16x32_bf16 v[96:99], a[28:31], v[140:143], v[96:99]
    v_mul_f32 v50, v50, v31
    s_waitcnt lgkmcnt(7)
    v_mfma_f32_16x16x32_bf16 v[68:71], a[32:35], v[136:139], v[68:71]
    ds_read_b128 a[28:31], v3 offset:56320
    v_mul_f32 v51, v51, v31
    v_mul_f32 v52, v52, v31
    v_mfma_f32_16x16x32_bf16 v[100:103], a[32:35], v[140:143], v[100:103]
    v_mul_f32 v53, v53, v31
    s_waitcnt lgkmcnt(7)
    v_mfma_f32_16x16x32_bf16 v[64:67], a[0:3], v[144:147], v[64:67]
    ds_read_b128 a[32:35], v3 offset:57344
    v_mul_f32 v54, v54, v31
    v_mul_f32 v55, v55, v31
    v_mfma_f32_16x16x32_bf16 v[96:99], a[0:3], v[148:151], v[96:99]
    v_cvt_pk_bf16_f32 v48, v48, v49
    s_waitcnt lgkmcnt(7)
    v_mfma_f32_16x16x32_bf16 v[68:71], a[4:7], v[144:147], v[68:71]
    ds_read_b128 a[0:3], v3 offset:58368
    v_cvt_pk_bf16_f32 v49, v50, v51
    v_cvt_pk_bf16_f32 v50, v52, v53
    v_mfma_f32_16x16x32_bf16 v[100:103], a[4:7], v[148:151], v[100:103]
    v_cvt_pk_bf16_f32 v51, v54, v55
    s_waitcnt lgkmcnt(7)
    v_mfma_f32_16x16x32_bf16 v[64:67], a[8:11], v[152:155], v[64:67]
    ds_read_b128 a[4:7], v3 offset:59392
    v_cndmask_b32 v50, v50, v12, s[38:39]
    v_cndmask_b32 v51, v51, 0, s[38:39]
    v_mfma_f32_16x16x32_bf16 v[96:99], a[8:11], v[156:159], v[96:99]
    buffer_store_dwordx4 v[48:51], v6, s[4:7], s26 offen offset:0 sc1
    s_waitcnt lgkmcnt(7)
    v_mfma_f32_16x16x32_bf16 v[68:71], a[12:15], v[152:155], v[68:71]
    ds_read_b128 a[8:11], v3 offset:60416
    v_mul_f32 v80, v80, v33
    v_mul_f32 v81, v81, v33
    v_mfma_f32_16x16x32_bf16 v[100:103], a[12:15], v[156:159], v[100:103]
    v_mul_f32 v82, v82, v33
    s_waitcnt lgkmcnt(7)
    v_mfma_f32_16x16x32_bf16 v[64:67], a[16:19], a[40:43], v[64:67]
    ds_read_b128 a[12:15], v3 offset:61440
    v_mul_f32 v83, v83, v33
    v_mul_f32 v84, v84, v33
    v_mfma_f32_16x16x32_bf16 v[96:99], a[16:19], a[44:47], v[96:99]
    v_mul_f32 v85, v85, v33
    s_waitcnt lgkmcnt(7)
    v_mfma_f32_16x16x32_bf16 v[68:71], a[20:23], a[40:43], v[68:71]
    ds_read_b128 a[16:19], v3 offset:62464
    v_mul_f32 v86, v86, v33
    v_mul_f32 v87, v87, v33
    v_mfma_f32_16x16x32_bf16 v[100:103], a[20:23], a[44:47], v[100:103]
    v_cvt_pk_bf16_f32 v80, v80, v81
    s_waitcnt lgkmcnt(7)
    v_mfma_f32_16x16x32_bf16 v[64:67], a[24:27], a[48:51], v[64:67]
    ds_read_b128 a[20:23], v3 offset:63488
    v_cvt_pk_bf16_f32 v81, v82, v83
    v_cvt_pk_bf16_f32 v82, v84, v85
    v_mfma_f32_16x16x32_bf16 v[96:99], a[24:27], a[52:55], v[96:99]
    v_cvt_pk_bf16_f32 v83, v86, v87
    s_waitcnt lgkmcnt(7)
    v_mfma_f32_16x16x32_bf16 v[68:71], a[28:31], a[48:51], v[68:71]
    ds_read_b128 a[24:27], v3 offset:64512
    v_cndmask_b32 v82, v82, v12, s[38:39]
    v_cndmask_b32 v83, v83, 0, s[38:39]
    v_mfma_f32_16x16x32_bf16 v[100:103], a[28:31], a[52:55], v[100:103]
    buffer_store_dwordx4 v[80:83], v6, s[4:7], s26 offen offset:256 sc1
    s_waitcnt lgkmcnt(7)
    v_mfma_f32_16x16x32_bf16 v[64:67], a[32:35], a[56:59], v[64:67]
    v_mfma_f32_16x16x32_bf16 v[96:99], a[32:35], a[60:63], v[96:99]
    s_waitcnt lgkmcnt(6)
    v_mfma_f32_16x16x32_bf16 v[68:71], a[0:3], a[56:59], v[68:71]
    v_mfma_f32_16x16x32_bf16 v[100:103], a[0:3], a[60:63], v[100:103]
    s_waitcnt lgkmcnt(5)
    v_mfma_f32_16x16x32_bf16 v[64:67], a[4:7], a[64:67], v[64:67]
    v_mfma_f32_16x16x32_bf16 v[96:99], a[4:7], a[68:71], v[96:99]
    s_waitcnt lgkmcnt(4)
    v_mfma_f32_16x16x32_bf16 v[68:71], a[8:11], a[64:67], v[68:71]
    v_mfma_f32_16x16x32_bf16 v[100:103], a[8:11], a[68:71], v[100:103]
    s_waitcnt lgkmcnt(3)
    v_mfma_f32_16x16x32_bf16 v[64:67], a[12:15], a[72:75], v[64:67]
    v_mfma_f32_16x16x32_bf16 v[96:99], a[12:15], a[76:79], v[96:99]
    s_waitcnt lgkmcnt(2)
    v_mfma_f32_16x16x32_bf16 v[68:71], a[16:19], a[72:75], v[68:71]
    v_mfma_f32_16x16x32_bf16 v[100:103], a[16:19], a[76:79], v[100:103]
    s_waitcnt lgkmcnt(1)
    v_mfma_f32_16x16x32_bf16 v[64:67], a[20:23], a[80:83], v[64:67]
    v_mfma_f32_16x16x32_bf16 v[96:99], a[20:23], a[84:87], v[96:99]
    s_waitcnt lgkmcnt(0)
    v_mfma_f32_16x16x32_bf16 v[68:71], a[24:27], a[80:83], v[68:71]
    v_mfma_f32_16x16x32_bf16 v[100:103], a[24:27], a[84:87], v[100:103]
    s_waitcnt vmcnt(2)
    s_barrier
    s_nop 7
    v_mul_f32 v64, v64, v31
    v_mul_f32 v65, v65, v31
    v_mul_f32 v66, v66, v31
    v_mul_f32 v67, v67, v31
    v_mul_f32 v68, v68, v31
    v_mul_f32 v69, v69, v31
    v_mul_f32 v70, v70, v31
    v_mul_f32 v71, v71, v31
    v_cvt_pk_bf16_f32 v64, v64, v65
    v_cvt_pk_bf16_f32 v65, v66, v67
    v_cvt_pk_bf16_f32 v66, v68, v69
    v_cvt_pk_bf16_f32 v67, v70, v71
    v_cndmask_b32 v66, v66, v12, s[38:39]
    v_cndmask_b32 v67, v67, 0, s[38:39]
    buffer_store_dwordx4 v[64:67], v6, s[4:7], s27 offen offset:0 sc1
    v_mul_f32 v96, v96, v33
    v_mul_f32 v97, v97, v33
    v_mul_f32 v98, v98, v33
    v_mul_f32 v99, v99, v33
    v_mul_f32 v100, v100, v33
    v_mul_f32 v101, v101, v33
    v_mul_f32 v102, v102, v33
    v_mul_f32 v103, v103, v33
    v_cvt_pk_bf16_f32 v96, v96, v97
    v_cvt_pk_bf16_f32 v97, v98, v99
    v_cvt_pk_bf16_f32 v98, v100, v101
    v_cvt_pk_bf16_f32 v99, v102, v103
    v_cndmask_b32 v98, v98, v12, s[38:39]
    v_cndmask_b32 v99, v99, 0, s[38:39]
    buffer_store_dwordx4 v[96:99], v6, s[4:7], s27 offen offset:256 sc1
    s_branch L_qkv_sig
L_mega_kernel_att_2:
    s_setprio 1
    s_lshr_b32 s24, s22, 2
    s_lshl_b32 s25, s17, 3
    s_lshl_b32 s26, s23, 1
    s_add_u32 s25, s25, s26
    s_add_u32 s25, s25, s24
    s_lshl_b32 s26, s16, 6
    s_add_u32 s27, s26, s25
    s_lshl_b32 s20, s27, 10
    s_add_u32 s20, s20, s18
    s_add_u32 s20, s20, 2752512
    s_mul_i32 s21, s27, 3072
    s_add_u32 s21, s21, s18
    s_add_u32 s21, s21, 4852224
    s_cmp_eq_u32 s24, 0
    s_cselect_b32 s62, 1, -1
    s_mul_i32 s62, s62, 3072
    s_add_u32 s62, s62, s21
    s_xor_b32 s63, s20, 1024
    s_mul_i32 s26, s26, 3072
    s_add_u32 s26, s26, s18
    s_add_u32 s26, s26, 4849664
    s_mul_i32 s28, s24, 98304
    s_add_u32 s28, s28, s26
    s_add_u32 s28, s28, s31
    s_mul_i32 s27, s24, 73728
    s_add_u32 s29, s27, s31
    v_and_b32 v10, 31, v1
    v_lshrrev_b32 v11, 5, v1
    v_lshlrev_b32 v12, 4, v10
    v_lshlrev_b32 v32, 9, v11
    v_sub_u32 v32, 2568, v32
    v_add_u32 v32, v32, v12
    v_bfe_u32 v13, v1, 2, 2
    v_lshl_add_u32 v13, v11, 2, v13
    v_lshlrev_b32 v13, 4, v13
    v_and_b32 v14, 1, v1
    v_lshlrev_b32 v14, 9, v14
    v_bfe_u32 v15, v1, 1, 1
    v_lshl_add_u32 v14, v15, 3, v14
    v_and_b32 v15, 3, v1
    v_min_u32 v15, 1, v15
    v_lshlrev_b32 v15, 3, v15
    v_add_u32 v15, 1024, v15
    v_cndmask_b32 v14, v15, v14, s[36:37]
    v_add3_u32 v33, v13, v14, 64
    v_add_u32 v33, 960, v33
    v_add_u32 v26, s27, v3
    v_add_u32 v28, s27, v32
    v_add_u32 v30, s27, v33
    v_add_u32 v27, 36864, v26
    v_add_u32 v29, 36864, v28
    v_add_u32 v31, 36864, v30
    v_mov_b32 v124, 0
    v_mov_b32 v125, 0
    v_mov_b32 v130, 0
    v_mov_b32 v131, 0
    v_lshlrev_b32 v36, 11, v7
    s_or_b32 s55, s22, s19
    s_lshl_b32 s50, s13, 11
    s_add_u32 s50, s50, s18
    s_add_u32 s50, s50, 23887872
    v_lshlrev_b32 v10, 7, v1
    v_mov_b32 v11, 1
    s_mov_b32 s45, s22
    s_waitcnt vmcnt(0)
    s_barrier
    s_cmp_lg_u32 s22, 5
    s_cbranch_scc1 L_mega_kernel_es_27
    s_mov_b64 exec, 0xffff
    buffer_atomic_add v11, v10, s[4:7], s50 offen sc1
    s_mov_b64 exec, -1
L_mega_kernel_es_27:
    s_cmp_lg_u32 s22, 4
    s_cbranch_scc1 L_mega_kernel_eq_28
    s_lshl_b32 s53, s16, 3
    s_add_u32 s53, s53, s17
    s_lshl_b32 s50, s53, 7
    s_add_u32 s50, s50, s18
    s_add_u32 s50, s50, 23920704
    s_add_u32 s53, s3, 16
    s_mov_b32 s52, 0x400000
L_mega_kernel_sp_29:
    s_buffer_load_dword s51, s[4:7], s50 glc
    s_sub_u32 s52, s52, 1
    s_waitcnt lgkmcnt(0)
    s_cmp_lg_u32 s51, s53
    s_cbranch_scc0 L_mega_kernel_po_31
    s_and_b32 s51, s52, 31
    s_cbranch_scc1 L_mega_kernel_sp_29
    buffer_load_dword v9, off, s[4:7], s50 sc1
    s_cmp_eq_u32 s52, 0
    s_cbranch_scc1 L_mega_kernel_po_31
    s_waitcnt vmcnt(0)
    v_readfirstlane_b32 s51, v9
    s_cmp_lg_u32 s51, s53
    s_cbranch_scc1 L_mega_kernel_sp_29
L_mega_kernel_po_31:
L_mega_kernel_eq_28:
    s_barrier
    buffer_load_dwordx4 v[132:135], v3, s[4:7], s26 offen sc1
    buffer_load_dwordx4 v[120:123], v3, s[4:7], s63 offen sc1
    buffer_load_dwordx4 v[126:129], v3, s[4:7], s20 offen sc1
    s_cmp_lg_u32 s45, 0
    s_cbranch_scc1 L_mega_kernel_polls_32
    s_lshl_b32 s53, s16, 3
    s_add_u32 s53, s53, s17
    s_lshl_b32 s50, s53, 7
    s_add_u32 s50, s50, s18
    s_add_u32 s50, s50, 23887872
    s_add_u32 s53, s3, 16
    s_mov_b32 s52, 0x400000
L_mega_kernel_sp_33:
    s_buffer_load_dword s51, s[4:7], s50 glc
    s_sub_u32 s52, s52, 1
    s_waitcnt lgkmcnt(0)
    s_cmp_lg_u32 s51, s53
    s_cbranch_scc0 L_mega_kernel_po_35
    s_and_b32 s51, s52, 31
    s_cbranch_scc1 L_mega_kernel_sp_33
    buffer_load_dword v9, off, s[4:7], s50 sc1
    s_cmp_eq_u32 s52, 0
    s_cbranch_scc1 L_mega_kernel_po_35
    s_waitcnt vmcnt(0)
    v_readfirstlane_b32 s51, v9
    s_cmp_lg_u32 s51, s53
    s_cbranch_scc1 L_mega_kernel_sp_33
L_mega_kernel_po_35:
L_mega_kernel_polls_32:
    s_barrier
    s_add_u32 m0, s29, 0
    s_nop 0
    buffer_load_dwordx4 v3, s[4:7], s28 offen sc1 lds
    s_add_u32 s28, s28, 4096
    s_add_u32 m0, s29, 4096
    s_nop 0
    buffer_load_dwordx4 v3, s[4:7], s28 offen sc1 lds
    s_add_u32 s28, s28, 4096
    s_mov_b64 exec, s[32:33]
    buffer_load_dwordx2 v[124:125], v12, s[4:7], s62 offen sc1
    buffer_load_dwordx2 v[130:131], v12, s[4:7], s21 offen sc1
    s_mov_b64 exec, -1
    s_setprio 0
    s_add_u32 m0, s29, 8192
    s_nop 0
    buffer_load_dwordx4 v3, s[4:7], s28 offen sc1 lds
    s_add_u32 s28, s28, 4096
    s_waitcnt vmcnt(5)
    v_mfma_f32_32x32x16_bf16 v[40:55], v[132:135], v[120:123], 0
    v_mfma_f32_32x32x16_bf16 v[56:71], v[132:135], v[126:129], 0
    s_nop 10
    v_max3_f32 v104, v40, v41, v42
    v_max3_f32 v104, v104, v43, v44
    v_max3_f32 v104, v104, v45, v46
    v_max3_f32 v104, v104, v47, v48
    v_max3_f32 v104, v104, v49, v50
    v_max3_f32 v104, v104, v51, v52
    v_max3_f32 v104, v104, v53, v54
    v_max_f32 v104, v104, v55
    v_mov_b32 v105, v104
    s_nop 1
    v_permlane32_swap_b32 v105, v104
    s_nop 0
    v_max_f32 v104, v104, v105
    v_sub_f32 v104, 0, v104
    v_max3_f32 v112, v56, v57, v58
    v_max3_f32 v112, v112, v59, v60
    v_max3_f32 v112, v112, v61, v62
    v_max3_f32 v112, v112, v63, v64
    v_max3_f32 v112, v112, v65, v66
    v_max3_f32 v112, v112, v67, v68
    v_max3_f32 v112, v112, v69, v70
    v_max_f32 v112, v112, v71
    v_mov_b32 v113, v112
    s_nop 1
    v_permlane32_swap_b32 v113, v112
    s_nop 0
    v_max_f32 v112, v112, v113
    v_sub_f32 v112, 0, v112
    s_waitcnt vmcnt(1)
    s_mov_b64 exec, s[34:35]
    v_lshrrev_b32 v124, 16, v104
    v_lshrrev_b32 v130, 16, v112
    s_mov_b64 exec, -1
    s_waitcnt vmcnt(1)
    s_barrier
    s_setprio 1
    ds_read_b64 v[136:137], v28 offset:0
    ds_read_b128 v[132:135], v26 offset:0
    ds_read_b64_tr_b16 v[144:145], v30 offset:0
    ds_read_b64_tr_b16 v[146:147], v30 offset:128
    ds_read_b64_tr_b16 v[148:149], v30 offset:256
    ds_read_b64_tr_b16 v[150:151], v30 offset:384
    ds_read_b64 v[142:143], v28 offset:3072
    ds_read_b128 v[138:141], v26 offset:3072
    s_waitcnt lgkmcnt(6)
    v_mfma_f32_32x32x16_bf16 v[40:55], v[132:135], v[120:123], 0
    v_mfma_f32_32x32x8_bf16 v[40:55], v[136:137], v[124:125], v[40:55]
    s_nop 11
    v_mfma_f32_32x32x16_bf16 v[56:71], v[132:135], v[126:129], 0
    ds_read_b64_tr_b16 v[152:153], v30 offset:3072
    v_exp_f32 v40, v40
    v_exp_f32 v41, v41
    v_exp_f32 v42, v42
    v_exp_f32 v43, v43
    v_cvt_pk_bf16_f32 v104, v40, v41
    v_exp_f32 v44, v44
    v_mfma_f32_32x32x8_bf16 v[56:71], v[136:137], v[130:131], v[56:71]
    ds_read_b64_tr_b16 v[154:155], v30 offset:3200
    s_add_u32 m0, s29, 12288
    s_nop 0
    buffer_load_dwordx4 v3, s[4:7], s28 offen sc1 lds
    s_add_u32 s28, s28, 4096
    v_exp_f32 v45, v45
    v_cvt_pk_bf16_f32 v105, v42, v43
    v_exp_f32 v46, v46
    v_exp_f32 v47, v47
    v_cvt_pk_bf16_f32 v106, v44, v45
    v_exp_f32 v48, v48
    ds_read_b64_tr_b16 v[156:157], v30 offset:3328
    v_exp_f32 v49, v49
    v_cvt_pk_bf16_f32 v107, v46, v47
    v_exp_f32 v50, v50
    v_exp_f32 v51, v51
    v_cvt_pk_bf16_f32 v108, v48, v49
    v_exp_f32 v52, v52
    ds_read_b64_tr_b16 v[158:159], v30 offset:3456
    s_add_u32 m0, s29, 16384
    s_nop 0
    buffer_load_dwordx4 v3, s[4:7], s28 offen sc1 lds
    s_add_u32 s28, s28, 4096
    v_exp_f32 v53, v53
    v_cvt_pk_bf16_f32 v109, v50, v51
    v_exp_f32 v54, v54
    v_exp_f32 v55, v55
    v_cvt_pk_bf16_f32 v110, v52, v53
    v_cvt_pk_bf16_f32 v111, v54, v55
    s_waitcnt vmcnt(2)
    s_barrier
    s_waitcnt lgkmcnt(4)
    v_mfma_f32_32x32x16_bf16 v[40:55], v[138:141], v[120:123], 0
    ds_read_b128 v[132:135], v26 offset:6144
    v_exp_f32 v56, v56
    v_exp_f32 v57, v57
    v_exp_f32 v58, v58
    v_exp_f32 v59, v59
    v_cvt_pk_bf16_f32 v112, v56, v57
    v_exp_f32 v60, v60
    v_mfma_f32_32x32x8_bf16 v[40:55], v[142:143], v[124:125], v[40:55]
    ds_read_b64 v[136:137], v28 offset:6144
    s_add_u32 m0, s29, 20480
    s_nop 0
    buffer_load_dwordx4 v3, s[4:7], s28 offen sc1 lds
    s_add_u32 s28, s28, 4096
    v_exp_f32 v61, v61
    v_cvt_pk_bf16_f32 v113, v58, v59
    v_exp_f32 v62, v62
    v_exp_f32 v63, v63
    v_cvt_pk_bf16_f32 v114, v60, v61
    v_exp_f32 v64, v64
    v_mfma_f32_32x32x16_bf16 v[72:87], v[144:147], v[104:107], 0
    s_add_u32 m0, s29, 24576
    s_nop 0
    buffer_load_dwordx4 v3, s[4:7], s28 offen sc1 lds
    s_add_u32 s28, s28, 4096
    v_exp_f32 v65, v65
    v_cvt_pk_bf16_f32 v115, v62, v63
    v_exp_f32 v66, v66
    v_exp_f32 v67, v67
    v_cvt_pk_bf16_f32 v116, v64, v65
    v_exp_f32 v68, v68
    v_mfma_f32_32x32x16_bf16 v[72:87], v[148:151], v[108:111], v[72:87]
    s_waitcnt lgkmcnt(0)
    v_exp_f32 v69, v69
    v_cvt_pk_bf16_f32 v117, v66, v67
    v_exp_f32 v70, v70
    v_exp_f32 v71, v71
    v_cvt_pk_bf16_f32 v118, v68, v69
    v_cvt_pk_bf16_f32 v119, v70, v71
    v_mfma_f32_32x32x16_bf16 v[56:71], v[138:141], v[126:129], 0
    ds_read_b128 v[138:141], v26 offset:9216
    v_exp_f32 v40, v40
    v_exp_f32 v41, v41
    v_exp_f32 v42, v42
    v_exp_f32 v43, v43
    v_cvt_pk_bf16_f32 v104, v40, v41
    v_exp_f32 v44, v44
    v_mfma_f32_32x32x8_bf16 v[56:71], v[142:143], v[130:131], v[56:71]
    ds_read_b64 v[142:143], v28 offset:9216
    s_add_u32 m0, s29, 28672
    s_nop 0
    buffer_load_dwordx4 v3, s[4:7], s28 offen sc1 lds
    s_add_u32 s28, s28, 4096
    v_exp_f32 v45, v45
    v_cvt_pk_bf16_f32 v105, v42, v43
    v_exp_f32 v46, v46
    v_exp_f32 v47, v47
    v_cvt_pk_bf16_f32 v106, v44, v45
    v_exp_f32 v48, v48
    v_mfma_f32_32x32x16_bf16 v[88:103], v[144:147], v[112:115], 0
    ds_read_b64_tr_b16 v[144:145], v30 offset:6144
    v_exp_f32 v49, v49
    v_cvt_pk_bf16_f32 v107, v46, v47
    v_exp_f32 v50, v50
    v_exp_f32 v51, v51
    v_cvt_pk_bf16_f32 v108, v48, v49
    v_exp_f32 v52, v52
    v_mfma_f32_32x32x16_bf16 v[88:103], v[148:151], v[116:119], v[88:103]
    ds_read_b64_tr_b16 v[146:147], v30 offset:6272
    s_add_u32 m0, s29, 32768
    s_nop 0
    buffer_load_dwordx4 v3, s[4:7], s28 offen sc1 lds
    s_add_u32 s28, s28, 4096
    v_exp_f32 v53, v53
    v_cvt_pk_bf16_f32 v109, v50, v51
    v_exp_f32 v54, v54
    v_exp_f32 v55, v55
    v_cvt_pk_bf16_f32 v110, v52, v53
    v_cvt_pk_bf16_f32 v111, v54, v55
    v_mfma_f32_32x32x16_bf16 v[40:55], v[132:135], v[120:123], 0
    ds_read_b64_tr_b16 v[148:149], v30 offset:6400
    v_exp_f32 v56, v56
    v_exp_f32 v57, v57
    v_exp_f32 v58, v58
    v_exp_f32 v59, v59
    v_cvt_pk_bf16_f32 v112, v56, v57
    v_exp_f32 v60, v60
    v_mfma_f32_32x32x8_bf16 v[40:55], v[136:137], v[124:125], v[40:55]
    ds_read_b64_tr_b16 v[150:151], v30 offset:6528
    s_add_u32 m0, s29, 36864
    s_nop 0
    buffer_load_dwordx4 v3, s[4:7], s28 offen sc1 lds
    s_add_u32 s28, s28, 4096
    v_exp_f32 v61, v61
    v_cvt_pk_bf16_f32 v113, v58, v59
    v_exp_f32 v62, v62
    v_exp_f32 v63, v63
    v_cvt_pk_bf16_f32 v114, v60, v61
    v_exp_f32 v64, v64
    v_mfma_f32_32x32x16_bf16 v[72:87], v[152:155], v[104:107], v[72:87]
    s_add_u32 m0, s29, 40960
    s_nop 0
    buffer_load_dwordx4 v3, s[4:7], s28 offen sc1 lds
    s_add_u32 s28, s28, 4096
    v_exp_f32 v65, v65
    v_cvt_pk_bf16_f32 v115, v62, v63
    v_exp_f32 v66, v66
    v_exp_f32 v67, v67
    v_cvt_pk_bf16_f32 v116, v64, v65
    v_exp_f32 v68, v68
    v_mfma_f32_32x32x16_bf16 v[72:87], v[156:159], v[108:111], v[72:87]
    s_waitcnt vmcnt(4) lgkmcnt(0)
    s_barrier
    s_setprio 1
    v_exp_f32 v69, v69
    v_cvt_pk_bf16_f32 v117, v66, v67
    v_exp_f32 v70, v70
    v_exp_f32 v71, v71
    v_cvt_pk_bf16_f32 v118, v68, v69
    v_cvt_pk_bf16_f32 v119, v70, v71
    v_mfma_f32_32x32x16_bf16 v[56:71], v[132:135], v[126:129], 0
    ds_read_b128 v[132:135], v26 offset:12288
    v_exp_f32 v40, v40
    v_exp_f32 v41, v41
    v_exp_f32 v42, v42
    v_exp_f32 v43, v43
    v_cvt_pk_bf16_f32 v104, v40, v41
    v_exp_f32 v44, v44
    v_mfma_f32_32x32x8_bf16 v[56:71], v[136:137], v[130:131], v[56:71]
    ds_read_b64 v[136:137], v28 offset:12288
    s_add_u32 m0, s29, 45056
    s_nop 0
    buffer_load_dwordx4 v3, s[4:7], s28 offen sc1 lds
    s_add_u32 s28, s28, 4096
    v_exp_f32 v45, v45
    v_cvt_pk_bf16_f32 v105, v42, v43
    v_exp_f32 v46, v46
    v_exp_f32 v47, v47
    v_cvt_pk_bf16_f32 v106, v44, v45
    v_exp_f32 v48, v48
    v_mfma_f32_32x32x16_bf16 v[88:103], v[152:155], v[112:115], v[88:103]
    ds_read_b64_tr_b16 v[152:153], v30 offset:9216
    v_exp_f32 v49, v49
    v_cvt_pk_bf16_f32 v107, v46, v47
    v_exp_f32 v50, v50
    v_exp_f32 v51, v51
    v_cvt_pk_bf16_f32 v108, v48, v49
    v_exp_f32 v52, v52
    v_mfma_f32_32x32x16_bf16 v[88:103], v[156:159], v[116:119], v[88:103]
    ds_read_b64_tr_b16 v[154:155], v30 offset:9344
    s_add_u32 m0, s29, 49152
    s_nop 0
    buffer_load_dwordx4 v3, s[4:7], s28 offen sc1 lds
    s_add_u32 s28, s28, 4096
    v_exp_f32 v53, v53
    v_cvt_pk_bf16_f32 v109, v50, v51
    v_exp_f32 v54, v54
    v_exp_f32 v55, v55
    v_cvt_pk_bf16_f32 v110, v52, v53
    v_cvt_pk_bf16_f32 v111, v54, v55
    v_mfma_f32_32x32x16_bf16 v[40:55], v[138:141], v[120:123], 0
    ds_read_b64_tr_b16 v[156:157], v30 offset:9472
    v_exp_f32 v56, v56
    v_exp_f32 v57, v57
    v_exp_f32 v58, v58
    v_exp_f32 v59, v59
    v_cvt_pk_bf16_f32 v112, v56, v57
    v_exp_f32 v60, v60
    v_mfma_f32_32x32x8_bf16 v[40:55], v[142:143], v[124:125], v[40:55]
    ds_read_b64_tr_b16 v[158:159], v30 offset:9600
    s_add_u32 m0, s29, 53248
    s_nop 0
    buffer_load_dwordx4 v3, s[4:7], s28 offen sc1 lds
    s_add_u32 s28, s28, 4096
    v_exp_f32 v61, v61
    v_cvt_pk_bf16_f32 v113, v58, v59
    v_exp_f32 v62, v62
    v_exp_f32 v63, v63
    v_cvt_pk_bf16_f32 v114, v60, v61
    v_exp_f32 v64, v64
    v_mfma_f32_32x32x16_bf16 v[72:87], v[144:147], v[104:107], v[72:87]
    s_add_u32 m0, s29, 57344
    s_nop 0
    buffer_load_dwordx4 v3, s[4:7], s28 offen sc1 lds
    s_add_u32 s28, s28, 4096
    v_exp_f32 v65, v65
    v_cvt_pk_bf16_f32 v115, v62, v63
    v_exp_f32 v66, v66
    v_exp_f32 v67, v67
    v_cvt_pk_bf16_f32 v116, v64, v65
    v_exp_f32 v68, v68
    v_mfma_f32_32x32x16_bf16 v[72:87], v[148:151], v[108:111], v[72:87]
    s_waitcnt lgkmcnt(0)
    v_exp_f32 v69, v69
    v_cvt_pk_bf16_f32 v117, v66, v67
    v_exp_f32 v70, v70
    v_exp_f32 v71, v71
    v_cvt_pk_bf16_f32 v118, v68, v69
    v_cvt_pk_bf16_f32 v119, v70, v71
    v_mfma_f32_32x32x16_bf16 v[56:71], v[138:141], v[126:129], 0
    ds_read_b128 v[138:141], v26 offset:15360
    v_exp_f32 v40, v40
    v_exp_f32 v41, v41
    v_exp_f32 v42, v42
    v_exp_f32 v43, v43
    v_cvt_pk_bf16_f32 v104, v40, v41
    v_exp_f32 v44, v44
    v_mfma_f32_32x32x8_bf16 v[56:71], v[142:143], v[130:131], v[56:71]
    ds_read_b64 v[142:143], v28 offset:15360
    s_add_u32 m0, s29, 61440
    s_nop 0
    buffer_load_dwordx4 v3, s[4:7], s28 offen sc1 lds
    s_add_u32 s28, s28, 4096
    v_exp_f32 v45, v45
    v_cvt_pk_bf16_f32 v105, v42, v43
    v_exp_f32 v46, v46
    v_exp_f32 v47, v47
    v_cvt_pk_bf16_f32 v106, v44, v45
    v_exp_f32 v48, v48
    v_mfma_f32_32x32x16_bf16 v[88:103], v[144:147], v[112:115], v[88:103]
    ds_read_b64_tr_b16 v[144:145], v30 offset:12288
    v_exp_f32 v49, v49
    v_cvt_pk_bf16_f32 v107, v46, v47
    v_exp_f32 v50, v50
    v_exp_f32 v51, v51
    v_cvt_pk_bf16_f32 v108, v48, v49
    v_exp_f32 v52, v52
    v_mfma_f32_32x32x16_bf16 v[88:103], v[148:151], v[116:119], v[88:103]
    ds_read_b64_tr_b16 v[146:147], v30 offset:12416
    s_add_u32 m0, s29, 65536
    s_nop 0
    buffer_load_dwordx4 v3, s[4:7], s28 offen sc1 lds
    s_add_u32 s28, s28, 4096
    v_exp_f32 v53, v53
    v_cvt_pk_bf16_f32 v109, v50, v51
    v_exp_f32 v54, v54
    v_exp_f32 v55, v55
    v_cvt_pk_bf16_f32 v110, v52, v53
    v_cvt_pk_bf16_f32 v111, v54, v55
    v_mfma_f32_32x32x16_bf16 v[40:55], v[132:135], v[120:123], 0
    ds_read_b64_tr_b16 v[148:149], v30 offset:12544
    v_exp_f32 v56, v56
    v_exp_f32 v57, v57
    v_exp_f32 v58, v58
    v_exp_f32 v59, v59
    v_cvt_pk_bf16_f32 v112, v56, v57
    v_exp_f32 v60, v60
    v_mfma_f32_32x32x8_bf16 v[40:55], v[136:137], v[124:125], v[40:55]
    ds_read_b64_tr_b16 v[150:151], v30 offset:12672
    s_add_u32 m0, s29, 69632
    s_nop 0
    buffer_load_dwordx4 v3, s[4:7], s28 offen sc1 lds
    s_add_u32 s28, s28, 4096
    v_exp_f32 v61, v61
    v_cvt_pk_bf16_f32 v113, v58, v59
    v_exp_f32 v62, v62
    v_exp_f32 v63, v63
    v_cvt_pk_bf16_f32 v114, v60, v61
    v_exp_f32 v64, v64
    v_mfma_f32_32x32x16_bf16 v[72:87], v[152:155], v[104:107], v[72:87]
    v_exp_f32 v65, v65
    v_cvt_pk_bf16_f32 v115, v62, v63
    v_exp_f32 v66, v66
    v_exp_f32 v67, v67
    v_cvt_pk_bf16_f32 v116, v64, v65
    v_exp_f32 v68, v68
    v_mfma_f32_32x32x16_bf16 v[72:87], v[156:159], v[108:111], v[72:87]
    s_waitcnt lgkmcnt(0)
    s_setprio 0
    v_exp_f32 v69, v69
    v_cvt_pk_bf16_f32 v117, v66, v67
    v_exp_f32 v70, v70
    v_exp_f32 v71, v71
    v_cvt_pk_bf16_f32 v118, v68, v69
    v_cvt_pk_bf16_f32 v119, v70, v71
    v_mfma_f32_32x32x16_bf16 v[56:71], v[132:135], v[126:129], 0
    ds_read_b128 v[132:135], v26 offset:18432
    v_exp_f32 v40, v40
    v_exp_f32 v41, v41
    v_exp_f32 v42, v42
    v_exp_f32 v43, v43
    v_cvt_pk_bf16_f32 v104, v40, v41
    v_exp_f32 v44, v44
    v_mfma_f32_32x32x8_bf16 v[56:71], v[136:137], v[130:131], v[56:71]
    ds_read_b64 v[136:137], v28 offset:18432
    v_exp_f32 v45, v45
    v_cvt_pk_bf16_f32 v105, v42, v43
    v_exp_f32 v46, v46
    v_exp_f32 v47, v47
    v_cvt_pk_bf16_f32 v106, v44, v45
    v_exp_f32 v48, v48
    v_mfma_f32_32x32x16_bf16 v[88:103], v[152:155], v[112:115], v[88:103]
    ds_read_b64_tr_b16 v[152:153], v30 offset:15360
    v_exp_f32 v49, v49
    v_cvt_pk_bf16_f32 v107, v46, v47
    v_exp_f32 v50, v50
    v_exp_f32 v51, v51
    v_cvt_pk_bf16_f32 v108, v48, v49
    v_exp_f32 v52, v52
    v_mfma_f32_32x32x16_bf16 v[88:103], v[156:159], v[116:119], v[88:103]
    ds_read_b64_tr_b16 v[154:155], v30 offset:15488
    v_exp_f32 v53, v53
    v_cvt_pk_bf16_f32 v109, v50, v51
    v_exp_f32 v54, v54
    v_exp_f32 v55, v55
    v_cvt_pk_bf16_f32 v110, v52, v53
    v_cvt_pk_bf16_f32 v111, v54, v55
    v_mfma_f32_32x32x16_bf16 v[40:55], v[138:141], v[120:123], 0
    ds_read_b64_tr_b16 v[156:157], v30 offset:15616
    v_exp_f32 v56, v56
    v_exp_f32 v57, v57
    v_exp_f32 v58, v58
    v_exp_f32 v59, v59
    v_cvt_pk_bf16_f32 v112, v56, v57
    v_exp_f32 v60, v60
    v_mfma_f32_32x32x8_bf16 v[40:55], v[142:143], v[124:125], v[40:55]
    ds_read_b64_tr_b16 v[158:159], v30 offset:15744
    v_exp_f32 v61, v61
    v_cvt_pk_bf16_f32 v113, v58, v59
    v_exp_f32 v62, v62
    v_exp_f32 v63, v63
    v_cvt_pk_bf16_f32 v114, v60, v61
    v_exp_f32 v64, v64
    v_mfma_f32_32x32x16_bf16 v[72:87], v[144:147], v[104:107], v[72:87]
    v_exp_f32 v65, v65
    v_cvt_pk_bf16_f32 v115, v62, v63
    v_exp_f32 v66, v66
    v_exp_f32 v67, v67
    v_cvt_pk_bf16_f32 v116, v64, v65
    v_exp_f32 v68, v68
    v_mfma_f32_32x32x16_bf16 v[72:87], v[148:151], v[108:111], v[72:87]
    s_waitcnt vmcnt(0) lgkmcnt(0)
    s_barrier
    s_setprio 1
    s_cmp_eq_u32 s60, 1
    s_cbranch_scc1 L_mega_kernel_ool_36
L_mega_kernel_back_37:
    v_exp_f32 v69, v69
    v_cvt_pk_bf16_f32 v117, v66, v67
    v_exp_f32 v70, v70
    v_exp_f32 v71, v71
    v_cvt_pk_bf16_f32 v118, v68, v69
    v_cvt_pk_bf16_f32 v119, v70, v71
    v_mfma_f32_32x32x16_bf16 v[56:71], v[138:141], v[126:129], 0
    ds_read_b128 v[138:141], v26 offset:21504
    v_exp_f32 v40, v40
    v_exp_f32 v41, v41
    v_exp_f32 v42, v42
    v_exp_f32 v43, v43
    v_cvt_pk_bf16_f32 v104, v40, v41
    v_exp_f32 v44, v44
    v_mfma_f32_32x32x8_bf16 v[56:71], v[142:143], v[130:131], v[56:71]
    ds_read_b64 v[142:143], v28 offset:21504
    v_exp_f32 v45, v45
    v_cvt_pk_bf16_f32 v105, v42, v43
    v_exp_f32 v46, v46
    v_exp_f32 v47, v47
    v_cvt_pk_bf16_f32 v106, v44, v45
    v_exp_f32 v48, v48
    v_mfma_f32_32x32x16_bf16 v[88:103], v[144:147], v[112:115], v[88:103]
    ds_read_b64_tr_b16 v[144:145], v30 offset:18432
    v_exp_f32 v49, v49
    v_cvt_pk_bf16_f32 v107, v46, v47
    v_exp_f32 v50, v50
    v_exp_f32 v51, v51
    v_cvt_pk_bf16_f32 v108, v48, v49
    v_exp_f32 v52, v52
    v_mfma_f32_32x32x16_bf16 v[88:103], v[148:151], v[116:119], v[88:103]
    ds_read_b64_tr_b16 v[146:147], v30 offset:18560
    v_exp_f32 v53, v53
    v_cvt_pk_bf16_f32 v109, v50, v51
    v_exp_f32 v54, v54
    v_exp_f32 v55, v55
    v_cvt_pk_bf16_f32 v110, v52, v53
    v_cvt_pk_bf16_f32 v111, v54, v55
    v_mfma_f32_32x32x16_bf16 v[40:55], v[132:135], v[120:123], 0
    ds_read_b64_tr_b16 v[148:149], v30 offset:18688
    v_exp_f32 v56, v56
    v_exp_f32 v57, v57
    v_exp_f32 v58, v58
    v_exp_f32 v59, v59
    v_cvt_pk_bf16_f32 v112, v56, v57
    v_exp_f32 v60, v60
    v_mfma_f32_32x32x8_bf16 v[40:55], v[136:137], v[124:125], v[40:55]
    ds_read_b64_tr_b16 v[150:151], v30 offset:18816
    v_exp_f32 v61, v61
    v_cvt_pk_bf16_f32 v113, v58, v59
    v_exp_f32 v62, v62
    v_exp_f32 v63, v63
    v_cvt_pk_bf16_f32 v114, v60, v61
    v_exp_f32 v64, v64
    v_mfma_f32_32x32x16_bf16 v[72:87], v[152:155], v[104:107], v[72:87]
    v_exp_f32 v65, v65
    v_cvt_pk_bf16_f32 v115, v62, v63
    v_exp_f32 v66, v66
    v_exp_f32 v67, v67
    v_cvt_pk_bf16_f32 v116, v64, v65
    v_exp_f32 v68, v68
    v_mfma_f32_32x32x16_bf16 v[72:87], v[156:159], v[108:111], v[72:87]
    s_waitcnt lgkmcnt(0)
    v_exp_f32 v69, v69
    v_cvt_pk_bf16_f32 v117, v66, v67
    v_exp_f32 v70, v70
    v_exp_f32 v71, v71
    v_cvt_pk_bf16_f32 v118, v68, v69
    v_cvt_pk_bf16_f32 v119, v70, v71
    v_mfma_f32_32x32x16_bf16 v[56:71], v[132:135], v[126:129], 0
    ds_read_b128 v[132:135], v26 offset:24576
    v_exp_f32 v40, v40
    v_exp_f32 v41, v41
    v_exp_f32 v42, v42
    v_exp_f32 v43, v43
    v_cvt_pk_bf16_f32 v104, v40, v41
    v_exp_f32 v44, v44
    v_mfma_f32_32x32x8_bf16 v[56:71], v[136:137], v[130:131], v[56:71]
    ds_read_b64 v[136:137], v28 offset:24576
    v_exp_f32 v45, v45
    v_cvt_pk_bf16_f32 v105, v42, v43
    v_exp_f32 v46, v46
    v_exp_f32 v47, v47
    v_cvt_pk_bf16_f32 v106, v44, v45
    v_exp_f32 v48, v48
    v_mfma_f32_32x32x16_bf16 v[88:103], v[152:155], v[112:115], v[88:103]
    ds_read_b64_tr_b16 v[152:153], v30 offset:21504
    v_exp_f32 v49, v49
    v_cvt_pk_bf16_f32 v107, v46, v47
    v_exp_f32 v50, v50
    v_exp_f32 v51, v51
    v_cvt_pk_bf16_f32 v108, v48, v49
    v_exp_f32 v52, v52
    v_mfma_f32_32x32x16_bf16 v[88:103], v[156:159], v[116:119], v[88:103]
    ds_read_b64_tr_b16 v[154:155], v30 offset:21632
    v_exp_f32 v53, v53
    v_cvt_pk_bf16_f32 v109, v50, v51
    v_exp_f32 v54, v54
    v_exp_f32 v55, v55
    v_cvt_pk_bf16_f32 v110, v52, v53
    v_cvt_pk_bf16_f32 v111, v54, v55
    v_mfma_f32_32x32x16_bf16 v[40:55], v[138:141], v[120:123], 0
    ds_read_b64_tr_b16 v[156:157], v30 offset:21760
    v_exp_f32 v56, v56
    v_exp_f32 v57, v57
    v_exp_f32 v58, v58
    v_exp_f32 v59, v59
    v_cvt_pk_bf16_f32 v112, v56, v57
    v_exp_f32 v60, v60
    v_mfma_f32_32x32x8_bf16 v[40:55], v[142:143], v[124:125], v[40:55]
    ds_read_b64_tr_b16 v[158:159], v30 offset:21888
    v_exp_f32 v61, v61
    v_cvt_pk_bf16_f32 v113, v58, v59
    v_exp_f32 v62, v62
    v_exp_f32 v63, v63
    v_cvt_pk_bf16_f32 v114, v60, v61
    v_exp_f32 v64, v64
    v_mfma_f32_32x32x16_bf16 v[72:87], v[144:147], v[104:107], v[72:87]
    v_exp_f32 v65, v65
    v_cvt_pk_bf16_f32 v115, v62, v63
    v_exp_f32 v66, v66
    v_exp_f32 v67, v67
    v_cvt_pk_bf16_f32 v116, v64, v65
    v_exp_f32 v68, v68
    v_mfma_f32_32x32x16_bf16 v[72:87], v[148:151], v[108:111], v[72:87]
    s_waitcnt lgkmcnt(0)
    v_exp_f32 v69, v69
    v_cvt_pk_bf16_f32 v117, v66, v67
    v_exp_f32 v70, v70
    v_exp_f32 v71, v71
    v_cvt_pk_bf16_f32 v118, v68, v69
    v_cvt_pk_bf16_f32 v119, v70, v71
    v_mfma_f32_32x32x16_bf16 v[56:71], v[138:141], v[126:129], 0
    ds_read_b128 v[138:141], v26 offset:27648
    v_exp_f32 v40, v40
    v_exp_f32 v41, v41
    v_exp_f32 v42, v42
    v_exp_f32 v43, v43
    v_cvt_pk_bf16_f32 v104, v40, v41
    v_exp_f32 v44, v44
    v_mfma_f32_32x32x8_bf16 v[56:71], v[142:143], v[130:131], v[56:71]
    ds_read_b64 v[142:143], v28 offset:27648
    v_exp_f32 v45, v45
    v_cvt_pk_bf16_f32 v105, v42, v43
    v_exp_f32 v46, v46
    v_exp_f32 v47, v47
    v_cvt_pk_bf16_f32 v106, v44, v45
    v_exp_f32 v48, v48
    v_mfma_f32_32x32x16_bf16 v[88:103], v[144:147], v[112:115], v[88:103]
    ds_read_b64_tr_b16 v[144:145], v30 offset:24576
    v_exp_f32 v49, v49
    v_cvt_pk_bf16_f32 v107, v46, v47
    v_exp_f32 v50, v50
    v_exp_f32 v51, v51
    v_cvt_pk_bf16_f32 v108, v48, v49
    v_exp_f32 v52, v52
    v_mfma_f32_32x32x16_bf16 v[88:103], v[148:151], v[116:119], v[88:103]
    ds_read_b64_tr_b16 v[146:147], v30 offset:24704
    v_exp_f32 v53, v53
    v_cvt_pk_bf16_f32 v109, v50, v51
    v_exp_f32 v54, v54
    v_exp_f32 v55, v55
    v_cvt_pk_bf16_f32 v110, v52, v53
    v_cvt_pk_bf16_f32 v111, v54, v55
    v_mfma_f32_32x32x16_bf16 v[40:55], v[132:135], v[120:123], 0
    ds_read_b64_tr_b16 v[148:149], v30 offset:24832
    v_exp_f32 v56, v56
    v_exp_f32 v57, v57
    v_exp_f32 v58, v58
    v_exp_f32 v59, v59
    v_cvt_pk_bf16_f32 v112, v56, v57
    v_exp_f32 v60, v60
    v_mfma_f32_32x32x8_bf16 v[40:55], v[136:137], v[124:125], v[40:55]
    ds_read_b64_tr_b16 v[150:151], v30 offset:24960
    v_exp_f32 v61, v61
    v_cvt_pk_bf16_f32 v113, v58, v59
    v_exp_f32 v62, v62
    v_exp_f32 v63, v63
    v_cvt_pk_bf16_f32 v114, v60, v61
    v_exp_f32 v64, v64
    v_mfma_f32_32x32x16_bf16 v[72:87], v[152:155], v[104:107], v[72:87]
    v_exp_f32 v65, v65
    v_cvt_pk_bf16_f32 v115, v62, v63
    v_exp_f32 v66, v66
    v_exp_f32 v67, v67
    v_cvt_pk_bf16_f32 v116, v64, v65
    v_exp_f32 v68, v68
    v_mfma_f32_32x32x16_bf16 v[72:87], v[156:159], v[108:111], v[72:87]
    s_waitcnt lgkmcnt(0)
    v_exp_f32 v69, v69
    v_cvt_pk_bf16_f32 v117, v66, v67
    v_exp_f32 v70, v70
    v_exp_f32 v71, v71
    v_cvt_pk_bf16_f32 v118, v68, v69
    v_cvt_pk_bf16_f32 v119, v70, v71
    v_mfma_f32_32x32x16_bf16 v[56:71], v[132:135], v[126:129], 0
    ds_read_b128 v[132:135], v26 offset:30720
    v_exp_f32 v40, v40
    v_exp_f32 v41, v41
    v_exp_f32 v42, v42
    v_exp_f32 v43, v43
    v_cvt_pk_bf16_f32 v104, v40, v41
    v_exp_f32 v44, v44
    v_mfma_f32_32x32x8_bf16 v[56:71], v[136:137], v[130:131], v[56:71]
    ds_read_b64 v[136:137], v28 offset:30720
    v_exp_f32 v45, v45
    v_cvt_pk_bf16_f32 v105, v42, v43
    v_exp_f32 v46, v46
    v_exp_f32 v47, v47
    v_cvt_pk_bf16_f32 v106, v44, v45
    v_exp_f32 v48, v48
    v_mfma_f32_32x32x16_bf16 v[88:103], v[152:155], v[112:115], v[88:103]
    ds_read_b64_tr_b16 v[152:153], v30 offset:27648
    v_exp_f32 v49, v49
    v_cvt_pk_bf16_f32 v107, v46, v47
    v_exp_f32 v50, v50
    v_exp_f32 v51, v51
    v_cvt_pk_bf16_f32 v108, v48, v49
    v_exp_f32 v52, v52
    v_mfma_f32_32x32x16_bf16 v[88:103], v[156:159], v[116:119], v[88:103]
    ds_read_b64_tr_b16 v[154:155], v30 offset:27776
    v_exp_f32 v53, v53
    v_cvt_pk_bf16_f32 v109, v50, v51
    v_exp_f32 v54, v54
    v_exp_f32 v55, v55
    v_cvt_pk_bf16_f32 v110, v52, v53
    v_cvt_pk_bf16_f32 v111, v54, v55
    v_mfma_f32_32x32x16_bf16 v[40:55], v[138:141], v[120:123], 0
    ds_read_b64_tr_b16 v[156:157], v30 offset:27904
    v_exp_f32 v56, v56
    v_exp_f32 v57, v57
    v_exp_f32 v58, v58
    v_exp_f32 v59, v59
    v_cvt_pk_bf16_f32 v112, v56, v57
    v_exp_f32 v60, v60
    v_mfma_f32_32x32x8_bf16 v[40:55], v[142:143], v[124:125], v[40:55]
    ds_read_b64_tr_b16 v[158:159], v30 offset:28032
    v_exp_f32 v61, v61
    v_cvt_pk_bf16_f32 v113, v58, v59
    v_exp_f32 v62, v62
    v_exp_f32 v63, v63
    v_cvt_pk_bf16_f32 v114, v60, v61
    v_exp_f32 v64, v64
    v_mfma_f32_32x32x16_bf16 v[72:87], v[144:147], v[104:107], v[72:87]
    v_exp_f32 v65, v65
    v_cvt_pk_bf16_f32 v115, v62, v63
    v_exp_f32 v66, v66
    v_exp_f32 v67, v67
    v_cvt_pk_bf16_f32 v116, v64, v65
    v_exp_f32 v68, v68
    v_mfma_f32_32x32x16_bf16 v[72:87], v[148:151], v[108:111], v[72:87]
    s_waitcnt lgkmcnt(0)
    v_exp_f32 v69, v69
    v_cvt_pk_bf16_f32 v117, v66, v67
    v_exp_f32 v70, v70
    v_exp_f32 v71, v71
    v_cvt_pk_bf16_f32 v118, v68, v69
    v_cvt_pk_bf16_f32 v119, v70, v71
    v_mfma_f32_32x32x16_bf16 v[56:71], v[138:141], v[126:129], 0
    ds_read_b128 v[138:141], v26 offset:33792
    v_exp_f32 v40, v40
    v_exp_f32 v41, v41
    v_exp_f32 v42, v42
    v_exp_f32 v43, v43
    v_cvt_pk_bf16_f32 v104, v40, v41
    v_exp_f32 v44, v44
    v_mfma_f32_32x32x8_bf16 v[56:71], v[142:143], v[130:131], v[56:71]
    ds_read_b64 v[142:143], v28 offset:33792
    v_exp_f32 v45, v45
    v_cvt_pk_bf16_f32 v105, v42, v43
    v_exp_f32 v46, v46
    v_exp_f32 v47, v47
    v_cvt_pk_bf16_f32 v106, v44, v45
    v_exp_f32 v48, v48
    v_mfma_f32_32x32x16_bf16 v[88:103], v[144:147], v[112:115], v[88:103]
    ds_read_b64_tr_b16 v[144:145], v30 offset:30720
    v_exp_f32 v49, v49
    v_cvt_pk_bf16_f32 v107, v46, v47
    v_exp_f32 v50, v50
    v_exp_f32 v51, v51
    v_cvt_pk_bf16_f32 v108, v48, v49
    v_exp_f32 v52, v52
    v_mfma_f32_32x32x16_bf16 v[88:103], v[148:151], v[116:119], v[88:103]
    ds_read_b64_tr_b16 v[146:147], v30 offset:30848
    v_exp_f32 v53, v53
    v_cvt_pk_bf16_f32 v109, v50, v51
    v_exp_f32 v54, v54
    v_exp_f32 v55, v55
    v_cvt_pk_bf16_f32 v110, v52, v53
    v_cvt_pk_bf16_f32 v111, v54, v55
    v_mfma_f32_32x32x16_bf16 v[40:55], v[132:135], v[120:123], 0
    ds_read_b64_tr_b16 v[148:149], v30 offset:30976
    v_exp_f32 v56, v56
    v_exp_f32 v57, v57
    v_exp_f32 v58, v58
    v_exp_f32 v59, v59
    v_cvt_pk_bf16_f32 v112, v56, v57
    v_exp_f32 v60, v60
    v_mfma_f32_32x32x8_bf16 v[40:55], v[136:137], v[124:125], v[40:55]
    ds_read_b64_tr_b16 v[150:151], v30 offset:31104
    v_exp_f32 v61, v61
    v_cvt_pk_bf16_f32 v113, v58, v59
    v_exp_f32 v62, v62
    v_exp_f32 v63, v63
    v_cvt_pk_bf16_f32 v114, v60, v61
    v_exp_f32 v64, v64
    v_mfma_f32_32x32x16_bf16 v[72:87], v[152:155], v[104:107], v[72:87]
    v_exp_f32 v65, v65
    v_cvt_pk_bf16_f32 v115, v62, v63
    v_exp_f32 v66, v66
    v_exp_f32 v67, v67
    v_cvt_pk_bf16_f32 v116, v64, v65
    v_exp_f32 v68, v68
    v_mfma_f32_32x32x16_bf16 v[72:87], v[156:159], v[108:111], v[72:87]
    s_waitcnt lgkmcnt(0)
    v_exp_f32 v69, v69
    v_cvt_pk_bf16_f32 v117, v66, v67
    v_exp_f32 v70, v70
    v_exp_f32 v71, v71
    v_cvt_pk_bf16_f32 v118, v68, v69
    v_cvt_pk_bf16_f32 v119, v70, v71
    v_mfma_f32_32x32x16_bf16 v[56:71], v[132:135], v[126:129], 0
    ds_read_b128 v[132:135], v27 offset:0
    v_exp_f32 v40, v40
    v_exp_f32 v41, v41
    v_exp_f32 v42, v42
    v_exp_f32 v43, v43
    v_cvt_pk_bf16_f32 v104, v40, v41
    v_exp_f32 v44, v44
    v_mfma_f32_32x32x8_bf16 v[56:71], v[136:137], v[130:131], v[56:71]
    ds_read_b64 v[136:137], v29 offset:0
    v_exp_f32 v45, v45
    v_cvt_pk_bf16_f32 v105, v42, v43
    v_exp_f32 v46, v46
    v_exp_f32 v47, v47
    v_cvt_pk_bf16_f32 v106, v44, v45
    v_exp_f32 v48, v48
    v_mfma_f32_32x32x16_bf16 v[88:103], v[152:155], v[112:115], v[88:103]
    ds_read_b64_tr_b16 v[152:153], v30 offset:33792
    v_exp_f32 v49, v49
    v_cvt_pk_bf16_f32 v107, v46, v47
    v_exp_f32 v50, v50
    v_exp_f32 v51, v51
    v_cvt_pk_bf16_f32 v108, v48, v49
    v_exp_f32 v52, v52
    v_mfma_f32_32x32x16_bf16 v[88:103], v[156:159], v[116:119], v[88:103]
    ds_read_b64_tr_b16 v[154:155], v30 offset:33920
    v_exp_f32 v53, v53
    v_cvt_pk_bf16_f32 v109, v50, v51
    v_exp_f32 v54, v54
    v_exp_f32 v55, v55
    v_cvt_pk_bf16_f32 v110, v52, v53
    v_cvt_pk_bf16_f32 v111, v54, v55
    v_mfma_f32_32x32x16_bf16 v[40:55], v[138:141], v[120:123], 0
    ds_read_b64_tr_b16 v[156:157], v30 offset:34048
    v_exp_f32 v56, v56
    v_exp_f32 v57, v57
    v_exp_f32 v58, v58
    v_exp_f32 v59, v59
    v_cvt_pk_bf16_f32 v112, v56, v57
    v_exp_f32 v60, v60
    v_mfma_f32_32x32x8_bf16 v[40:55], v[142:143], v[124:125], v[40:55]
    ds_read_b64_tr_b16 v[158:159], v30 offset:34176
    v_exp_f32 v61, v61
    v_cvt_pk_bf16_f32 v113, v58, v59
    v_exp_f32 v62, v62
    v_exp_f32 v63, v63
    v_cvt_pk_bf16_f32 v114, v60, v61
    v_exp_f32 v64, v64
    v_mfma_f32_32x32x16_bf16 v[72:87], v[144:147], v[104:107], v[72:87]
    v_exp_f32 v65, v65
    v_cvt_pk_bf16_f32 v115, v62, v63
    v_exp_f32 v66, v66
    v_exp_f32 v67, v67
    v_cvt_pk_bf16_f32 v116, v64, v65
    v_exp_f32 v68, v68
    v_mfma_f32_32x32x16_bf16 v[72:87], v[148:151], v[108:111], v[72:87]
    s_waitcnt lgkmcnt(0)
    s_setprio 0
    v_exp_f32 v69, v69
    v_cvt_pk_bf16_f32 v117, v66, v67
    v_exp_f32 v70, v70
    v_exp_f32 v71, v71
    v_cvt_pk_bf16_f32 v118, v68, v69
    v_cvt_pk_bf16_f32 v119, v70, v71
    v_mfma_f32_32x32x16_bf16 v[56:71], v[138:141], v[126:129], 0
    ds_read_b128 v[138:141], v27 offset:3072
    v_exp_f32 v40, v40
    v_exp_f32 v41, v41
    v_exp_f32 v42, v42
    v_exp_f32 v43, v43
    v_cvt_pk_bf16_f32 v104, v40, v41
    v_exp_f32 v44, v44
    v_mfma_f32_32x32x8_bf16 v[56:71], v[142:143], v[130:131], v[56:71]
    ds_read_b64 v[142:143], v29 offset:3072
    v_exp_f32 v45, v45
    v_cvt_pk_bf16_f32 v105, v42, v43
    v_exp_f32 v46, v46
    v_exp_f32 v47, v47
    v_cvt_pk_bf16_f32 v106, v44, v45
    v_exp_f32 v48, v48
    v_mfma_f32_32x32x16_bf16 v[88:103], v[144:147], v[112:115], v[88:103]
    ds_read_b64_tr_b16 v[144:145], v31 offset:0
    v_exp_f32 v49, v49
    v_cvt_pk_bf16_f32 v107, v46, v47
    v_exp_f32 v50, v50
    v_exp_f32 v51, v51
    v_cvt_pk_bf16_f32 v108, v48, v49
    v_exp_f32 v52, v52
    v_mfma_f32_32x32x16_bf16 v[88:103], v[148:151], v[116:119], v[88:103]
    ds_read_b64_tr_b16 v[146:147], v31 offset:128
    v_exp_f32 v53, v53
    v_cvt_pk_bf16_f32 v109, v50, v51
    v_exp_f32 v54, v54
    v_exp_f32 v55, v55
    v_cvt_pk_bf16_f32 v110, v52, v53
    v_cvt_pk_bf16_f32 v111, v54, v55
    v_mfma_f32_32x32x16_bf16 v[40:55], v[132:135], v[120:123], 0
    ds_read_b64_tr_b16 v[148:149], v31 offset:256
    v_exp_f32 v56, v56
    v_exp_f32 v57, v57
    v_exp_f32 v58, v58
    v_exp_f32 v59, v59
    v_cvt_pk_bf16_f32 v112, v56, v57
    v_exp_f32 v60, v60
    v_mfma_f32_32x32x8_bf16 v[40:55], v[136:137], v[124:125], v[40:55]
    ds_read_b64_tr_b16 v[150:151], v31 offset:384
    v_exp_f32 v61, v61
    v_cvt_pk_bf16_f32 v113, v58, v59
    v_exp_f32 v62, v62
    v_exp_f32 v63, v63
    v_cvt_pk_bf16_f32 v114, v60, v61
    v_exp_f32 v64, v64
    v_mfma_f32_32x32x16_bf16 v[72:87], v[152:155], v[104:107], v[72:87]
    v_exp_f32 v65, v65
    v_cvt_pk_bf16_f32 v115, v62, v63
    v_exp_f32 v66, v66
    v_exp_f32 v67, v67
    v_cvt_pk_bf16_f32 v116, v64, v65
    v_exp_f32 v68, v68
    v_mfma_f32_32x32x16_bf16 v[72:87], v[156:159], v[108:111], v[72:87]
    s_waitcnt vmcnt(63) lgkmcnt(0)
    s_barrier
    s_setprio 1
    s_cmp_eq_u32 s60, 1
    s_cbranch_scc1 L_mega_kernel_ool_38
L_mega_kernel_back_39:
    v_exp_f32 v69, v69
    v_cvt_pk_bf16_f32 v117, v66, v67
    v_exp_f32 v70, v70
    v_exp_f32 v71, v71
    v_cvt_pk_bf16_f32 v118, v68, v69
    v_cvt_pk_bf16_f32 v119, v70, v71
    v_mfma_f32_32x32x16_bf16 v[56:71], v[132:135], v[126:129], 0
    ds_read_b128 v[132:135], v27 offset:6144
    v_exp_f32 v40, v40
    v_exp_f32 v41, v41
    v_exp_f32 v42, v42
    v_exp_f32 v43, v43
    v_cvt_pk_bf16_f32 v104, v40, v41
    v_exp_f32 v44, v44
    v_mfma_f32_32x32x8_bf16 v[56:71], v[136:137], v[130:131], v[56:71]
    ds_read_b64 v[136:137], v29 offset:6144
    v_exp_f32 v45, v45
    v_cvt_pk_bf16_f32 v105, v42, v43
    v_exp_f32 v46, v46
    v_exp_f32 v47, v47
    v_cvt_pk_bf16_f32 v106, v44, v45
    v_exp_f32 v48, v48
    v_mfma_f32_32x32x16_bf16 v[88:103], v[152:155], v[112:115], v[88:103]
    ds_read_b64_tr_b16 v[152:153], v31 offset:3072
    v_exp_f32 v49, v49
    v_cvt_pk_bf16_f32 v107, v46, v47
    v_exp_f32 v50, v50
    v_exp_f32 v51, v51
    v_cvt_pk_bf16_f32 v108, v48, v49
    v_exp_f32 v52, v52
    v_mfma_f32_32x32x16_bf16 v[88:103], v[156:159], v[116:119], v[88:103]
    ds_read_b64_tr_b16 v[154:155], v31 offset:3200
    v_exp_f32 v53, v53
    v_cvt_pk_bf16_f32 v109, v50, v51
    v_exp_f32 v54, v54
    v_exp_f32 v55, v55
    v_cvt_pk_bf16_f32 v110, v52, v53
    v_cvt_pk_bf16_f32 v111, v54, v55
    v_mfma_f32_32x32x16_bf16 v[40:55], v[138:141], v[120:123], 0
    ds_read_b64_tr_b16 v[156:157], v31 offset:3328
    v_exp_f32 v56, v56
    v_exp_f32 v57, v57
    v_exp_f32 v58, v58
    v_exp_f32 v59, v59
    v_cvt_pk_bf16_f32 v112, v56, v57
    v_exp_f32 v60, v60
    v_mfma_f32_32x32x8_bf16 v[40:55], v[142:143], v[124:125], v[40:55]
    ds_read_b64_tr_b16 v[158:159], v31 offset:3456
    v_exp_f32 v61, v61
    v_cvt_pk_bf16_f32 v113, v58, v59
    v_exp_f32 v62, v62
    v_exp_f32 v63, v63
    v_cvt_pk_bf16_f32 v114, v60, v61
    v_exp_f32 v64, v64
    v_mfma_f32_32x32x16_bf16 v[72:87], v[144:147], v[104:107], v[72:87]
    v_exp_f32 v65, v65
    v_cvt_pk_bf16_f32 v115, v62, v63
    v_exp_f32 v66, v66
    v_exp_f32 v67, v67
    v_cvt_pk_bf16_f32 v116, v64, v65
    v_exp_f32 v68, v68
    v_mfma_f32_32x32x16_bf16 v[72:87], v[148:151], v[108:111], v[72:87]
    s_waitcnt lgkmcnt(0)
    v_exp_f32 v69, v69
    v_cvt_pk_bf16_f32 v117, v66, v67
    v_exp_f32 v70, v70
    v_exp_f32 v71, v71
    v_cvt_pk_bf16_f32 v118, v68, v69
    v_cvt_pk_bf16_f32 v119, v70, v71
    v_mfma_f32_32x32x16_bf16 v[56:71], v[138:141], v[126:129], 0
    ds_read_b128 v[138:141], v27 offset:9216
    v_exp_f32 v40, v40
    v_exp_f32 v41, v41
    v_exp_f32 v42, v42
    v_exp_f32 v43, v43
    v_cvt_pk_bf16_f32 v104, v40, v41
    v_exp_f32 v44, v44
    v_mfma_f32_32x32x8_bf16 v[56:71], v[142:143], v[130:131], v[56:71]
    ds_read_b64 v[142:143], v29 offset:9216
    v_exp_f32 v45, v45
    v_cvt_pk_bf16_f32 v105, v42, v43
    v_exp_f32 v46, v46
    v_exp_f32 v47, v47
    v_cvt_pk_bf16_f32 v106, v44, v45
    v_exp_f32 v48, v48
    v_mfma_f32_32x32x16_bf16 v[88:103], v[144:147], v[112:115], v[88:103]
    ds_read_b64_tr_b16 v[144:145], v31 offset:6144
    v_exp_f32 v49, v49
    v_cvt_pk_bf16_f32 v107, v46, v47
    v_exp_f32 v50, v50
    v_exp_f32 v51, v51
    v_cvt_pk_bf16_f32 v108, v48, v49
    v_exp_f32 v52, v52
    v_mfma_f32_32x32x16_bf16 v[88:103], v[148:151], v[116:119], v[88:103]
    ds_read_b64_tr_b16 v[146:147], v31 offset:6272
    v_exp_f32 v53, v53
    v_cvt_pk_bf16_f32 v109, v50, v51
    v_exp_f32 v54, v54
    v_exp_f32 v55, v55
    v_cvt_pk_bf16_f32 v110, v52, v53
    v_cvt_pk_bf16_f32 v111, v54, v55
    v_mfma_f32_32x32x16_bf16 v[40:55], v[132:135], v[120:123], 0
    ds_read_b64_tr_b16 v[148:149], v31 offset:6400
    v_exp_f32 v56, v56
    v_exp_f32 v57, v57
    v_exp_f32 v58, v58
    v_exp_f32 v59, v59
    v_cvt_pk_bf16_f32 v112, v56, v57
    v_exp_f32 v60, v60
    v_mfma_f32_32x32x8_bf16 v[40:55], v[136:137], v[124:125], v[40:55]
    ds_read_b64_tr_b16 v[150:151], v31 offset:6528
    v_exp_f32 v61, v61
    v_cvt_pk_bf16_f32 v113, v58, v59
    v_exp_f32 v62, v62
    v_exp_f32 v63, v63
    v_cvt_pk_bf16_f32 v114, v60, v61
    v_exp_f32 v64, v64
    v_mfma_f32_32x32x16_bf16 v[72:87], v[152:155], v[104:107], v[72:87]
    v_exp_f32 v65, v65
    v_cvt_pk_bf16_f32 v115, v62, v63
    v_exp_f32 v66, v66
    v_exp_f32 v67, v67
    v_cvt_pk_bf16_f32 v116, v64, v65
    v_exp_f32 v68, v68
    v_mfma_f32_32x32x16_bf16 v[72:87], v[156:159], v[108:111], v[72:87]
    s_waitcnt lgkmcnt(0)
    v_exp_f32 v69, v69
    v_cvt_pk_bf16_f32 v117, v66, v67
    v_exp_f32 v70, v70
    v_exp_f32 v71, v71
    v_cvt_pk_bf16_f32 v118, v68, v69
    v_cvt_pk_bf16_f32 v119, v70, v71
    v_mfma_f32_32x32x16_bf16 v[56:71], v[132:135], v[126:129], 0
    ds_read_b128 v[132:135], v27 offset:12288
    v_exp_f32 v40, v40
    v_exp_f32 v41, v41
    v_exp_f32 v42, v42
    v_exp_f32 v43, v43
    v_cvt_pk_bf16_f32 v104, v40, v41
    v_exp_f32 v44, v44
    v_mfma_f32_32x32x8_bf16 v[56:71], v[136:137], v[130:131], v[56:71]
    ds_read_b64 v[136:137], v29 offset:12288
    v_exp_f32 v45, v45
    v_cvt_pk_bf16_f32 v105, v42, v43
    v_exp_f32 v46, v46
    v_exp_f32 v47, v47
    v_cvt_pk_bf16_f32 v106, v44, v45
    v_exp_f32 v48, v48
    v_mfma_f32_32x32x16_bf16 v[88:103], v[152:155], v[112:115], v[88:103]
    ds_read_b64_tr_b16 v[152:153], v31 offset:9216
    v_exp_f32 v49, v49
    v_cvt_pk_bf16_f32 v107, v46, v47
    v_exp_f32 v50, v50
    v_exp_f32 v51, v51
    v_cvt_pk_bf16_f32 v108, v48, v49
    v_exp_f32 v52, v52
    v_mfma_f32_32x32x16_bf16 v[88:103], v[156:159], v[116:119], v[88:103]
    ds_read_b64_tr_b16 v[154:155], v31 offset:9344
    v_exp_f32 v53, v53
    v_cvt_pk_bf16_f32 v109, v50, v51
    v_exp_f32 v54, v54
    v_exp_f32 v55, v55
    v_cvt_pk_bf16_f32 v110, v52, v53
    v_cvt_pk_bf16_f32 v111, v54, v55
    v_mfma_f32_32x32x16_bf16 v[40:55], v[138:141], v[120:123], 0
    ds_read_b64_tr_b16 v[156:157], v31 offset:9472
    v_exp_f32 v56, v56
    v_exp_f32 v57, v57
    v_exp_f32 v58, v58
    v_exp_f32 v59, v59
    v_cvt_pk_bf16_f32 v112, v56, v57
    v_exp_f32 v60, v60
    v_mfma_f32_32x32x8_bf16 v[40:55], v[142:143], v[124:125], v[40:55]
    ds_read_b64_tr_b16 v[158:159], v31 offset:9600
    v_exp_f32 v61, v61
    v_cvt_pk_bf16_f32 v113, v58, v59
    v_exp_f32 v62, v62
    v_exp_f32 v63, v63
    v_cvt_pk_bf16_f32 v114, v60, v61
    v_exp_f32 v64, v64
    v_mfma_f32_32x32x16_bf16 v[72:87], v[144:147], v[104:107], v[72:87]
    v_exp_f32 v65, v65
    v_cvt_pk_bf16_f32 v115, v62, v63
    v_exp_f32 v66, v66
    v_exp_f32 v67, v67
    v_cvt_pk_bf16_f32 v116, v64, v65
    v_exp_f32 v68, v68
    v_mfma_f32_32x32x16_bf16 v[72:87], v[148:151], v[108:111], v[72:87]
    s_waitcnt lgkmcnt(0)
    v_exp_f32 v69, v69
    v_cvt_pk_bf16_f32 v117, v66, v67
    v_exp_f32 v70, v70
    v_exp_f32 v71, v71
    v_cvt_pk_bf16_f32 v118, v68, v69
    v_cvt_pk_bf16_f32 v119, v70, v71
    v_mfma_f32_32x32x16_bf16 v[56:71], v[138:141], v[126:129], 0
    ds_read_b128 v[138:141], v27 offset:15360
    v_exp_f32 v40, v40
    v_exp_f32 v41, v41
    v_exp_f32 v42, v42
    v_exp_f32 v43, v43
    v_cvt_pk_bf16_f32 v104, v40, v41
    v_exp_f32 v44, v44
    v_mfma_f32_32x32x8_bf16 v[56:71], v[142:143], v[130:131], v[56:71]
    ds_read_b64 v[142:143], v29 offset:15360
    v_exp_f32 v45, v45
    v_cvt_pk_bf16_f32 v105, v42, v43
    v_exp_f32 v46, v46
    v_exp_f32 v47, v47
    v_cvt_pk_bf16_f32 v106, v44, v45
    v_exp_f32 v48, v48
    v_mfma_f32_32x32x16_bf16 v[88:103], v[144:147], v[112:115], v[88:103]
    ds_read_b64_tr_b16 v[144:145], v31 offset:12288
    v_exp_f32 v49, v49
    v_cvt_pk_bf16_f32 v107, v46, v47
    v_exp_f32 v50, v50
    v_exp_f32 v51, v51
    v_cvt_pk_bf16_f32 v108, v48, v49
    v_exp_f32 v52, v52
    v_mfma_f32_32x32x16_bf16 v[88:103], v[148:151], v[116:119], v[88:103]
    ds_read_b64_tr_b16 v[146:147], v31 offset:12416
    v_exp_f32 v53, v53
    v_cvt_pk_bf16_f32 v109, v50, v51
    v_exp_f32 v54, v54
    v_exp_f32 v55, v55
    v_cvt_pk_bf16_f32 v110, v52, v53
    v_cvt_pk_bf16_f32 v111, v54, v55
    v_mfma_f32_32x32x16_bf16 v[40:55], v[132:135], v[120:123], 0
    ds_read_b64_tr_b16 v[148:149], v31 offset:12544
    v_exp_f32 v56, v56
    v_exp_f32 v57, v57
    v_exp_f32 v58, v58
    v_exp_f32 v59, v59
    v_cvt_pk_bf16_f32 v112, v56, v57
    v_exp_f32 v60, v60
    v_mfma_f32_32x32x8_bf16 v[40:55], v[136:137], v[124:125], v[40:55]
    ds_read_b64_tr_b16 v[150:151], v31 offset:12672
    v_exp_f32 v61, v61
    v_cvt_pk_bf16_f32 v113, v58, v59
    v_exp_f32 v62, v62
    v_exp_f32 v63, v63
    v_cvt_pk_bf16_f32 v114, v60, v61
    v_exp_f32 v64, v64
    v_mfma_f32_32x32x16_bf16 v[72:87], v[152:155], v[104:107], v[72:87]
    v_exp_f32 v65, v65
    v_cvt_pk_bf16_f32 v115, v62, v63
    v_exp_f32 v66, v66
    v_exp_f32 v67, v67
    v_cvt_pk_bf16_f32 v116, v64, v65
    v_exp_f32 v68, v68
    v_mfma_f32_32x32x16_bf16 v[72:87], v[156:159], v[108:111], v[72:87]
    s_waitcnt lgkmcnt(0)
    v_exp_f32 v69, v69
    v_cvt_pk_bf16_f32 v117, v66, v67
    v_exp_f32 v70, v70
    v_exp_f32 v71, v71
    v_cvt_pk_bf16_f32 v118, v68, v69
    v_cvt_pk_bf16_f32 v119, v70, v71
    v_mfma_f32_32x32x16_bf16 v[56:71], v[132:135], v[126:129], 0
    ds_read_b128 v[132:135], v27 offset:18432
    v_exp_f32 v40, v40
    v_exp_f32 v41, v41
    v_exp_f32 v42, v42
    v_exp_f32 v43, v43
    v_cvt_pk_bf16_f32 v104, v40, v41
    v_exp_f32 v44, v44
    v_mfma_f32_32x32x8_bf16 v[56:71], v[136:137], v[130:131], v[56:71]
    ds_read_b64 v[136:137], v29 offset:18432
    v_exp_f32 v45, v45
    v_cvt_pk_bf16_f32 v105, v42, v43
    v_exp_f32 v46, v46
    v_exp_f32 v47, v47
    v_cvt_pk_bf16_f32 v106, v44, v45
    v_exp_f32 v48, v48
    v_mfma_f32_32x32x16_bf16 v[88:103], v[152:155], v[112:115], v[88:103]
    ds_read_b64_tr_b16 v[152:153], v31 offset:15360
    v_exp_f32 v49, v49
    v_cvt_pk_bf16_f32 v107, v46, v47
    v_exp_f32 v50, v50
    v_exp_f32 v51, v51
    v_cvt_pk_bf16_f32 v108, v48, v49
    v_exp_f32 v52, v52
    v_mfma_f32_32x32x16_bf16 v[88:103], v[156:159], v[116:119], v[88:103]
    ds_read_b64_tr_b16 v[154:155], v31 offset:15488
    v_exp_f32 v53, v53
    v_cvt_pk_bf16_f32 v109, v50, v51
    v_exp_f32 v54, v54
    v_exp_f32 v55, v55
    v_cvt_pk_bf16_f32 v110, v52, v53
    v_cvt_pk_bf16_f32 v111, v54, v55
    v_mfma_f32_32x32x16_bf16 v[40:55], v[138:141], v[120:123], 0
    ds_read_b64_tr_b16 v[156:157], v31 offset:15616
    v_exp_f32 v56, v56
    v_exp_f32 v57, v57
    v_exp_f32 v58, v58
    v_exp_f32 v59, v59
    v_cvt_pk_bf16_f32 v112, v56, v57
    v_exp_f32 v60, v60
    v_mfma_f32_32x32x8_bf16 v[40:55], v[142:143], v[124:125], v[40:55]
    ds_read_b64_tr_b16 v[158:159], v31 offset:15744
    v_exp_f32 v61, v61
    v_cvt_pk_bf16_f32 v113, v58, v59
    v_exp_f32 v62, v62
    v_exp_f32 v63, v63
    v_cvt_pk_bf16_f32 v114, v60, v61
    v_exp_f32 v64, v64
    v_mfma_f32_32x32x16_bf16 v[72:87], v[144:147], v[104:107], v[72:87]
    v_exp_f32 v65, v65
    v_cvt_pk_bf16_f32 v115, v62, v63
    v_exp_f32 v66, v66
    v_exp_f32 v67, v67
    v_cvt_pk_bf16_f32 v116, v64, v65
    v_exp_f32 v68, v68
    v_mfma_f32_32x32x16_bf16 v[72:87], v[148:151], v[108:111], v[72:87]
    s_waitcnt lgkmcnt(0)
    s_setprio 0
    v_exp_f32 v69, v69
    v_cvt_pk_bf16_f32 v117, v66, v67
    v_exp_f32 v70, v70
    v_exp_f32 v71, v71
    v_cvt_pk_bf16_f32 v118, v68, v69
    v_cvt_pk_bf16_f32 v119, v70, v71
    v_mfma_f32_32x32x16_bf16 v[56:71], v[138:141], v[126:129], 0
    ds_read_b128 v[138:141], v27 offset:21504
    v_exp_f32 v40, v40
    v_exp_f32 v41, v41
    v_exp_f32 v42, v42
    v_exp_f32 v43, v43
    v_cvt_pk_bf16_f32 v104, v40, v41
    v_exp_f32 v44, v44
    v_mfma_f32_32x32x8_bf16 v[56:71], v[142:143], v[130:131], v[56:71]
    ds_read_b64 v[142:143], v29 offset:21504
    v_exp_f32 v45, v45
    v_cvt_pk_bf16_f32 v105, v42, v43
    v_exp_f32 v46, v46
    v_exp_f32 v47, v47
    v_cvt_pk_bf16_f32 v106, v44, v45
    v_exp_f32 v48, v48
    v_mfma_f32_32x32x16_bf16 v[88:103], v[144:147], v[112:115], v[88:103]
    ds_read_b64_tr_b16 v[144:145], v31 offset:18432
    v_exp_f32 v49, v49
    v_cvt_pk_bf16_f32 v107, v46, v47
    v_exp_f32 v50, v50
    v_exp_f32 v51, v51
    v_cvt_pk_bf16_f32 v108, v48, v49
    v_exp_f32 v52, v52
    v_mfma_f32_32x32x16_bf16 v[88:103], v[148:151], v[116:119], v[88:103]
    ds_read_b64_tr_b16 v[146:147], v31 offset:18560
    v_exp_f32 v53, v53
    v_cvt_pk_bf16_f32 v109, v50, v51
    v_exp_f32 v54, v54
    v_exp_f32 v55, v55
    v_cvt_pk_bf16_f32 v110, v52, v53
    v_cvt_pk_bf16_f32 v111, v54, v55
    v_mfma_f32_32x32x16_bf16 v[40:55], v[132:135], v[120:123], 0
    ds_read_b64_tr_b16 v[148:149], v31 offset:18688
    v_exp_f32 v56, v56
    v_exp_f32 v57, v57
    v_exp_f32 v58, v58
    v_exp_f32 v59, v59
    v_cvt_pk_bf16_f32 v112, v56, v57
    v_exp_f32 v60, v60
    v_mfma_f32_32x32x8_bf16 v[40:55], v[136:137], v[124:125], v[40:55]
    ds_read_b64_tr_b16 v[150:151], v31 offset:18816
    v_exp_f32 v61, v61
    v_cvt_pk_bf16_f32 v113, v58, v59
    v_exp_f32 v62, v62
    v_exp_f32 v63, v63
    v_cvt_pk_bf16_f32 v114, v60, v61
    v_exp_f32 v64, v64
    v_mfma_f32_32x32x16_bf16 v[72:87], v[152:155], v[104:107], v[72:87]
    v_exp_f32 v65, v65
    v_cvt_pk_bf16_f32 v115, v62, v63
    v_exp_f32 v66, v66
    v_exp_f32 v67, v67
    v_cvt_pk_bf16_f32 v116, v64, v65
    v_exp_f32 v68, v68
    v_mfma_f32_32x32x16_bf16 v[72:87], v[156:159], v[108:111], v[72:87]
    s_waitcnt vmcnt(0) lgkmcnt(0)
    s_barrier
    s_setprio 1
    s_cmp_eq_u32 s55, 0
    s_cbranch_scc1 L_mega_kernel_ool_40
L_mega_kernel_back_41:
    v_exp_f32 v69, v69
    v_cvt_pk_bf16_f32 v117, v66, v67
    v_exp_f32 v70, v70
    v_exp_f32 v71, v71
    v_cvt_pk_bf16_f32 v118, v68, v69
    v_cvt_pk_bf16_f32 v119, v70, v71
    v_mfma_f32_32x32x16_bf16 v[56:71], v[132:135], v[126:129], 0
    ds_read_b128 v[132:135], v27 offset:24576
    v_exp_f32 v40, v40
    v_exp_f32 v41, v41
    v_exp_f32 v42, v42
    v_exp_f32 v43, v43
    v_cvt_pk_bf16_f32 v104, v40, v41
    v_exp_f32 v44, v44
    v_mfma_f32_32x32x8_bf16 v[56:71], v[136:137], v[130:131], v[56:71]
    ds_read_b64 v[136:137], v29 offset:24576
    s_add_u32 m0, s29, 0
    s_nop 0
    buffer_load_dwordx4 v3, s[4:7], s28 offen sc1 lds
    s_add_u32 s28, s28, 4096
    v_exp_f32 v45, v45
    v_cvt_pk_bf16_f32 v105, v42, v43
    v_exp_f32 v46, v46
    v_exp_f32 v47, v47
    v_cvt_pk_bf16_f32 v106, v44, v45
    v_exp_f32 v48, v48
    v_mfma_f32_32x32x16_bf16 v[88:103], v[152:155], v[112:115], v[88:103]
    ds_read_b64_tr_b16 v[152:153], v31 offset:21504
    v_exp_f32 v49, v49
    v_cvt_pk_bf16_f32 v107, v46, v47
    v_exp_f32 v50, v50
    v_exp_f32 v51, v51
    v_cvt_pk_bf16_f32 v108, v48, v49
    v_exp_f32 v52, v52
    v_mfma_f32_32x32x16_bf16 v[88:103], v[156:159], v[116:119], v[88:103]
    ds_read_b64_tr_b16 v[154:155], v31 offset:21632
    s_add_u32 m0, s29, 4096
    s_nop 0
    buffer_load_dwordx4 v3, s[4:7], s28 offen sc1 lds
    s_add_u32 s28, s28, 4096
    v_exp_f32 v53, v53
    v_cvt_pk_bf16_f32 v109, v50, v51
    v_exp_f32 v54, v54
    v_exp_f32 v55, v55
    v_cvt_pk_bf16_f32 v110, v52, v53
    v_cvt_pk_bf16_f32 v111, v54, v55
    v_mfma_f32_32x32x16_bf16 v[40:55], v[138:141], v[120:123], 0
    ds_read_b64_tr_b16 v[156:157], v31 offset:21760
    v_exp_f32 v56, v56
    v_exp_f32 v57, v57
    v_exp_f32 v58, v58
    v_exp_f32 v59, v59
    v_cvt_pk_bf16_f32 v112, v56, v57
    v_exp_f32 v60, v60
    v_mfma_f32_32x32x8_bf16 v[40:55], v[142:143], v[124:125], v[40:55]
    ds_read_b64_tr_b16 v[158:159], v31 offset:21888
    s_add_u32 m0, s29, 8192
    s_nop 0
    buffer_load_dwordx4 v3, s[4:7], s28 offen sc1 lds
    s_add_u32 s28, s28, 4096
    v_exp_f32 v61, v61
    v_cvt_pk_bf16_f32 v113, v58, v59
    v_exp_f32 v62, v62
    v_exp_f32 v63, v63
    v_cvt_pk_bf16_f32 v114, v60, v61
    v_exp_f32 v64, v64
    v_mfma_f32_32x32x16_bf16 v[72:87], v[144:147], v[104:107], v[72:87]
    s_add_u32 m0, s29, 12288
    s_nop 0
    buffer_load_dwordx4 v3, s[4:7], s28 offen sc1 lds
    s_add_u32 s28, s28, 4096
    v_exp_f32 v65, v65
    v_cvt_pk_bf16_f32 v115, v62, v63
    v_exp_f32 v66, v66
    v_exp_f32 v67, v67
    v_cvt_pk_bf16_f32 v116, v64, v65
    v_exp_f32 v68, v68
    v_mfma_f32_32x32x16_bf16 v[72:87], v[148:151], v[108:111], v[72:87]
    s_waitcnt lgkmcnt(0)
    v_exp_f32 v69, v69
    v_cvt_pk_bf16_f32 v117, v66, v67
    v_exp_f32 v70, v70
    v_exp_f32 v71, v71
    v_cvt_pk_bf16_f32 v118, v68, v69
    v_cvt_pk_bf16_f32 v119, v70, v71
    v_mfma_f32_32x32x16_bf16 v[56:71], v[138:141], v[126:129], 0
    ds_read_b128 v[138:141], v27 offset:27648
    v_exp_f32 v40, v40
    v_exp_f32 v41, v41
    v_exp_f32 v42, v42
    v_exp_f32 v43, v43
    v_cvt_pk_bf16_f32 v104, v40, v41
    v_exp_f32 v44, v44
    v_mfma_f32_32x32x8_bf16 v[56:71], v[142:143], v[130:131], v[56:71]
    ds_read_b64 v[142:143], v29 offset:27648
    s_add_u32 m0, s29, 16384
    s_nop 0
    buffer_load_dwordx4 v3, s[4:7], s28 offen sc1 lds
    s_add_u32 s28, s28, 4096
    v_exp_f32 v45, v45
    v_cvt_pk_bf16_f32 v105, v42, v43
    v_exp_f32 v46, v46
    v_exp_f32 v47, v47
    v_cvt_pk_bf16_f32 v106, v44, v45
    v_exp_f32 v48, v48
    v_mfma_f32_32x32x16_bf16 v[88:103], v[144:147], v[112:115], v[88:103]
    ds_read_b64_tr_b16 v[144:145], v31 offset:24576
    v_exp_f32 v49, v49
    v_cvt_pk_bf16_f32 v107, v46, v47
    v_exp_f32 v50, v50
    v_exp_f32 v51, v51
    v_cvt_pk_bf16_f32 v108, v48, v49
    v_exp_f32 v52, v52
    v_mfma_f32_32x32x16_bf16 v[88:103], v[148:151], v[116:119], v[88:103]
    ds_read_b64_tr_b16 v[146:147], v31 offset:24704
    s_add_u32 m0, s29, 20480
    s_nop 0
    buffer_load_dwordx4 v3, s[4:7], s28 offen sc1 lds
    s_add_u32 s28, s28, 4096
    v_exp_f32 v53, v53
    v_cvt_pk_bf16_f32 v109, v50, v51
    v_exp_f32 v54, v54
    v_exp_f32 v55, v55
    v_cvt_pk_bf16_f32 v110, v52, v53
    v_cvt_pk_bf16_f32 v111, v54, v55
    v_mfma_f32_32x32x16_bf16 v[40:55], v[132:135], v[120:123], 0
    ds_read_b64_tr_b16 v[148:149], v31 offset:24832
    v_exp_f32 v56, v56
    v_exp_f32 v57, v57
    v_exp_f32 v58, v58
    v_exp_f32 v59, v59
    v_cvt_pk_bf16_f32 v112, v56, v57
    v_exp_f32 v60, v60
    v_mfma_f32_32x32x8_bf16 v[40:55], v[136:137], v[124:125], v[40:55]
    ds_read_b64_tr_b16 v[150:151], v31 offset:24960
    v_exp_f32 v61, v61
    v_cvt_pk_bf16_f32 v113, v58, v59
    v_exp_f32 v62, v62
    v_exp_f32 v63, v63
    v_cvt_pk_bf16_f32 v114, v60, v61
    v_exp_f32 v64, v64
    v_mfma_f32_32x32x16_bf16 v[72:87], v[152:155], v[104:107], v[72:87]
    v_exp_f32 v65, v65
    v_cvt_pk_bf16_f32 v115, v62, v63
    v_exp_f32 v66, v66
    v_exp_f32 v67, v67
    v_cvt_pk_bf16_f32 v116, v64, v65
    v_exp_f32 v68, v68
    v_mfma_f32_32x32x16_bf16 v[72:87], v[156:159], v[108:111], v[72:87]
    s_waitcnt lgkmcnt(0)
    v_exp_f32 v69, v69
    v_cvt_pk_bf16_f32 v117, v66, v67
    v_exp_f32 v70, v70
    v_exp_f32 v71, v71
    v_cvt_pk_bf16_f32 v118, v68, v69
    v_cvt_pk_bf16_f32 v119, v70, v71
    v_mfma_f32_32x32x16_bf16 v[56:71], v[132:135], v[126:129], 0
    ds_read_b128 v[132:135], v27 offset:30720
    v_exp_f32 v40, v40
    v_exp_f32 v41, v41
    v_exp_f32 v42, v42
    v_exp_f32 v43, v43
    v_cvt_pk_bf16_f32 v104, v40, v41
    v_exp_f32 v44, v44
    v_mfma_f32_32x32x8_bf16 v[56:71], v[136:137], v[130:131], v[56:71]
    ds_read_b64 v[136:137], v29 offset:30720
    v_exp_f32 v45, v45
    v_cvt_pk_bf16_f32 v105, v42, v43
    v_exp_f32 v46, v46
    v_exp_f32 v47, v47
    v_cvt_pk_bf16_f32 v106, v44, v45
    v_exp_f32 v48, v48
    v_mfma_f32_32x32x16_bf16 v[88:103], v[152:155], v[112:115], v[88:103]
    ds_read_b64_tr_b16 v[152:153], v31 offset:27648
    v_exp_f32 v49, v49
    v_cvt_pk_bf16_f32 v107, v46, v47
    v_exp_f32 v50, v50
    v_exp_f32 v51, v51
    v_cvt_pk_bf16_f32 v108, v48, v49
    v_exp_f32 v52, v52
    v_mfma_f32_32x32x16_bf16 v[88:103], v[156:159], v[116:119], v[88:103]
    ds_read_b64_tr_b16 v[154:155], v31 offset:27776
    v_exp_f32 v53, v53
    v_cvt_pk_bf16_f32 v109, v50, v51
    v_exp_f32 v54, v54
    v_exp_f32 v55, v55
    v_cvt_pk_bf16_f32 v110, v52, v53
    v_cvt_pk_bf16_f32 v111, v54, v55
    v_mfma_f32_32x32x16_bf16 v[40:55], v[138:141], v[120:123], 0
    ds_read_b64_tr_b16 v[156:157], v31 offset:27904
    v_exp_f32 v56, v56
    v_exp_f32 v57, v57
    v_exp_f32 v58, v58
    v_exp_f32 v59, v59
    v_cvt_pk_bf16_f32 v112, v56, v57
    v_exp_f32 v60, v60
    v_mfma_f32_32x32x8_bf16 v[40:55], v[142:143], v[124:125], v[40:55]
    ds_read_b64_tr_b16 v[158:159], v31 offset:28032
    v_exp_f32 v61, v61
    v_cvt_pk_bf16_f32 v113, v58, v59
    v_exp_f32 v62, v62
    v_exp_f32 v63, v63
    v_cvt_pk_bf16_f32 v114, v60, v61
    v_exp_f32 v64, v64
    v_mfma_f32_32x32x16_bf16 v[72:87], v[144:147], v[104:107], v[72:87]
    v_exp_f32 v65, v65
    v_cvt_pk_bf16_f32 v115, v62, v63
    v_exp_f32 v66, v66
    v_exp_f32 v67, v67
    v_cvt_pk_bf16_f32 v116, v64, v65
    v_exp_f32 v68, v68
    v_mfma_f32_32x32x16_bf16 v[72:87], v[148:151], v[108:111], v[72:87]
    s_waitcnt lgkmcnt(0)
    s_setprio 0
    v_exp_f32 v69, v69
    v_cvt_pk_bf16_f32 v117, v66, v67
    v_exp_f32 v70, v70
    v_exp_f32 v71, v71
    v_cvt_pk_bf16_f32 v118, v68, v69
    v_cvt_pk_bf16_f32 v119, v70, v71
    v_mfma_f32_32x32x16_bf16 v[56:71], v[138:141], v[126:129], 0
    ds_read_b128 v[138:141], v27 offset:33792
    v_exp_f32 v40, v40
    v_exp_f32 v41, v41
    v_exp_f32 v42, v42
    v_exp_f32 v43, v43
    v_cvt_pk_bf16_f32 v104, v40, v41
    v_exp_f32 v44, v44
    v_mfma_f32_32x32x8_bf16 v[56:71], v[142:143], v[130:131], v[56:71]
    ds_read_b64 v[142:143], v29 offset:33792
    v_exp_f32 v45, v45
    v_cvt_pk_bf16_f32 v105, v42, v43
    v_exp_f32 v46, v46
    v_exp_f32 v47, v47
    v_cvt_pk_bf16_f32 v106, v44, v45
    v_exp_f32 v48, v48
    v_mfma_f32_32x32x16_bf16 v[88:103], v[144:147], v[112:115], v[88:103]
    ds_read_b64_tr_b16 v[144:145], v31 offset:30720
    v_exp_f32 v49, v49
    v_cvt_pk_bf16_f32 v107, v46, v47
    v_exp_f32 v50, v50
    v_exp_f32 v51, v51
    v_cvt_pk_bf16_f32 v108, v48, v49
    v_exp_f32 v52, v52
    v_mfma_f32_32x32x16_bf16 v[88:103], v[148:151], v[116:119], v[88:103]
    ds_read_b64_tr_b16 v[146:147], v31 offset:30848
    v_exp_f32 v53, v53
    v_cvt_pk_bf16_f32 v109, v50, v51
    v_exp_f32 v54, v54
    v_exp_f32 v55, v55
    v_cvt_pk_bf16_f32 v110, v52, v53
    v_cvt_pk_bf16_f32 v111, v54, v55
    v_mfma_f32_32x32x16_bf16 v[40:55], v[132:135], v[120:123], 0
    ds_read_b64_tr_b16 v[148:149], v31 offset:30976
    v_exp_f32 v56, v56
    v_exp_f32 v57, v57
    v_exp_f32 v58, v58
    v_exp_f32 v59, v59
    v_cvt_pk_bf16_f32 v112, v56, v57
    v_exp_f32 v60, v60
    v_mfma_f32_32x32x8_bf16 v[40:55], v[136:137], v[124:125], v[40:55]
    ds_read_b64_tr_b16 v[150:151], v31 offset:31104
    v_exp_f32 v61, v61
    v_cvt_pk_bf16_f32 v113, v58, v59
    v_exp_f32 v62, v62
    v_exp_f32 v63, v63
    v_cvt_pk_bf16_f32 v114, v60, v61
    v_exp_f32 v64, v64
    v_mfma_f32_32x32x16_bf16 v[72:87], v[152:155], v[104:107], v[72:87]
    v_exp_f32 v65, v65
    v_cvt_pk_bf16_f32 v115, v62, v63
    v_exp_f32 v66, v66
    v_exp_f32 v67, v67
    v_cvt_pk_bf16_f32 v116, v64, v65
    v_exp_f32 v68, v68
    v_mfma_f32_32x32x16_bf16 v[72:87], v[156:159], v[108:111], v[72:87]
    s_cmp_eq_u32 s55, 0
    s_cbranch_scc1 L_mega_kernel_ool_42
L_mega_kernel_back_43:
    s_waitcnt vmcnt(0) lgkmcnt(0)
    s_barrier
    s_setprio 1
    s_cmp_ge_u32 s22, 4
    s_cbranch_scc1 L_mega_kernel_ool_44
L_mega_kernel_back_45:
    v_exp_f32 v69, v69
    v_cvt_pk_bf16_f32 v117, v66, v67
    v_exp_f32 v70, v70
    v_exp_f32 v71, v71
    v_cvt_pk_bf16_f32 v118, v68, v69
    v_cvt_pk_bf16_f32 v119, v70, v71
    v_mfma_f32_32x32x16_bf16 v[56:71], v[132:135], v[126:129], 0
    ds_read_b128 v[132:135], v26 offset:0
    v_exp_f32 v40, v40
    v_exp_f32 v41, v41
    v_exp_f32 v42, v42
    v_exp_f32 v43, v43
    v_cvt_pk_bf16_f32 v104, v40, v41
    v_exp_f32 v44, v44
    v_mfma_f32_32x32x8_bf16 v[56:71], v[136:137], v[130:131], v[56:71]
    ds_read_b64 v[136:137], v28 offset:0
    v_exp_f32 v45, v45
    v_cvt_pk_bf16_f32 v105, v42, v43
    v_exp_f32 v46, v46
    v_exp_f32 v47, v47
    v_cvt_pk_bf16_f32 v106, v44, v45
    v_exp_f32 v48, v48
    v_mfma_f32_32x32x16_bf16 v[88:103], v[152:155], v[112:115], v[88:103]
    ds_read_b64_tr_b16 v[152:153], v31 offset:33792
    v_exp_f32 v49, v49
    v_cvt_pk_bf16_f32 v107, v46, v47
    v_exp_f32 v50, v50
    v_exp_f32 v51, v51
    v_cvt_pk_bf16_f32 v108, v48, v49
    v_exp_f32 v52, v52
    v_mfma_f32_32x32x16_bf16 v[88:103], v[156:159], v[116:119], v[88:103]
    ds_read_b64_tr_b16 v[154:155], v31 offset:33920
    v_exp_f32 v53, v53
    v_cvt_pk_bf16_f32 v109, v50, v51
    v_exp_f32 v54, v54
    v_exp_f32 v55, v55
    v_cvt_pk_bf16_f32 v110, v52, v53
    v_cvt_pk_bf16_f32 v111, v54, v55
    v_mfma_f32_32x32x16_bf16 v[40:55], v[138:141], v[120:123], 0
    ds_read_b64_tr_b16 v[156:157], v31 offset:34048
    v_exp_f32 v56, v56
    v_exp_f32 v57, v57
    v_exp_f32 v58, v58
    v_exp_f32 v59, v59
    v_cvt_pk_bf16_f32 v112, v56, v57
    v_exp_f32 v60, v60
    v_mfma_f32_32x32x8_bf16 v[40:55], v[142:143], v[124:125], v[40:55]
    ds_read_b64_tr_b16 v[158:159], v31 offset:34176
    v_exp_f32 v61, v61
    v_cvt_pk_bf16_f32 v113, v58, v59
    v_exp_f32 v62, v62
    v_exp_f32 v63, v63
    v_cvt_pk_bf16_f32 v114, v60, v61
    v_exp_f32 v64, v64
    v_mfma_f32_32x32x16_bf16 v[72:87], v[144:147], v[104:107], v[72:87]
    v_exp_f32 v65, v65
    v_cvt_pk_bf16_f32 v115, v62, v63
    v_exp_f32 v66, v66
    v_exp_f32 v67, v67
    v_cvt_pk_bf16_f32 v116, v64, v65
    v_exp_f32 v68, v68
    v_mfma_f32_32x32x16_bf16 v[72:87], v[148:151], v[108:111], v[72:87]
    s_waitcnt lgkmcnt(0)
    v_exp_f32 v69, v69
    v_cvt_pk_bf16_f32 v117, v66, v67
    v_exp_f32 v70, v70
    v_exp_f32 v71, v71
    v_cvt_pk_bf16_f32 v118, v68, v69
    v_cvt_pk_bf16_f32 v119, v70, v71
    v_mfma_f32_32x32x16_bf16 v[56:71], v[138:141], v[126:129], 0
    ds_read_b128 v[138:141], v26 offset:3072
    v_exp_f32 v40, v40
    v_exp_f32 v41, v41
    v_exp_f32 v42, v42
    v_exp_f32 v43, v43
    v_cvt_pk_bf16_f32 v104, v40, v41
    v_exp_f32 v44, v44
    v_mfma_f32_32x32x8_bf16 v[56:71], v[142:143], v[130:131], v[56:71]
    ds_read_b64 v[142:143], v28 offset:3072
    v_exp_f32 v45, v45
    v_cvt_pk_bf16_f32 v105, v42, v43
    v_exp_f32 v46, v46
    v_exp_f32 v47, v47
    v_cvt_pk_bf16_f32 v106, v44, v45
    v_exp_f32 v48, v48
    v_mfma_f32_32x32x16_bf16 v[88:103], v[144:147], v[112:115], v[88:103]
    ds_read_b64_tr_b16 v[144:145], v30 offset:0
    v_exp_f32 v49, v49
    v_cvt_pk_bf16_f32 v107, v46, v47
    v_exp_f32 v50, v50
    v_exp_f32 v51, v51
    v_cvt_pk_bf16_f32 v108, v48, v49
    v_exp_f32 v52, v52
    v_mfma_f32_32x32x16_bf16 v[88:103], v[148:151], v[116:119], v[88:103]
    ds_read_b64_tr_b16 v[146:147], v30 offset:128
    v_exp_f32 v53, v53
    v_cvt_pk_bf16_f32 v109, v50, v51
    v_exp_f32 v54, v54
    v_exp_f32 v55, v55
    v_cvt_pk_bf16_f32 v110, v52, v53
    v_cvt_pk_bf16_f32 v111, v54, v55
    v_mfma_f32_32x32x16_bf16 v[40:55], v[132:135], v[120:123], 0
    ds_read_b64_tr_b16 v[148:149], v30 offset:256
    v_exp_f32 v56, v56
    v_exp_f32 v57, v57
    v_exp_f32 v58, v58
    v_exp_f32 v59, v59
    v_cvt_pk_bf16_f32 v112, v56, v57
    v_exp_f32 v60, v60
    v_mfma_f32_32x32x8_bf16 v[40:55], v[136:137], v[124:125], v[40:55]
    ds_read_b64_tr_b16 v[150:151], v30 offset:384
    v_exp_f32 v61, v61
    v_cvt_pk_bf16_f32 v113, v58, v59
    v_exp_f32 v62, v62
    v_exp_f32 v63, v63
    v_cvt_pk_bf16_f32 v114, v60, v61
    v_exp_f32 v64, v64
    v_mfma_f32_32x32x16_bf16 v[72:87], v[152:155], v[104:107], v[72:87]
    v_exp_f32 v65, v65
    v_cvt_pk_bf16_f32 v115, v62, v63
    v_exp_f32 v66, v66
    v_exp_f32 v67, v67
    v_cvt_pk_bf16_f32 v116, v64, v65
    v_exp_f32 v68, v68
    v_mfma_f32_32x32x16_bf16 v[72:87], v[156:159], v[108:111], v[72:87]
    s_waitcnt lgkmcnt(0)
    v_exp_f32 v69, v69
    v_cvt_pk_bf16_f32 v117, v66, v67
    v_exp_f32 v70, v70
    v_exp_f32 v71, v71
    v_cvt_pk_bf16_f32 v118, v68, v69
    v_cvt_pk_bf16_f32 v119, v70, v71
    v_mfma_f32_32x32x16_bf16 v[56:71], v[132:135], v[126:129], 0
    ds_read_b128 v[132:135], v26 offset:6144
    v_exp_f32 v40, v40
    v_exp_f32 v41, v41
    v_exp_f32 v42, v42
    v_exp_f32 v43, v43
    v_cvt_pk_bf16_f32 v104, v40, v41
    v_exp_f32 v44, v44
    v_mfma_f32_32x32x8_bf16 v[56:71], v[136:137], v[130:131], v[56:71]
    ds_read_b64 v[136:137], v28 offset:6144
    v_exp_f32 v45, v45
    v_cvt_pk_bf16_f32 v105, v42, v43
    v_exp_f32 v46, v46
    v_exp_f32 v47, v47
    v_cvt_pk_bf16_f32 v106, v44, v45
    v_exp_f32 v48, v48
    v_mfma_f32_32x32x16_bf16 v[88:103], v[152:155], v[112:115], v[88:103]
    ds_read_b64_tr_b16 v[152:153], v30 offset:3072
    v_exp_f32 v49, v49
    v_cvt_pk_bf16_f32 v107, v46, v47
    v_exp_f32 v50, v50
    v_exp_f32 v51, v51
    v_cvt_pk_bf16_f32 v108, v48, v49
    v_exp_f32 v52, v52
    v_mfma_f32_32x32x16_bf16 v[88:103], v[156:159], v[116:119], v[88:103]
    ds_read_b64_tr_b16 v[154:155], v30 offset:3200
    v_exp_f32 v53, v53
    v_cvt_pk_bf16_f32 v109, v50, v51
    v_exp_f32 v54, v54
    v_exp_f32 v55, v55
    v_cvt_pk_bf16_f32 v110, v52, v53
    v_cvt_pk_bf16_f32 v111, v54, v55
    v_mfma_f32_32x32x16_bf16 v[40:55], v[138:141], v[120:123], 0
    ds_read_b64_tr_b16 v[156:157], v30 offset:3328
    v_exp_f32 v56, v56
    v_exp_f32 v57, v57
    v_exp_f32 v58, v58
    v_exp_f32 v59, v59
    v_cvt_pk_bf16_f32 v112, v56, v57
    v_exp_f32 v60, v60
    v_mfma_f32_32x32x8_bf16 v[40:55], v[142:143], v[124:125], v[40:55]
    ds_read_b64_tr_b16 v[158:159], v30 offset:3456
    v_exp_f32 v61, v61
    v_cvt_pk_bf16_f32 v113, v58, v59
    v_exp_f32 v62, v62
    v_exp_f32 v63, v63
    v_cvt_pk_bf16_f32 v114, v60, v61
    v_exp_f32 v64, v64
    v_mfma_f32_32x32x16_bf16 v[72:87], v[144:147], v[104:107], v[72:87]
    v_exp_f32 v65, v65
    v_cvt_pk_bf16_f32 v115, v62, v63
    v_exp_f32 v66, v66
    v_exp_f32 v67, v67
    v_cvt_pk_bf16_f32 v116, v64, v65
    v_exp_f32 v68, v68
    v_mfma_f32_32x32x16_bf16 v[72:87], v[148:151], v[108:111], v[72:87]
    s_waitcnt lgkmcnt(0)
    v_exp_f32 v69, v69
    v_cvt_pk_bf16_f32 v117, v66, v67
    v_exp_f32 v70, v70
    v_exp_f32 v71, v71
    v_cvt_pk_bf16_f32 v118, v68, v69
    v_cvt_pk_bf16_f32 v119, v70, v71
    v_mfma_f32_32x32x16_bf16 v[56:71], v[138:141], v[126:129], 0
    ds_read_b128 v[138:141], v26 offset:9216
    v_exp_f32 v40, v40
    v_exp_f32 v41, v41
    v_exp_f32 v42, v42
    v_exp_f32 v43, v43
    v_cvt_pk_bf16_f32 v104, v40, v41
    v_exp_f32 v44, v44
    v_mfma_f32_32x32x8_bf16 v[56:71], v[142:143], v[130:131], v[56:71]
    ds_read_b64 v[142:143], v28 offset:9216
    v_exp_f32 v45, v45
    v_cvt_pk_bf16_f32 v105, v42, v43
    v_exp_f32 v46, v46
    v_exp_f32 v47, v47
    v_cvt_pk_bf16_f32 v106, v44, v45
    v_exp_f32 v48, v48
    v_mfma_f32_32x32x16_bf16 v[88:103], v[144:147], v[112:115], v[88:103]
    ds_read_b64_tr_b16 v[144:145], v30 offset:6144
    v_exp_f32 v49, v49
    v_cvt_pk_bf16_f32 v107, v46, v47
    v_exp_f32 v50, v50
    v_exp_f32 v51, v51
    v_cvt_pk_bf16_f32 v108, v48, v49
    v_exp_f32 v52, v52
    v_mfma_f32_32x32x16_bf16 v[88:103], v[148:151], v[116:119], v[88:103]
    ds_read_b64_tr_b16 v[146:147], v30 offset:6272
    v_exp_f32 v53, v53
    v_cvt_pk_bf16_f32 v109, v50, v51
    v_exp_f32 v54, v54
    v_exp_f32 v55, v55
    v_cvt_pk_bf16_f32 v110, v52, v53
    v_cvt_pk_bf16_f32 v111, v54, v55
    v_mfma_f32_32x32x16_bf16 v[40:55], v[132:135], v[120:123], 0
    ds_read_b64_tr_b16 v[148:149], v30 offset:6400
    v_exp_f32 v56, v56
    v_exp_f32 v57, v57
    v_exp_f32 v58, v58
    v_exp_f32 v59, v59
    v_cvt_pk_bf16_f32 v112, v56, v57
    v_exp_f32 v60, v60
    v_mfma_f32_32x32x8_bf16 v[40:55], v[136:137], v[124:125], v[40:55]
    ds_read_b64_tr_b16 v[150:151], v30 offset:6528
    v_exp_f32 v61, v61
    v_cvt_pk_bf16_f32 v113, v58, v59
    v_exp_f32 v62, v62
    v_exp_f32 v63, v63
    v_cvt_pk_bf16_f32 v114, v60, v61
    v_exp_f32 v64, v64
    v_mfma_f32_32x32x16_bf16 v[72:87], v[152:155], v[104:107], v[72:87]
    v_exp_f32 v65, v65
    v_cvt_pk_bf16_f32 v115, v62, v63
    v_exp_f32 v66, v66
    v_exp_f32 v67, v67
    v_cvt_pk_bf16_f32 v116, v64, v65
    v_exp_f32 v68, v68
    v_mfma_f32_32x32x16_bf16 v[72:87], v[156:159], v[108:111], v[72:87]
    s_waitcnt lgkmcnt(0)
    s_setprio 0
    s_cmp_eq_u32 s55, 0
    s_cbranch_scc1 L_mega_kernel_ool_46
L_mega_kernel_back_47:
    v_exp_f32 v69, v69
    v_cvt_pk_bf16_f32 v117, v66, v67
    v_exp_f32 v70, v70
    v_exp_f32 v71, v71
    v_cvt_pk_bf16_f32 v118, v68, v69
    v_cvt_pk_bf16_f32 v119, v70, v71
    v_mfma_f32_32x32x16_bf16 v[56:71], v[132:135], v[126:129], 0
    ds_read_b128 v[132:135], v26 offset:12288
    v_exp_f32 v40, v40
    v_exp_f32 v41, v41
    v_exp_f32 v42, v42
    v_exp_f32 v43, v43
    v_cvt_pk_bf16_f32 v104, v40, v41
    v_exp_f32 v44, v44
    v_mfma_f32_32x32x8_bf16 v[56:71], v[136:137], v[130:131], v[56:71]
    ds_read_b64 v[136:137], v28 offset:12288
    v_exp_f32 v45, v45
    v_cvt_pk_bf16_f32 v105, v42, v43
    v_exp_f32 v46, v46
    v_exp_f32 v47, v47
    v_cvt_pk_bf16_f32 v106, v44, v45
    v_exp_f32 v48, v48
    v_mfma_f32_32x32x16_bf16 v[88:103], v[152:155], v[112:115], v[88:103]
    ds_read_b64_tr_b16 v[152:153], v30 offset:9216
    v_exp_f32 v49, v49
    v_cvt_pk_bf16_f32 v107, v46, v47
    v_exp_f32 v50, v50
    v_exp_f32 v51, v51
    v_cvt_pk_bf16_f32 v108, v48, v49
    v_exp_f32 v52, v52
    v_mfma_f32_32x32x16_bf16 v[88:103], v[156:159], v[116:119], v[88:103]
    ds_read_b64_tr_b16 v[154:155], v30 offset:9344
    v_exp_f32 v53, v53
    v_cvt_pk_bf16_f32 v109, v50, v51
    v_exp_f32 v54, v54
    v_exp_f32 v55, v55
    v_cvt_pk_bf16_f32 v110, v52, v53
    v_cvt_pk_bf16_f32 v111, v54, v55
    v_mfma_f32_32x32x16_bf16 v[40:55], v[138:141], v[120:123], 0
    ds_read_b64_tr_b16 v[156:157], v30 offset:9472
    v_exp_f32 v56, v56
    v_exp_f32 v57, v57
    v_exp_f32 v58, v58
    v_exp_f32 v59, v59
    v_cvt_pk_bf16_f32 v112, v56, v57
    v_exp_f32 v60, v60
    v_mfma_f32_32x32x8_bf16 v[40:55], v[142:143], v[124:125], v[40:55]
    ds_read_b64_tr_b16 v[158:159], v30 offset:9600
    v_exp_f32 v61, v61
    v_cvt_pk_bf16_f32 v113, v58, v59
    v_exp_f32 v62, v62
    v_exp_f32 v63, v63
    v_cvt_pk_bf16_f32 v114, v60, v61
    v_exp_f32 v64, v64
    v_mfma_f32_32x32x16_bf16 v[72:87], v[144:147], v[104:107], v[72:87]
    v_exp_f32 v65, v65
    v_cvt_pk_bf16_f32 v115, v62, v63
    v_exp_f32 v66, v66
    v_exp_f32 v67, v67
    v_cvt_pk_bf16_f32 v116, v64, v65
    v_exp_f32 v68, v68
    v_mfma_f32_32x32x16_bf16 v[72:87], v[148:151], v[108:111], v[72:87]
    s_waitcnt vmcnt(63) lgkmcnt(0)
    s_barrier
    s_setprio 1
    v_exp_f32 v69, v69
    v_cvt_pk_bf16_f32 v117, v66, v67
    v_exp_f32 v70, v70
    v_exp_f32 v71, v71
    v_cvt_pk_bf16_f32 v118, v68, v69
    v_cvt_pk_bf16_f32 v119, v70, v71
    v_mfma_f32_32x32x16_bf16 v[56:71], v[138:141], v[126:129], 0
    ds_read_b128 v[138:141], v26 offset:15360
    v_exp_f32 v40, v40
    v_exp_f32 v41, v41
    v_exp_f32 v42, v42
    v_exp_f32 v43, v43
    v_cvt_pk_bf16_f32 v104, v40, v41
    v_exp_f32 v44, v44
    v_mfma_f32_32x32x8_bf16 v[56:71], v[142:143], v[130:131], v[56:71]
    ds_read_b64 v[142:143], v28 offset:15360
    s_lshl_b32 s29, s22, 10
    s_mul_i32 s28, s15, 102400
    s_add_u32 s63, s28, 52924416
    s_add_u32 s28, s28, 52822016
    s_add_u32 s28, s28, s29
    s_add_u32 m0, s29, 24576
    s_nop 0
    buffer_load_dwordx4 v3, s[4:7], s28 offen sc1 lds
    s_add_u32 s28, s28, 8192
    v_exp_f32 v45, v45
    v_cvt_pk_bf16_f32 v105, v42, v43
    v_exp_f32 v46, v46
    v_exp_f32 v47, v47
    v_cvt_pk_bf16_f32 v106, v44, v45
    v_exp_f32 v48, v48
    v_mfma_f32_32x32x16_bf16 v[88:103], v[144:147], v[112:115], v[88:103]
    ds_read_b64_tr_b16 v[144:145], v30 offset:12288
    v_exp_f32 v49, v49
    v_cvt_pk_bf16_f32 v107, v46, v47
    v_exp_f32 v50, v50
    v_exp_f32 v51, v51
    v_cvt_pk_bf16_f32 v108, v48, v49
    v_exp_f32 v52, v52
    v_mfma_f32_32x32x16_bf16 v[88:103], v[148:151], v[116:119], v[88:103]
    ds_read_b64_tr_b16 v[146:147], v30 offset:12416
    s_add_u32 m0, s29, 32768
    s_nop 0
    buffer_load_dwordx4 v3, s[4:7], s28 offen sc1 lds
    s_add_u32 s28, s28, 8192
    v_exp_f32 v53, v53
    v_cvt_pk_bf16_f32 v109, v50, v51
    v_exp_f32 v54, v54
    v_exp_f32 v55, v55
    v_cvt_pk_bf16_f32 v110, v52, v53
    v_cvt_pk_bf16_f32 v111, v54, v55
    v_mfma_f32_32x32x16_bf16 v[40:55], v[132:135], v[120:123], 0
    ds_read_b64_tr_b16 v[148:149], v30 offset:12544
    v_exp_f32 v56, v56
    v_exp_f32 v57, v57
    v_exp_f32 v58, v58
    v_exp_f32 v59, v59
    v_cvt_pk_bf16_f32 v112, v56, v57
    v_exp_f32 v60, v60
    v_mfma_f32_32x32x8_bf16 v[40:55], v[136:137], v[124:125], v[40:55]
    ds_read_b64_tr_b16 v[150:151], v30 offset:12672
    s_add_u32 m0, s29, 40960
    s_nop 0
    buffer_load_dwordx4 v3, s[4:7], s28 offen sc1 lds
    s_add_u32 s28, s28, 8192
    v_exp_f32 v61, v61
    v_cvt_pk_bf16_f32 v113, v58, v59
    v_exp_f32 v62, v62
    v_exp_f32 v63, v63
    v_cvt_pk_bf16_f32 v114, v60, v61
    v_exp_f32 v64, v64
    v_mfma_f32_32x32x16_bf16 v[72:87], v[152:155], v[104:107], v[72:87]
    s_add_u32 m0, s29, 98304
    s_nop 0
    buffer_load_dwordx4 v3, s[4:7], s28 offen sc1 lds
    s_add_u32 s28, s28, 8192
    v_exp_f32 v65, v65
    v_cvt_pk_bf16_f32 v115, v62, v63
    v_exp_f32 v66, v66
    v_exp_f32 v67, v67
    v_cvt_pk_bf16_f32 v116, v64, v65
    v_exp_f32 v68, v68
    v_mfma_f32_32x32x16_bf16 v[72:87], v[156:159], v[108:111], v[72:87]
    s_waitcnt lgkmcnt(0)
    v_exp_f32 v69, v69
    v_cvt_pk_bf16_f32 v117, v66, v67
    v_exp_f32 v70, v70
    v_exp_f32 v71, v71
    v_cvt_pk_bf16_f32 v118, v68, v69
    v_cvt_pk_bf16_f32 v119, v70, v71
    v_mfma_f32_32x32x16_bf16 v[56:71], v[132:135], v[126:129], 0
    ds_read_b128 v[132:135], v26 offset:18432
    v_exp_f32 v40, v40
    v_exp_f32 v41, v41
    v_exp_f32 v42, v42
    v_exp_f32 v43, v43
    v_cvt_pk_bf16_f32 v104, v40, v41
    v_exp_f32 v44, v44
    v_mfma_f32_32x32x8_bf16 v[56:71], v[136:137], v[130:131], v[56:71]
    ds_read_b64 v[136:137], v28 offset:18432
    s_add_u32 m0, s29, 106496
    s_nop 0
    buffer_load_dwordx4 v3, s[4:7], s28 offen sc1 lds
    s_add_u32 s28, s28, 8192
    v_exp_f32 v45, v45
    v_cvt_pk_bf16_f32 v105, v42, v43
    v_exp_f32 v46, v46
    v_exp_f32 v47, v47
    v_cvt_pk_bf16_f32 v106, v44, v45
    v_exp_f32 v48, v48
    v_mfma_f32_32x32x16_bf16 v[88:103], v[152:155], v[112:115], v[88:103]
    ds_read_b64_tr_b16 v[152:153], v30 offset:15360
    v_exp_f32 v49, v49
    v_cvt_pk_bf16_f32 v107, v46, v47
    v_exp_f32 v50, v50
    v_exp_f32 v51, v51
    v_cvt_pk_bf16_f32 v108, v48, v49
    v_exp_f32 v52, v52
    v_mfma_f32_32x32x16_bf16 v[88:103], v[156:159], v[116:119], v[88:103]
    ds_read_b64_tr_b16 v[154:155], v30 offset:15488
    s_add_u32 m0, s29, 114688
    s_nop 0
    buffer_load_dwordx4 v3, s[4:7], s28 offen sc1 lds
    s_add_u32 s28, s28, 8192
    v_exp_f32 v53, v53
    v_cvt_pk_bf16_f32 v109, v50, v51
    v_exp_f32 v54, v54
    v_exp_f32 v55, v55
    v_cvt_pk_bf16_f32 v110, v52, v53
    v_cvt_pk_bf16_f32 v111, v54, v55
    v_mfma_f32_32x32x16_bf16 v[40:55], v[138:141], v[120:123], 0
    ds_read_b64_tr_b16 v[156:157], v30 offset:15616
    v_exp_f32 v56, v56
    v_exp_f32 v57, v57
    v_exp_f32 v58, v58
    v_exp_f32 v59, v59
    v_cvt_pk_bf16_f32 v112, v56, v57
    v_exp_f32 v60, v60
    v_mfma_f32_32x32x8_bf16 v[40:55], v[142:143], v[124:125], v[40:55]
    ds_read_b64_tr_b16 v[158:159], v30 offset:15744
    s_add_u32 m0, s29, 49152
    s_nop 0
    buffer_load_dwordx4 v3, s[4:7], s28 offen sc1 lds
    s_add_u32 s28, s28, 8192
    v_exp_f32 v61, v61
    v_cvt_pk_bf16_f32 v113, v58, v59
    v_exp_f32 v62, v62
    v_exp_f32 v63, v63
    v_cvt_pk_bf16_f32 v114, v60, v61
    v_exp_f32 v64, v64
    v_mfma_f32_32x32x16_bf16 v[72:87], v[144:147], v[104:107], v[72:87]
    s_add_u32 m0, s29, 57344
    s_nop 0
    buffer_load_dwordx4 v3, s[4:7], s28 offen sc1 lds
    s_add_u32 s28, s28, 8192
    v_exp_f32 v65, v65
    v_cvt_pk_bf16_f32 v115, v62, v63
    v_exp_f32 v66, v66
    v_exp_f32 v67, v67
    v_cvt_pk_bf16_f32 v116, v64, v65
    v_exp_f32 v68, v68
    v_mfma_f32_32x32x16_bf16 v[72:87], v[148:151], v[108:111], v[72:87]
    s_waitcnt lgkmcnt(0)
    v_exp_f32 v69, v69
    v_cvt_pk_bf16_f32 v117, v66, v67
    v_exp_f32 v70, v70
    v_exp_f32 v71, v71
    v_cvt_pk_bf16_f32 v118, v68, v69
    v_cvt_pk_bf16_f32 v119, v70, v71
    v_mfma_f32_32x32x16_bf16 v[56:71], v[138:141], v[126:129], 0
    ds_read_b128 v[138:141], v26 offset:21504
    v_exp_f32 v40, v40
    v_exp_f32 v41, v41
    v_exp_f32 v42, v42
    v_exp_f32 v43, v43
    v_cvt_pk_bf16_f32 v104, v40, v41
    v_exp_f32 v44, v44
    v_mfma_f32_32x32x8_bf16 v[56:71], v[142:143], v[130:131], v[56:71]
    ds_read_b64 v[142:143], v28 offset:21504
    s_add_u32 m0, s29, 65536
    s_nop 0
    buffer_load_dwordx4 v3, s[4:7], s28 offen sc1 lds
    s_add_u32 s28, s28, 8192
    v_exp_f32 v45, v45
    v_cvt_pk_bf16_f32 v105, v42, v43
    v_exp_f32 v46, v46
    v_exp_f32 v47, v47
    v_cvt_pk_bf16_f32 v106, v44, v45
    v_exp_f32 v48, v48
    v_mfma_f32_32x32x16_bf16 v[88:103], v[144:147], v[112:115], v[88:103]
    ds_read_b64_tr_b16 v[144:145], v30 offset:18432
    v_exp_f32 v49, v49
    v_cvt_pk_bf16_f32 v107, v46, v47
    v_exp_f32 v50, v50
    v_exp_f32 v51, v51
    v_cvt_pk_bf16_f32 v108, v48, v49
    v_exp_f32 v52, v52
    v_mfma_f32_32x32x16_bf16 v[88:103], v[148:151], v[116:119], v[88:103]
    ds_read_b64_tr_b16 v[146:147], v30 offset:18560
    s_add_u32 m0, s29, 122880
    s_nop 0
    buffer_load_dwordx4 v3, s[4:7], s28 offen sc1 lds
    s_add_u32 s28, s28, 8192
    v_exp_f32 v53, v53
    v_cvt_pk_bf16_f32 v109, v50, v51
    v_exp_f32 v54, v54
    v_exp_f32 v55, v55
    v_cvt_pk_bf16_f32 v110, v52, v53
    v_cvt_pk_bf16_f32 v111, v54, v55
    v_mfma_f32_32x32x16_bf16 v[40:55], v[132:135], v[120:123], 0
    ds_read_b64_tr_b16 v[148:149], v30 offset:18688
    v_exp_f32 v56, v56
    v_exp_f32 v57, v57
    v_exp_f32 v58, v58
    v_exp_f32 v59, v59
    v_cvt_pk_bf16_f32 v112, v56, v57
    v_exp_f32 v60, v60
    v_mfma_f32_32x32x8_bf16 v[40:55], v[136:137], v[124:125], v[40:55]
    ds_read_b64_tr_b16 v[150:151], v30 offset:18816
    s_add_u32 m0, s29, 131072
    s_nop 0
    buffer_load_dwordx4 v3, s[4:7], s28 offen sc1 lds
    s_add_u32 s28, s28, 8192
    v_exp_f32 v61, v61
    v_cvt_pk_bf16_f32 v113, v58, v59
    v_exp_f32 v62, v62
    v_exp_f32 v63, v63
    v_cvt_pk_bf16_f32 v114, v60, v61
    v_exp_f32 v64, v64
    v_mfma_f32_32x32x16_bf16 v[72:87], v[152:155], v[104:107], v[72:87]
    s_add_u32 m0, s29, 139264
    s_nop 0
    buffer_load_dwordx4 v3, s[4:7], s28 offen sc1 lds
    s_add_u32 s28, s28, 8192
    v_exp_f32 v65, v65
    v_cvt_pk_bf16_f32 v115, v62, v63
    v_exp_f32 v66, v66
    v_exp_f32 v67, v67
    v_cvt_pk_bf16_f32 v116, v64, v65
    v_exp_f32 v68, v68
    v_mfma_f32_32x32x16_bf16 v[72:87], v[156:159], v[108:111], v[72:87]
    s_waitcnt lgkmcnt(0)
    v_exp_f32 v69, v69
    v_cvt_pk_bf16_f32 v117, v66, v67
    v_exp_f32 v70, v70
    v_exp_f32 v71, v71
    v_cvt_pk_bf16_f32 v118, v68, v69
    v_cvt_pk_bf16_f32 v119, v70, v71
    v_mfma_f32_32x32x16_bf16 v[56:71], v[132:135], v[126:129], 0
    v_exp_f32 v40, v40
    v_exp_f32 v41, v41
    v_exp_f32 v42, v42
    v_exp_f32 v43, v43
    v_cvt_pk_bf16_f32 v104, v40, v41
    v_exp_f32 v44, v44
    v_mfma_f32_32x32x8_bf16 v[56:71], v[136:137], v[130:131], v[56:71]
    v_exp_f32 v45, v45
    v_cvt_pk_bf16_f32 v105, v42, v43
    v_exp_f32 v46, v46
    v_exp_f32 v47, v47
    v_cvt_pk_bf16_f32 v106, v44, v45
    v_exp_f32 v48, v48
    v_mfma_f32_32x32x16_bf16 v[88:103], v[152:155], v[112:115], v[88:103]
    ds_read_b64_tr_b16 v[152:153], v30 offset:21504
    v_exp_f32 v49, v49
    v_cvt_pk_bf16_f32 v107, v46, v47
    v_exp_f32 v50, v50
    v_exp_f32 v51, v51
    v_cvt_pk_bf16_f32 v108, v48, v49
    v_exp_f32 v52, v52
    v_mfma_f32_32x32x16_bf16 v[88:103], v[156:159], v[116:119], v[88:103]
    ds_read_b64_tr_b16 v[154:155], v30 offset:21632
    v_exp_f32 v53, v53
    v_cvt_pk_bf16_f32 v109, v50, v51
    v_exp_f32 v54, v54
    v_exp_f32 v55, v55
    v_cvt_pk_bf16_f32 v110, v52, v53
    v_cvt_pk_bf16_f32 v111, v54, v55
    v_mfma_f32_32x32x16_bf16 v[40:55], v[138:141], v[120:123], 0
    ds_read_b64_tr_b16 v[156:157], v30 offset:21760
    v_exp_f32 v56, v56
    v_exp_f32 v57, v57
    v_exp_f32 v58, v58
    v_exp_f32 v59, v59
    v_cvt_pk_bf16_f32 v112, v56, v57
    v_exp_f32 v60, v60
    v_mfma_f32_32x32x8_bf16 v[40:55], v[142:143], v[124:125], v[40:55]
    ds_read_b64_tr_b16 v[158:159], v30 offset:21888
    v_exp_f32 v61, v61
    v_cvt_pk_bf16_f32 v113, v58, v59
    v_exp_f32 v62, v62
    v_exp_f32 v63, v63
    v_cvt_pk_bf16_f32 v114, v60, v61
    v_exp_f32 v64, v64
    v_mfma_f32_32x32x16_bf16 v[72:87], v[144:147], v[104:107], v[72:87]
    v_exp_f32 v65, v65
    v_cvt_pk_bf16_f32 v115, v62, v63
    v_exp_f32 v66, v66
    v_exp_f32 v67, v67
    v_cvt_pk_bf16_f32 v116, v64, v65
    v_exp_f32 v68, v68
    v_mfma_f32_32x32x16_bf16 v[72:87], v[148:151], v[108:111], v[72:87]
    s_waitcnt lgkmcnt(0)
    s_setprio 0
    v_exp_f32 v69, v69
    v_cvt_pk_bf16_f32 v117, v66, v67
    v_exp_f32 v70, v70
    v_exp_f32 v71, v71
    v_cvt_pk_bf16_f32 v118, v68, v69
    v_cvt_pk_bf16_f32 v119, v70, v71
    v_mfma_f32_32x32x16_bf16 v[56:71], v[138:141], v[126:129], 0
    v_exp_f32 v40, v40
    v_exp_f32 v41, v41
    v_exp_f32 v42, v42
    v_exp_f32 v43, v43
    v_cvt_pk_bf16_f32 v104, v40, v41
    v_exp_f32 v44, v44
    v_mfma_f32_32x32x8_bf16 v[56:71], v[142:143], v[130:131], v[56:71]
    v_exp_f32 v45, v45
    v_cvt_pk_bf16_f32 v105, v42, v43
    v_exp_f32 v46, v46
    v_exp_f32 v47, v47
    v_cvt_pk_bf16_f32 v106, v44, v45
    v_exp_f32 v48, v48
    v_mfma_f32_32x32x16_bf16 v[88:103], v[144:147], v[112:115], v[88:103]
    v_exp_f32 v49, v49
    v_cvt_pk_bf16_f32 v107, v46, v47
    v_exp_f32 v50, v50
    v_exp_f32 v51, v51
    v_cvt_pk_bf16_f32 v108, v48, v49
    v_exp_f32 v52, v52
    v_mfma_f32_32x32x16_bf16 v[88:103], v[148:151], v[116:119], v[88:103]
    v_exp_f32 v53, v53
    v_cvt_pk_bf16_f32 v109, v50, v51
    v_exp_f32 v54, v54
    v_exp_f32 v55, v55
    v_cvt_pk_bf16_f32 v110, v52, v53
    v_cvt_pk_bf16_f32 v111, v54, v55
    v_exp_f32 v56, v56
    v_exp_f32 v57, v57
    v_exp_f32 v58, v58
    v_exp_f32 v59, v59
    v_cvt_pk_bf16_f32 v112, v56, v57
    v_exp_f32 v60, v60
    v_exp_f32 v61, v61
    v_cvt_pk_bf16_f32 v113, v58, v59
    v_exp_f32 v62, v62
    v_exp_f32 v63, v63
    v_cvt_pk_bf16_f32 v114, v60, v61
    v_exp_f32 v64, v64
    v_mfma_f32_32x32x16_bf16 v[72:87], v[152:155], v[104:107], v[72:87]
    v_exp_f32 v65, v65
    v_cvt_pk_bf16_f32 v115, v62, v63
    v_exp_f32 v66, v66
    v_exp_f32 v67, v67
    v_cvt_pk_bf16_f32 v116, v64, v65
    v_exp_f32 v68, v68
    v_mfma_f32_32x32x16_bf16 v[72:87], v[156:159], v[108:111], v[72:87]
    v_exp_f32 v69, v69
    v_cvt_pk_bf16_f32 v117, v66, v67
    v_exp_f32 v70, v70
    v_exp_f32 v71, v71
    v_cvt_pk_bf16_f32 v118, v68, v69
    v_cvt_pk_bf16_f32 v119, v70, v71
    s_nop 1
    v_mfma_f32_32x32x16_bf16 v[88:103], v[152:155], v[112:115], v[88:103]
    v_mfma_f32_32x32x16_bf16 v[88:103], v[156:159], v[116:119], v[88:103]
    s_mul_i32 s28, s23, 3072
    s_add_u32 s27, s27, s28
    s_xor_b32 s21, s24, 1
    s_mul_i32 s21, s21, 73728
    s_add_u32 s28, s28, s21
    v_add_u32 v10, s27, v3
    v_add_u32 v11, s28, v3
    ds_write_b128 v10, v[72:75] offset:0
    ds_write_b128 v10, v[76:79] offset:1024
    ds_write_b128 v10, v[80:83] offset:2048
    s_mul_i32 s20, s25, 40960
    s_add_u32 s20, s20, s18
    s_add_u32 s20, s20, 11141120
    s_lshl_b32 s21, s16, 8
    s_add_u32 s29, s20, s21
    s_add_u32 s29, s29, 32768
    s_lshl_b32 s21, s16, 10
    s_add_u32 s20, s20, s21
    v_lshlrev_b32 v13, 3, v1
    s_mov_b32 s54, 0
    s_waitcnt lgkmcnt(0)
    s_barrier
    ds_read_b128 v[40:43], v11 offset:0
    ds_read_b128 v[44:47], v11 offset:1024
    ds_read_b128 v[48:51], v11 offset:2048
    s_waitcnt lgkmcnt(0)
    v_pk_add_f32 v[72:73], v[88:89], v[40:41]
    v_pk_add_f32 v[74:75], v[90:91], v[42:43]
    v_pk_add_f32 v[76:77], v[92:93], v[44:45]
    v_pk_add_f32 v[78:79], v[94:95], v[46:47]
    v_pk_add_f32 v[80:81], v[96:97], v[48:49]
    v_pk_add_f32 v[82:83], v[98:99], v[50:51]
L_mega_kernel_fin_50:
    v_mov_b32 v104, v80
    v_mov_b32 v105, v80
    s_nop 1
    v_permlane32_swap_b32 v104, v105
    s_nop 0
    v_rcp_f32 v106, v105
    v_rcp_f32 v107, v105
    v_mov_b32 v114, 0
    v_mov_b32 v115, 0
    v_pk_mul_f32 v[72:73], v[72:73], v[106:107]
    v_pk_mul_f32 v[74:75], v[74:75], v[106:107]
    v_pk_mul_f32 v[76:77], v[76:77], v[106:107]
    v_pk_mul_f32 v[78:79], v[78:79], v[106:107]
    v_pk_mul_f32 v[80:81], v[80:81], v[106:107]
    v_pk_mul_f32 v[82:83], v[82:83], v[106:107]
    v_cvt_pk_bf16_f32 v56, v72, v73
    v_cvt_pk_bf16_f32 v57, v74, v75
    v_cvt_pk_bf16_f32 v58, v76, v77
    v_cvt_pk_bf16_f32 v59, v78, v79
    v_cvt_pk_bf16_f32 v60, v80, v81
    v_cvt_pk_bf16_f32 v61, v82, v83
    buffer_store_dwordx4 v[56:59], v3, s[4:7], s20 offen sc1
    s_mov_b64 exec, s[32:33]
    buffer_store_dwordx2 v[60:61], v13, s[4:7], s29 offen sc1
    s_mov_b64 exec, -1
    s_cmp_lg_u32 s54, 0
    s_cbranch_scc1 L_mega_kernel_st_52
    v_pk_mul_f32 v[110:111], v[72:73], v[114:115]
    v_pk_fma_f32 v[110:111], v[74:75], v[114:115], v[110:111]
    v_pk_fma_f32 v[110:111], v[76:77], v[114:115], v[110:111]
    v_pk_fma_f32 v[110:111], v[78:79], v[114:115], v[110:111]
    v_pk_fma_f32 v[110:111], v[80:81], v[114:115], v[110:111]
    v_pk_fma_f32 v[110:111], v[82:83], v[114:115], v[110:111]
    v_mov_b32 v108, 0x71800000
    v_mov_b32 v109, 0x2b800000
    v_cmp_u_f32 vcc, v110, v111
    v_cmp_nge_f32 s[42:43], v105, v109
    s_or_b64 vcc, vcc, s[42:43]
    v_cmp_nge_f32 s[42:43], v108, v105
    s_or_b64 vcc, vcc, s[42:43]
    s_cbranch_vccnz L_mega_kernel_slow_51
L_mega_kernel_st_52:
    s_lshl_b32 s50, s17, 12
    s_add_u32 s50, s50, s18
    s_add_u32 s50, s50, 23920640
    v_lshlrev_b32 v10, 7, v1
    v_mov_b32 v11, 1
    s_mov_b32 s45, s22
    s_waitcnt vmcnt(0)
    s_barrier
    s_cmp_lg_u32 s22, 5
    s_cbranch_scc1 L_mega_kernel_es_54
    s_mov_b64 exec, s[32:33]
    buffer_atomic_add v11, v10, s[4:7], s50 offen sc1
    s_mov_b64 exec, -1
L_mega_kernel_es_54:
    s_cmp_ge_u32 s22, 4
    s_cbranch_scc1 L_mega_kernel_L_4
    s_setprio 2
    v_lshrrev_b32 v14, 1, v8
    v_lshlrev_b32 v14, 9, v14
    v_lshl_add_u32 v14, v7, 4, v14
    s_lshl_b32 s24, s14, 1
    s_lshr_b32 s25, s23, 1
    s_add_u32 s24, s24, s25
    s_and_b32 s25, s23, 1
    s_lshl_b32 s25, s25, 8
    s_mul_i32 s20, s24, 40960
    s_add_u32 s20, s20, s25
    s_add_u32 s20, s20, s18
    s_add_u32 s20, s20, 11141120
    s_lshr_b32 s21, s25, 1
    s_sub_u32 s21, s20, s21
    s_add_u32 s21, s21, 32768
    v_lshlrev_b32 v15, 9, v8
    v_lshl_add_u32 v15, v7, 3, v15
    s_mul_i32 s26, s24, 40960
    s_mul_i32 s27, s15, 5120
    s_add_u32 s26, s26, s27
    s_add_u32 s26, s26, s25
    s_add_u32 s26, s26, s18
    s_add_u32 s26, s26, 13762560
    s_add_u32 s27, s26, 4096
    s_lshl_b32 s28, s15, 14
    s_lshl_b32 s29, s24, 8
    s_add_u32 s28, s28, s29
    s_lshr_b32 s29, s25, 1
    s_add_u32 s28, s28, s29
    s_add_u32 s28, s28, s18
    s_add_u32 s28, s28, 16384000
    s_lshl_b32 s50, s19, 2
    s_or_b32 s50, s50, s45
    s_cmp_lg_u32 s50, 1
    s_cbranch_scc1 L_mega_kernel_nc_56
    s_mul_i32 s50, s13, 896
    s_add_u32 s50, s50, 56033280
    s_mov_b32 exec_hi, 0xffffff
    buffer_load_dwordx4 v[40:43], v3, s[4:7], s50 offen sc1
    s_add_u32 s50, s50, 14336
    buffer_load_dwordx4 v[44:47], v3, s[4:7], s50 offen sc1
    s_add_u32 s50, s50, 14336
    buffer_load_dwordx4 v[48:51], v3, s[4:7], s50 offen sc1
    s_add_u32 s50, s50, 14336
    buffer_load_dwordx4 v[52:55], v3, s[4:7], s50 offen sc1
    s_add_u32 s50, s50, 14336
    buffer_load_dwordx4 v[56:59], v3, s[4:7], s50 offen sc1
    s_add_u32 s50, s50, 14336
    buffer_load_dwordx4 v[60:63], v3, s[4:7], s50 offen sc1
    s_add_u32 s50, s50, 14336
    buffer_load_dwordx4 v[64:67], v3, s[4:7], s50 offen sc1
    s_add_u32 s50, s50, 14336
    buffer_load_dwordx4 v[68:71], v3, s[4:7], s50 offen sc1
    s_add_u32 s50, s50, 14336
    buffer_load_dwordx4 v[72:75], v3, s[4:7], s50 offen sc1
    s_add_u32 s50, s50, 14336
    buffer_load_dwordx4 v[76:79], v3, s[4:7], s50 offen sc1
    s_add_u32 s50, s50, 14336
    buffer_load_dwordx4 v[80:83], v3, s[4:7], s50 offen sc1
    s_add_u32 s50, s50, 14336
    buffer_load_dwordx4 v[84:87], v3, s[4:7], s50 offen sc1
    s_add_u32 s50, s50, 14336
    buffer_load_dwordx4 v[88:91], v3, s[4:7], s50 offen sc1
    s_add_u32 s50, s50, 14336
    buffer_load_dwordx4 v[92:95], v3, s[4:7], s50 offen sc1
    s_add_u32 s50, s50, 14336
    buffer_load_dwordx4 v[96:99], v3, s[4:7], s50 offen sc1
    s_add_u32 s50, s50, 14336
    buffer_load_dwordx4 v[100:103], v3, s[4:7], s50 offen sc1
    s_add_u32 s50, s50, 14336
    buffer_load_dwordx4 v[104:107], v3, s[4:7], s50 offen sc1
    s_add_u32 s50, s50, 14336
    buffer_load_dwordx4 v[108:111], v3, s[4:7], s50 offen sc1
    s_add_u32 s50, s50, 14336
    buffer_load_dwordx4 v[112:115], v3, s[4:7], s50 offen sc1
    s_add_u32 s50, s50, 14336
    buffer_load_dwordx4 v[116:119], v3, s[4:7], s50 offen sc1
    s_add_u32 s50, s50, 14336
    v_add_u32 v10, 147968, v3
    s_waitcnt vmcnt(0)
    v_pk_add_f32 v[40:41], v[40:41], v[44:45]
    v_pk_add_f32 v[42:43], v[42:43], v[46:47]
    v_pk_add_f32 v[40:41], v[40:41], v[48:49]
    v_pk_add_f32 v[42:43], v[42:43], v[50:51]
    v_pk_add_f32 v[40:41], v[40:41], v[52:53]
    v_pk_add_f32 v[42:43], v[42:43], v[54:55]
    v_pk_add_f32 v[40:41], v[40:41], v[56:57]
    v_pk_add_f32 v[42:43], v[42:43], v[58:59]
    v_pk_add_f32 v[40:41], v[40:41], v[60:61]
    v_pk_add_f32 v[42:43], v[42:43], v[62:63]
    v_pk_add_f32 v[40:41], v[40:41], v[64:65]
    v_pk_add_f32 v[42:43], v[42:43], v[66:67]
    v_pk_add_f32 v[40:41], v[40:41], v[68:69]
    v_pk_add_f32 v[42:43], v[42:43], v[70:71]
    v_pk_add_f32 v[40:41], v[40:41], v[72:73]
    v_pk_add_f32 v[42:43], v[42:43], v[74:75]
    v_pk_add_f32 v[40:41], v[40:41], v[76:77]
    v_pk_add_f32 v[42:43], v[42:43], v[78:79]
    v_pk_add_f32 v[40:41], v[40:41], v[80:81]
    v_pk_add_f32 v[42:43], v[42:43], v[82:83]
    v_pk_add_f32 v[40:41], v[40:41], v[84:85]
    v_pk_add_f32 v[42:43], v[42:43], v[86:87]
    v_pk_add_f32 v[40:41], v[40:41], v[88:89]
    v_pk_add_f32 v[42:43], v[42:43], v[90:91]
    v_pk_add_f32 v[40:41], v[40:41], v[92:93]
    v_pk_add_f32 v[42:43], v[42:43], v[94:95]
    v_pk_add_f32 v[40:41], v[40:41], v[96:97]
    v_pk_add_f32 v[42:43], v[42:43], v[98:99]
    v_pk_add_f32 v[40:41], v[40:41], v[100:101]
    v_pk_add_f32 v[42:43], v[42:43], v[102:103]
    v_pk_add_f32 v[40:41], v[40:41], v[104:105]
    v_pk_add_f32 v[42:43], v[42:43], v[106:107]
    v_pk_add_f32 v[40:41], v[40:41], v[108:109]
    v_pk_add_f32 v[42:43], v[42:43], v[110:111]
    v_pk_add_f32 v[40:41], v[40:41], v[112:113]
    v_pk_add_f32 v[42:43], v[42:43], v[114:115]
    v_pk_add_f32 v[40:41], v[40:41], v[116:117]
    v_pk_add_f32 v[42:43], v[42:43], v[118:119]
    ds_write_b128 v10, v[40:43]
    s_mov_b64 exec, -1
    s_waitcnt lgkmcnt(0)
L_mega_kernel_nc_56:
    v_add_u32 v36, s31, v3
    v_add_u32 v37, s31, v4
    v_add_u32 v38, s31, v5
    s_cmp_lg_u32 s45, 0
    s_cbranch_scc1 L_mega_kernel_polls_57
    s_lshl_b32 s53, s14, 3
    s_add_u32 s53, s53, s15
    s_lshl_b32 s50, s53, 7
    s_add_u32 s50, s50, s18
    s_add_u32 s50, s50, 23920640
    s_add_u32 s53, s3, 32
    s_mov_b32 s52, 0x400000
L_mega_kernel_sp_58:
    s_buffer_load_dword s51, s[4:7], s50 glc
    s_sub_u32 s52, s52, 1
    s_waitcnt lgkmcnt(0)
    s_cmp_lg_u32 s51, s53
    s_cbranch_scc0 L_mega_kernel_po_60
    s_and_b32 s51, s52, 31
    s_cbranch_scc1 L_mega_kernel_sp_58
    buffer_load_dword v9, off, s[4:7], s50 sc1
    s_cmp_eq_u32 s52, 0
    s_cbranch_scc1 L_mega_kernel_po_60
    s_waitcnt vmcnt(0)
    v_readfirstlane_b32 s51, v9
    s_cmp_lg_u32 s51, s53
    s_cbranch_scc1 L_mega_kernel_sp_58
L_mega_kernel_po_60:
L_mega_kernel_polls_57:
    s_barrier
    buffer_load_dwordx2 a[40:41], v15, s[4:7], s21 offen offset:0 sc1
    buffer_load_dwordx2 a[42:43], v15, s[4:7], s21 offen offset:256 sc1
    buffer_load_dwordx2 a[44:45], v15, s[4:7], s21 offen offset:2048 sc1
    buffer_load_dwordx2 a[46:47], v15, s[4:7], s21 offen offset:2304 sc1
    s_add_u32 s21, s21, 4096
    buffer_load_dwordx2 a[48:49], v15, s[4:7], s21 offen offset:0 sc1
    buffer_load_dwordx2 a[50:51], v15, s[4:7], s21 offen offset:256 sc1
    buffer_load_dwordx2 a[52:53], v15, s[4:7], s21 offen offset:2048 sc1
    buffer_load_dwordx2 a[54:55], v15, s[4:7], s21 offen offset:2304 sc1
    s_add_u32 s21, s21, 4096
    buffer_load_dwordx4 a[56:59], v6, s[4:7], s20 offen offset:0 sc1
    buffer_load_dwordx4 a[60:63], v6, s[4:7], s20 offen offset:2048 sc1
    s_add_u32 s20, s20, 4096
    buffer_load_dwordx4 a[64:67], v6, s[4:7], s20 offen offset:0 sc1
    buffer_load_dwordx4 a[68:71], v6, s[4:7], s20 offen offset:2048 sc1
    s_add_u32 s20, s20, 4096
    buffer_load_dwordx4 a[72:75], v6, s[4:7], s20 offen offset:0 sc1
    buffer_load_dwordx4 a[76:79], v6, s[4:7], s20 offen offset:2048 sc1
    s_add_u32 s20, s20, 4096
    buffer_load_dwordx4 a[80:83], v6, s[4:7], s20 offen offset:0 sc1
    buffer_load_dwordx4 a[84:87], v6, s[4:7], s20 offen offset:2048 sc1
    s_add_u32 s20, s20, 4096
    s_barrier
    ds_read_b128 a[0:3], v3 offset:24576
    ds_read_b128 a[4:7], v3 offset:25600
    ds_read_b128 a[8:11], v3 offset:26624
    ds_read_b128 a[12:15], v3 offset:27648
    ds_read_b128 a[16:19], v3 offset:28672
    ds_read_b128 a[20:23], v3 offset:29696
    ds_read_b128 a[24:27], v3 offset:30720
    ds_read_b128 a[28:31], v3 offset:31744
    s_waitcnt vmcnt(14) lgkmcnt(7)
    v_mfma_f32_16x16x32_bf16 v[40:43], a[0:3], a[40:43], 0
    ds_read_b128 a[32:35], v3 offset:32768
    s_waitcnt lgkmcnt(7)
    v_mfma_f32_16x16x32_bf16 v[44:47], a[4:7], a[40:43], 0
    ds_read_b128 a[0:3], v3 offset:33792
    s_waitcnt lgkmcnt(7)
    v_mfma_f32_16x16x32_bf16 v[48:51], a[8:11], a[40:43], 0
    ds_read_b128 a[4:7], v3 offset:34816
    s_waitcnt lgkmcnt(7)
    v_mfma_f32_16x16x32_bf16 v[52:55], a[12:15], a[40:43], 0
    ds_read_b128 a[8:11], v3 offset:35840
    s_waitcnt lgkmcnt(7)
    v_mfma_f32_16x16x32_bf16 v[56:59], a[16:19], a[40:43], 0
    ds_read_b128 a[12:15], v3 offset:36864
    s_waitcnt vmcnt(12) lgkmcnt(7)
    v_mfma_f32_16x16x32_bf16 v[40:43], a[20:23], a[44:47], v[40:43]
    ds_read_b128 a[16:19], v3 offset:37888
    s_waitcnt lgkmcnt(7)
    v_mfma_f32_16x16x32_bf16 v[44:47], a[24:27], a[44:47], v[44:47]
    ds_read_b128 a[20:23], v3 offset:38912
    s_waitcnt lgkmcnt(7)
    v_mfma_f32_16x16x32_bf16 v[48:51], a[28:31], a[44:47], v[48:51]
    ds_read_b128 a[24:27], v3 offset:39936
    s_waitcnt lgkmcnt(7)
    v_mfma_f32_16x16x32_bf16 v[52:55], a[32:35], a[44:47], v[52:55]
    ds_read_b128 a[28:31], v3 offset:40960
    s_waitcnt lgkmcnt(7)
    v_mfma_f32_16x16x32_bf16 v[56:59], a[0:3], a[44:47], v[56:59]
    ds_read_b128 a[32:35], v3 offset:41984
    s_waitcnt vmcnt(10) lgkmcnt(7)
    v_mfma_f32_16x16x32_bf16 v[40:43], a[4:7], a[48:51], v[40:43]
    ds_read_b128 a[0:3], v3 offset:43008
    s_waitcnt lgkmcnt(7)
    v_mfma_f32_16x16x32_bf16 v[44:47], a[8:11], a[48:51], v[44:47]
    ds_read_b128 a[4:7], v3 offset:44032
    s_waitcnt lgkmcnt(7)
    v_mfma_f32_16x16x32_bf16 v[48:51], a[12:15], a[48:51], v[48:51]
    ds_read_b128 a[8:11], v3 offset:45056
    s_waitcnt lgkmcnt(7)
    v_mfma_f32_16x16x32_bf16 v[52:55], a[16:19], a[48:51], v[52:55]
    ds_read_b128 a[12:15], v3 offset:46080
    s_waitcnt lgkmcnt(7)
    v_mfma_f32_16x16x32_bf16 v[56:59], a[20:23], a[48:51], v[56:59]
    ds_read_b128 a[16:19], v3 offset:47104
    s_waitcnt vmcnt(8) lgkmcnt(7)
    v_mfma_f32_16x16x32_bf16 v[40:43], a[24:27], a[52:55], v[40:43]
    ds_read_b128 a[20:23], v3 offset:48128
    s_waitcnt lgkmcnt(7)
    v_mfma_f32_16x16x32_bf16 v[44:47], a[28:31], a[52:55], v[44:47]
    ds_read_b128 a[24:27], v4 offset:32768
    s_waitcnt lgkmcnt(7)
    v_mfma_f32_16x16x32_bf16 v[48:51], a[32:35], a[52:55], v[48:51]
    ds_read_b128 a[28:31], v4 offset:33792
    s_waitcnt lgkmcnt(7)
    v_mfma_f32_16x16x32_bf16 v[52:55], a[0:3], a[52:55], v[52:55]
    ds_read_b128 a[32:35], v4 offset:34816
    s_waitcnt lgkmcnt(7)
    v_mfma_f32_16x16x32_bf16 v[56:59], a[4:7], a[52:55], v[56:59]
    ds_read_b128 a[0:3], v4 offset:35840
    s_waitcnt vmcnt(7) lgkmcnt(7)
    v_mfma_f32_16x16x32_bf16 v[40:43], a[8:11], a[56:59], v[40:43]
    ds_read_b128 a[4:7], v4 offset:36864
    s_waitcnt lgkmcnt(7)
    v_mfma_f32_16x16x32_bf16 v[44:47], a[12:15], a[56:59], v[44:47]
    ds_read_b128 a[8:11], v4 offset:37888
    s_waitcnt lgkmcnt(7)
    v_mfma_f32_16x16x32_bf16 v[48:51], a[16:19], a[56:59], v[48:51]
    ds_read_b128 a[12:15], v4 offset:38912
    s_waitcnt lgkmcnt(7)
    v_mfma_f32_16x16x32_bf16 v[52:55], a[20:23], a[56:59], v[52:55]
    ds_read_b128 a[16:19], v4 offset:39936
    s_waitcnt lgkmcnt(7)
    v_mfma_f32_16x16x32_bf16 v[56:59], a[24:27], a[56:59], v[56:59]
    ds_read_b128 a[20:23], v4 offset:40960
    s_waitcnt vmcnt(6) lgkmcnt(7)
    v_mfma_f32_16x16x32_bf16 v[40:43], a[28:31], a[60:63], v[40:43]
    ds_read_b128 a[24:27], v4 offset:41984
    s_waitcnt lgkmcnt(7)
    v_mfma_f32_16x16x32_bf16 v[44:47], a[32:35], a[60:63], v[44:47]
    ds_read_b128 a[28:31], v4 offset:43008
    s_waitcnt lgkmcnt(7)
    v_mfma_f32_16x16x32_bf16 v[48:51], a[0:3], a[60:63], v[48:51]
    ds_read_b128 a[32:35], v4 offset:44032
    s_waitcnt lgkmcnt(7)
    v_mfma_f32_16x16x32_bf16 v[52:55], a[4:7], a[60:63], v[52:55]
    ds_read_b128 a[0:3], v4 offset:45056
    s_waitcnt lgkmcnt(7)
    v_mfma_f32_16x16x32_bf16 v[56:59], a[8:11], a[60:63], v[56:59]
    ds_read_b128 a[4:7], v4 offset:46080
    s_waitcnt vmcnt(5) lgkmcnt(7)
    v_mfma_f32_16x16x32_bf16 v[40:43], a[12:15], a[64:67], v[40:43]
    ds_read_b128 a[8:11], v4 offset:47104
    s_waitcnt lgkmcnt(7)
    v_mfma_f32_16x16x32_bf16 v[44:47], a[16:19], a[64:67], v[44:47]
    ds_read_b128 a[12:15], v4 offset:48128
    s_waitcnt lgkmcnt(7)
    v_mfma_f32_16x16x32_bf16 v[48:51], a[20:23], a[64:67], v[48:51]
    ds_read_b128 a[16:19], v4 offset:49152
    s_waitcnt lgkmcnt(7)
    v_mfma_f32_16x16x32_bf16 v[52:55], a[24:27], a[64:67], v[52:55]
    ds_read_b128 a[20:23], v4 offset:50176
    s_waitcnt lgkmcnt(7)
    v_mfma_f32_16x16x32_bf16 v[56:59], a[28:31], a[64:67], v[56:59]
    ds_read_b128 a[24:27], v4 offset:51200
    s_waitcnt vmcnt(4) lgkmcnt(7)
    v_mfma_f32_16x16x32_bf16 v[40:43], a[32:35], a[68:71], v[40:43]
    ds_read_b128 a[28:31], v4 offset:52224
    s_waitcnt lgkmcnt(7)
    v_mfma_f32_16x16x32_bf16 v[44:47], a[0:3], a[68:71], v[44:47]
    ds_read_b128 a[32:35], v4 offset:53248
    s_waitcnt lgkmcnt(7)
    v_mfma_f32_16x16x32_bf16 v[48:51], a[4:7], a[68:71], v[48:51]
    ds_read_b128 a[0:3], v4 offset:54272
    s_waitcnt lgkmcnt(7)
    v_mfma_f32_16x16x32_bf16 v[52:55], a[8:11], a[68:71], v[52:55]
    ds_read_b128 a[4:7], v4 offset:55296
    s_waitcnt lgkmcnt(7)
    v_mfma_f32_16x16x32_bf16 v[56:59], a[12:15], a[68:71], v[56:59]
    ds_read_b128 a[8:11], v4 offset:56320
    s_waitcnt vmcnt(3) lgkmcnt(7)
    v_mfma_f32_16x16x32_bf16 v[40:43], a[16:19], a[72:75], v[40:43]
    ds_read_b128 a[12:15], v3 offset:49152
    s_waitcnt lgkmcnt(7)
    v_mfma_f32_16x16x32_bf16 v[44:47], a[20:23], a[72:75], v[44:47]
    ds_read_b128 a[16:19], v3 offset:50176
    s_waitcnt lgkmcnt(7)
    v_mfma_f32_16x16x32_bf16 v[48:51], a[24:27], a[72:75], v[48:51]
    ds_read_b128 a[20:23], v3 offset:51200
    s_waitcnt lgkmcnt(7)
    v_mfma_f32_16x16x32_bf16 v[52:55], a[28:31], a[72:75], v[52:55]
    ds_read_b128 a[24:27], v3 offset:52224
    s_waitcnt lgkmcnt(7)
    v_mfma_f32_16x16x32_bf16 v[56:59], a[32:35], a[72:75], v[56:59]
    ds_read_b128 a[28:31], v3 offset:53248
    s_waitcnt vmcnt(2) lgkmcnt(7)
    v_mfma_f32_16x16x32_bf16 v[40:43], a[0:3], a[76:79], v[40:43]
    ds_read_b128 a[32:35], v3 offset:54272
    s_waitcnt lgkmcnt(7)
    v_mfma_f32_16x16x32_bf16 v[44:47], a[4:7], a[76:79], v[44:47]
    ds_read_b128 a[0:3], v3 offset:55296
    s_waitcnt lgkmcnt(7)
    v_mfma_f32_16x16x32_bf16 v[48:51], a[8:11], a[76:79], v[48:51]
    ds_read_b128 a[4:7], v3 offset:56320
    s_waitcnt lgkmcnt(7)
    v_mfma_f32_16x16x32_bf16 v[52:55], a[12:15], a[76:79], v[52:55]
    ds_read_b128 a[8:11], v3 offset:57344
    s_waitcnt lgkmcnt(7)
    v_mfma_f32_16x16x32_bf16 v[56:59], a[16:19], a[76:79], v[56:59]
    ds_read_b128 a[12:15], v3 offset:58368
    s_waitcnt vmcnt(1) lgkmcnt(7)
    v_mfma_f32_16x16x32_bf16 v[40:43], a[20:23], a[80:83], v[40:43]
    ds_read_b128 a[16:19], v3 offset:59392
    s_waitcnt lgkmcnt(7)
    v_mfma_f32_16x16x32_bf16 v[44:47], a[24:27], a[80:83], v[44:47]
    ds_read_b128 a[20:23], v3 offset:60416
    s_waitcnt lgkmcnt(7)
    v_mfma_f32_16x16x32_bf16 v[48:51], a[28:31], a[80:83], v[48:51]
    s_barrier
    ds_read_b128 a[24:27], v3 offset:61440
    ds_read_b128 a[88:91], v36 offset:0
    s_waitcnt lgkmcnt(8)
    v_mfma_f32_16x16x32_bf16 v[52:55], a[32:35], a[80:83], v[52:55]
    ds_read_b128 a[28:31], v3 offset:62464
    s_waitcnt lgkmcnt(8)
    v_mfma_f32_16x16x32_bf16 v[56:59], a[0:3], a[80:83], v[56:59]
    ds_read_b128 a[32:35], v3 offset:63488
    s_waitcnt vmcnt(0) lgkmcnt(8)
    v_mfma_f32_16x16x32_bf16 v[40:43], a[4:7], a[84:87], v[40:43]
    ds_read_b128 a[0:3], v3 offset:64512
    s_waitcnt lgkmcnt(8)
    v_mfma_f32_16x16x32_bf16 v[44:47], a[8:11], a[84:87], v[44:47]
    ds_read_b128 a[4:7], v4 offset:0
    s_waitcnt lgkmcnt(8)
    v_mfma_f32_16x16x32_bf16 v[48:51], a[12:15], a[84:87], v[48:51]
    ds_read_b128 a[8:11], v4 offset:1024
    ds_read_b128 a[92:95], v36 offset:4096
    s_waitcnt lgkmcnt(9)
    v_mfma_f32_16x16x32_bf16 v[52:55], a[16:19], a[84:87], v[52:55]
    ds_read_b128 a[12:15], v4 offset:2048
    s_waitcnt lgkmcnt(9)
    v_mfma_f32_16x16x32_bf16 v[56:59], a[20:23], a[84:87], v[56:59]
    ds_read_b128 a[16:19], v4 offset:3072
    s_waitcnt lgkmcnt(8)
    v_mfma_f32_16x16x32_bf16 v[40:43], a[24:27], a[88:91], v[40:43]
    ds_read_b128 a[20:23], v4 offset:4096
    s_waitcnt lgkmcnt(8)
    v_mfma_f32_16x16x32_bf16 v[44:47], a[28:31], a[88:91], v[44:47]
    ds_read_b128 a[24:27], v4 offset:5120
    s_waitcnt lgkmcnt(8)
    v_mfma_f32_16x16x32_bf16 v[48:51], a[32:35], a[88:91], v[48:51]
    ds_read_b128 a[28:31], v4 offset:6144
    ds_read_b128 v[64:67], v36 offset:8192
    s_waitcnt lgkmcnt(9)
    v_mfma_f32_16x16x32_bf16 v[52:55], a[0:3], a[88:91], v[52:55]
    ds_read_b128 a[32:35], v4 offset:7168
    s_waitcnt lgkmcnt(9)
    v_mfma_f32_16x16x32_bf16 v[56:59], a[4:7], a[88:91], v[56:59]
    ds_read_b128 a[0:3], v4 offset:57344
    s_waitcnt lgkmcnt(8)
    v_mfma_f32_16x16x32_bf16 v[40:43], a[8:11], a[92:95], v[40:43]
    ds_read_b128 a[4:7], v4 offset:58368
    s_waitcnt lgkmcnt(8)
    v_mfma_f32_16x16x32_bf16 v[44:47], a[12:15], a[92:95], v[44:47]
    ds_read_b128 a[8:11], v4 offset:59392
    s_waitcnt lgkmcnt(8)
    v_mfma_f32_16x16x32_bf16 v[48:51], a[16:19], a[92:95], v[48:51]
    ds_read_b128 a[12:15], v4 offset:60416
    ds_read_b128 v[68:71], v36 offset:12288
    s_waitcnt lgkmcnt(9)
    v_mfma_f32_16x16x32_bf16 v[52:55], a[20:23], a[92:95], v[52:55]
    ds_read_b128 a[16:19], v4 offset:61440
    s_waitcnt lgkmcnt(9)
    v_mfma_f32_16x16x32_bf16 v[56:59], a[24:27], a[92:95], v[56:59]
    ds_read_b128 a[20:23], v4 offset:62464
    s_waitcnt lgkmcnt(8)
    v_mfma_f32_16x16x32_bf16 v[40:43], a[28:31], v[64:67], v[40:43]
    ds_read_b128 a[24:27], v4 offset:63488
    s_waitcnt lgkmcnt(8)
    v_mfma_f32_16x16x32_bf16 v[44:47], a[32:35], v[64:67], v[44:47]
    ds_read_b128 a[28:31], v4 offset:64512
    s_waitcnt lgkmcnt(8)
    v_mfma_f32_16x16x32_bf16 v[48:51], a[0:3], v[64:67], v[48:51]
    s_barrier
    ds_read_b128 a[32:35], v5 offset:0
    ds_read_b128 v[72:75], v36 offset:16384
    s_waitcnt lgkmcnt(9)
    v_mfma_f32_16x16x32_bf16 v[52:55], a[4:7], v[64:67], v[52:55]
    ds_read_b128 a[0:3], v5 offset:1024
    s_waitcnt lgkmcnt(9)
    v_mfma_f32_16x16x32_bf16 v[56:59], a[8:11], v[64:67], v[56:59]
    ds_read_b128 a[4:7], v5 offset:2048
    s_waitcnt lgkmcnt(8)
    v_mfma_f32_16x16x32_bf16 v[40:43], a[12:15], v[68:71], v[40:43]
    ds_read_b128 a[8:11], v5 offset:3072
    s_waitcnt lgkmcnt(8)
    v_mfma_f32_16x16x32_bf16 v[44:47], a[16:19], v[68:71], v[44:47]
    ds_read_b128 a[12:15], v5 offset:4096
    s_waitcnt lgkmcnt(8)
    v_mfma_f32_16x16x32_bf16 v[48:51], a[20:23], v[68:71], v[48:51]
    ds_read_b128 a[16:19], v5 offset:5120
    ds_read_b128 v[76:79], v36 offset:20480
    s_waitcnt lgkmcnt(9)
    v_mfma_f32_16x16x32_bf16 v[52:55], a[24:27], v[68:71], v[52:55]
    ds_read_b128 a[20:23], v5 offset:6144
    s_waitcnt lgkmcnt(9)
    v_mfma_f32_16x16x32_bf16 v[56:59], a[28:31], v[68:71], v[56:59]
    ds_read_b128 a[24:27], v5 offset:7168
    s_waitcnt lgkmcnt(8)
    v_mfma_f32_16x16x32_bf16 v[40:43], a[32:35], v[72:75], v[40:43]
    ds_read_b128 a[28:31], v5 offset:8192
    s_waitcnt lgkmcnt(8)
    v_mfma_f32_16x16x32_bf16 v[44:47], a[0:3], v[72:75], v[44:47]
    ds_read_b128 a[32:35], v5 offset:9216
    s_waitcnt lgkmcnt(8)
    v_mfma_f32_16x16x32_bf16 v[48:51], a[4:7], v[72:75], v[48:51]
    ds_read_b128 a[0:3], v5 offset:10240
    ds_read_b128 v[80:83], v37 offset:8192
    s_waitcnt lgkmcnt(9)
    v_mfma_f32_16x16x32_bf16 v[52:55], a[8:11], v[72:75], v[52:55]
    ds_read_b128 a[4:7], v5 offset:11264
    s_waitcnt lgkmcnt(9)
    v_mfma_f32_16x16x32_bf16 v[56:59], a[12:15], v[72:75], v[56:59]
    ds_read_b128 a[8:11], v5 offset:12288
    s_waitcnt lgkmcnt(8)
    v_mfma_f32_16x16x32_bf16 v[40:43], a[16:19], v[76:79], v[40:43]
    ds_read_b128 a[12:15], v5 offset:13312
    s_waitcnt lgkmcnt(8)
    v_mfma_f32_16x16x32_bf16 v[44:47], a[20:23], v[76:79], v[44:47]
    ds_read_b128 a[16:19], v5 offset:14336
    s_waitcnt lgkmcnt(8)
    v_mfma_f32_16x16x32_bf16 v[48:51], a[24:27], v[76:79], v[48:51]
    ds_read_b128 a[20:23], v5 offset:15360
    ds_read_b128 v[84:87], v37 offset:12288
    s_waitcnt lgkmcnt(9)
    v_mfma_f32_16x16x32_bf16 v[52:55], a[28:31], v[76:79], v[52:55]
    ds_read_b128 a[24:27], v4 offset:16384
    s_waitcnt lgkmcnt(9)
    v_mfma_f32_16x16x32_bf16 v[56:59], a[32:35], v[76:79], v[56:59]
    ds_read_b128 a[28:31], v4 offset:17408
    s_waitcnt lgkmcnt(8)
    v_mfma_f32_16x16x32_bf16 v[40:43], a[0:3], v[80:83], v[40:43]
    ds_read_b128 a[32:35], v4 offset:18432
    s_waitcnt lgkmcnt(8)
    v_mfma_f32_16x16x32_bf16 v[44:47], a[4:7], v[80:83], v[44:47]
    ds_read_b128 a[0:3], v4 offset:19456
    s_waitcnt lgkmcnt(8)
    v_mfma_f32_16x16x32_bf16 v[48:51], a[8:11], v[80:83], v[48:51]
    s_waitcnt lgkmcnt(7)
    v_mfma_f32_16x16x32_bf16 v[52:55], a[12:15], v[80:83], v[52:55]
    s_waitcnt lgkmcnt(6)
    v_mfma_f32_16x16x32_bf16 v[56:59], a[16:19], v[80:83], v[56:59]
    s_waitcnt lgkmcnt(4)
    v_mfma_f32_16x16x32_bf16 v[40:43], a[20:23], v[84:87], v[40:43]
    s_waitcnt lgkmcnt(3)
    v_mfma_f32_16x16x32_bf16 v[44:47], a[24:27], v[84:87], v[44:47]
    s_waitcnt lgkmcnt(2)
    v_mfma_f32_16x16x32_bf16 v[48:51], a[28:31], v[84:87], v[48:51]
    s_waitcnt lgkmcnt(1)
    v_mfma_f32_16x16x32_bf16 v[52:55], a[32:35], v[84:87], v[52:55]
    s_waitcnt lgkmcnt(0)
    v_mfma_f32_16x16x32_bf16 v[56:59], a[0:3], v[84:87], v[56:59]
    s_nop 0
    s_nop 4
    v_lshlrev_b32 v26, 16, v16
    v_and_b32 v27, 0xffff0000, v16
    v_lshlrev_b32 v28, 16, v17
    v_and_b32 v29, 0xffff0000, v17
    v_pk_add_f32 v[40:41], v[40:41], v[26:27]
    v_pk_add_f32 v[42:43], v[42:43], v[28:29]
    v_cvt_pk_bf16_f32 v16, v40, v41
    v_cvt_pk_bf16_f32 v17, v42, v43
    v_lshlrev_b32 v26, 16, v18
    v_and_b32 v27, 0xffff0000, v18
    v_lshlrev_b32 v28, 16, v19
    v_and_b32 v29, 0xffff0000, v19
    v_pk_add_f32 v[44:45], v[44:45], v[26:27]
    v_pk_add_f32 v[46:47], v[46:47], v[28:29]
    v_cvt_pk_bf16_f32 v18, v44, v45
    v_cvt_pk_bf16_f32 v19, v46, v47
    v_lshlrev_b32 v26, 16, v20
    v_and_b32 v27, 0xffff0000, v20
    v_lshlrev_b32 v28, 16, v21
    v_and_b32 v29, 0xffff0000, v21
    v_pk_add_f32 v[48:49], v[48:49], v[26:27]
    v_pk_add_f32 v[50:51], v[50:51], v[28:29]
    v_cvt_pk_bf16_f32 v20, v48, v49
    v_cvt_pk_bf16_f32 v21, v50, v51
    v_lshlrev_b32 v26, 16, v22
    v_and_b32 v27, 0xffff0000, v22
    v_lshlrev_b32 v28, 16, v23
    v_and_b32 v29, 0xffff0000, v23
    v_pk_add_f32 v[52:53], v[52:53], v[26:27]
    v_pk_add_f32 v[54:55], v[54:55], v[28:29]
    v_cvt_pk_bf16_f32 v22, v52, v53
    v_cvt_pk_bf16_f32 v23, v54, v55
    v_lshlrev_b32 v26, 16, v24
    v_and_b32 v27, 0xffff0000, v24
    v_lshlrev_b32 v28, 16, v25
    v_and_b32 v29, 0xffff0000, v25
    v_pk_add_f32 v[56:57], v[56:57], v[26:27]
    v_pk_add_f32 v[58:59], v[58:59], v[28:29]
    v_cvt_pk_bf16_f32 v24, v56, v57
    v_cvt_pk_bf16_f32 v25, v58, v59
    v_mov_b32 v30, v24
    v_mov_b32 v31, v25
    v_mov_b32 v32, v24
    v_mov_b32 v33, v25
    s_nop 1
    v_permlane16_swap_b32 v30, v32
    v_permlane16_swap_b32 v31, v33
    buffer_store_dwordx4 v[16:19], v6, s[4:7], s26 offen sc1
    buffer_store_dwordx4 v[20:23], v6, s[4:7], s26 offen offset:2048 sc1
    s_mov_b64 exec, s[36:37]
    buffer_store_dwordx4 v[30:33], v14, s[4:7], s27 offen sc1
    s_mov_b64 exec, -1
    s_mov_b32 s50, 0x3f803f80
    v_mov_b32 v26, 0
    v_mov_b32 v27, 0
    v_dot2c_f32_bf16 v26, s50, v16
    v_dot2c_f32_bf16 v27, v16, v16
    v_dot2c_f32_bf16 v26, s50, v17
    v_dot2c_f32_bf16 v27, v17, v17
    v_dot2c_f32_bf16 v26, s50, v18
    v_dot2c_f32_bf16 v27, v18, v18
    v_dot2c_f32_bf16 v26, s50, v19
    v_dot2c_f32_bf16 v27, v19, v19
    v_dot2c_f32_bf16 v26, s50, v20
    v_dot2c_f32_bf16 v27, v20, v20
    v_dot2c_f32_bf16 v26, s50, v21
    v_dot2c_f32_bf16 v27, v21, v21
    v_dot2c_f32_bf16 v26, s50, v22
    v_dot2c_f32_bf16 v27, v22, v22
    v_dot2c_f32_bf16 v26, s50, v23
    v_dot2c_f32_bf16 v27, v23, v23
    v_dot2c_f32_bf16 v26, s50, v24
    v_dot2c_f32_bf16 v27, v24, v24
    v_dot2c_f32_bf16 v26, s50, v25
    v_dot2c_f32_bf16 v27, v25, v25
    v_lshlrev_b32 v10, 3, v7
    s_nop 1
    v_mov_b32 v28, v26
    v_mov_b32 v29, v27
    s_nop 1
    v_permlane32_swap_b32 v28, v26
    v_permlane32_swap_b32 v29, v27
    s_nop 0
    v_add_f32 v26, v26, v28
    v_add_f32 v27, v27, v29
    v_mov_b32 v28, v26
    v_mov_b32 v29, v27
    s_nop 1
    v_permlane16_swap_b32 v28, v26
    v_permlane16_swap_b32 v29, v27
    s_nop 0
    v_add_f32 v26, v26, v28
    v_add_f32 v27, v27, v29
    s_mov_b64 exec, 0xffff
    buffer_store_dwordx2 v[26:27], v10, s[4:7], s28 offen sc1
    s_mov_b64 exec, -1
    s_mov_b32 s45, s22
    s_waitcnt vmcnt(0)
    s_barrier
    s_lshl_b32 s24, s12, 2
    s_add_u32 s24, s24, s23
    s_mul_i32 s20, s24, 40960
    s_add_u32 s20, s20, s18
    s_add_u32 s20, s20, 13762560
    v_lshlrev_b32 v13, 4, v8
    v_add_u32 v13, 147968, v13
    v_lshrrev_b32 v14, 1, v8
    v_lshlrev_b32 v14, 9, v14
    v_and_b32 v15, 1, v8
    v_lshl_add_u32 v14, v15, 8, v14
    v_lshl_add_u32 v14, v7, 4, v14
    s_mul_i32 s26, s24, 114688
    s_add_u32 s26, s26, s18
    s_add_u32 s26, s26, 16515072
    s_mul_i32 s27, s13, 3072
    s_add_u32 s27, s27, 12288
    s_cmp_eq_u32 s13, 15
    s_cselect_b32 s27, 111616, s27
    s_add_u32 s27, s27, s26
    s_lshl_b32 s50, s13, 12
    s_add_u32 s26, s26, s50
    s_cmp_lt_u32 s13, 3
    s_cselect_b32 s50, 0, 46080
    s_add_u32 s26, s26, s50
    v_add_u32 v36, s31, v3
    v_add_u32 v37, s31, v4
    v_add_u32 v38, s31, v5
    s_cmp_lg_u32 s45, 0
    s_cbranch_scc1 L_mega_kernel_polls_61
    s_lshl_b32 s53, s12, 4
    s_add_u32 s53, s53, s13
    s_lshl_b32 s50, s53, 7
    s_add_u32 s50, s50, s18
    s_add_u32 s50, s50, 23953408
    s_add_u32 s53, s3, 16
    s_mov_b32 s52, 0x400000
L_mega_kernel_sp_62:
    s_buffer_load_dword s51, s[4:7], s50 glc
    s_sub_u32 s52, s52, 1
    s_waitcnt lgkmcnt(0)
    s_cmp_lg_u32 s51, s53
    s_cbranch_scc0 L_mega_kernel_po_64
    s_and_b32 s51, s52, 31
    s_cbranch_scc1 L_mega_kernel_sp_62
    buffer_load_dword v9, off, s[4:7], s50 sc1
    s_cmp_eq_u32 s52, 0
    s_cbranch_scc1 L_mega_kernel_po_64
    s_waitcnt vmcnt(0)
    v_readfirstlane_b32 s51, v9
    s_cmp_lg_u32 s51, s53
    s_cbranch_scc1 L_mega_kernel_sp_62
L_mega_kernel_po_64:
L_mega_kernel_polls_61:
    s_barrier
    buffer_load_dwordx4 a[40:43], v6, s[4:7], s20 offen offset:0 sc1
    buffer_load_dwordx4 a[44:47], v6, s[4:7], s20 offen offset:256 sc1
    buffer_load_dwordx4 a[48:51], v6, s[4:7], s20 offen offset:2048 sc1
    buffer_load_dwordx4 a[52:55], v6, s[4:7], s20 offen offset:2304 sc1
    s_add_u32 s20, s20, 4096
    s_lshl_b32 s21, s24, 8
    s_add_u32 s21, s21, s18
    s_add_u32 s21, s21, 16384000
    s_add_u32 s25, s21, 16384
    v_lshlrev_b32 v10, 15, v8
    v_lshl_add_u32 v10, v7, 3, v10
    buffer_load_dwordx2 v[152:153], v10, s[4:7], s21 offen offset:0 sc1
    buffer_load_dwordx2 v[154:155], v10, s[4:7], s25 offen offset:0 sc1
    buffer_load_dwordx2 v[156:157], v10, s[4:7], s21 offen offset:128 sc1
    buffer_load_dwordx2 v[158:159], v10, s[4:7], s25 offen offset:128 sc1
    buffer_load_dwordx4 a[56:59], v6, s[4:7], s20 offen offset:0 sc1
    buffer_load_dwordx4 a[60:63], v6, s[4:7], s20 offen offset:256 sc1
    buffer_load_dwordx4 a[64:67], v6, s[4:7], s20 offen offset:2048 sc1
    buffer_load_dwordx4 a[68:71], v6, s[4:7], s20 offen offset:2304 sc1
    s_add_u32 s20, s20, 4096
    s_barrier
    ds_read_b128 a[0:3], v4 offset:20480
    ds_read_b128 a[4:7], v4 offset:21504
    ds_read_b128 a[8:11], v4 offset:22528
    ds_read_b128 a[12:15], v4 offset:23552
    ds_read_b128 a[16:19], v4 offset:24576
    ds_read_b128 a[20:23], v4 offset:25600
    ds_read_b128 a[24:27], v4 offset:26624
    ds_read_b128 a[28:31], v4 offset:27648
    s_waitcnt vmcnt(10) lgkmcnt(7)
    v_mfma_f32_16x16x32_bf16 v[40:43], a[0:3], a[40:43], 0
    ds_read_b128 a[32:35], v4 offset:28672
    v_mfma_f32_16x16x32_bf16 v[96:99], a[0:3], a[44:47], 0
    s_waitcnt lgkmcnt(7)
    v_mfma_f32_16x16x32_bf16 v[44:47], a[4:7], a[40:43], 0
    ds_read_b128 a[0:3], v4 offset:29696
    v_mfma_f32_16x16x32_bf16 v[100:103], a[4:7], a[44:47], 0
    s_waitcnt lgkmcnt(7)
    v_mfma_f32_16x16x32_bf16 v[48:51], a[8:11], a[40:43], 0
    ds_read_b128 a[4:7], v4 offset:30720
    v_mfma_f32_16x16x32_bf16 v[104:107], a[8:11], a[44:47], 0
    s_waitcnt lgkmcnt(7)
    v_mfma_f32_16x16x32_bf16 v[52:55], a[12:15], a[40:43], 0
    ds_read_b128 a[8:11], v4 offset:31744
    v_mfma_f32_16x16x32_bf16 v[108:111], a[12:15], a[44:47], 0
    s_waitcnt lgkmcnt(7)
    v_mfma_f32_16x16x32_bf16 v[56:59], a[16:19], a[40:43], 0
    ds_read_b128 a[12:15], v3 offset:24576
    v_mfma_f32_16x16x32_bf16 v[112:115], a[16:19], a[44:47], 0
    s_waitcnt lgkmcnt(7)
    v_mfma_f32_16x16x32_bf16 v[60:63], a[20:23], a[40:43], 0
    ds_read_b128 a[16:19], v3 offset:25600
    v_mfma_f32_16x16x32_bf16 v[116:119], a[20:23], a[44:47], 0
    s_waitcnt lgkmcnt(7)
    v_mfma_f32_16x16x32_bf16 v[64:67], a[24:27], a[40:43], 0
    ds_read_b128 a[20:23], v3 offset:26624
    v_mfma_f32_16x16x32_bf16 v[120:123], a[24:27], a[44:47], 0
    s_waitcnt lgkmcnt(7)
    v_mfma_f32_16x16x32_bf16 v[68:71], a[28:31], a[40:43], 0
    ds_read_b128 a[24:27], v3 offset:27648
    v_mfma_f32_16x16x32_bf16 v[124:127], a[28:31], a[44:47], 0
    s_waitcnt lgkmcnt(7)
    v_mfma_f32_16x16x32_bf16 v[72:75], a[32:35], a[40:43], 0
    ds_read_b128 a[28:31], v3 offset:28672
    v_mfma_f32_16x16x32_bf16 v[128:131], a[32:35], a[44:47], 0
    s_waitcnt lgkmcnt(7)
    v_mfma_f32_16x16x32_bf16 v[76:79], a[0:3], a[40:43], 0
    ds_read_b128 a[32:35], v3 offset:29696
    v_mfma_f32_16x16x32_bf16 v[132:135], a[0:3], a[44:47], 0
    s_waitcnt lgkmcnt(7)
    v_mfma_f32_16x16x32_bf16 v[80:83], a[4:7], a[40:43], 0
    ds_read_b128 a[0:3], v3 offset:30720
    v_mfma_f32_16x16x32_bf16 v[136:139], a[4:7], a[44:47], 0
    s_waitcnt lgkmcnt(7)
    v_mfma_f32_16x16x32_bf16 v[84:87], a[8:11], a[40:43], 0
    ds_read_b128 a[4:7], v3 offset:31744
    v_mfma_f32_16x16x32_bf16 v[140:143], a[8:11], a[44:47], 0
    s_waitcnt lgkmcnt(7)
    v_mfma_f32_16x16x32_bf16 v[88:91], a[12:15], a[40:43], 0
    ds_read_b128 a[8:11], v3 offset:32768
    v_mfma_f32_16x16x32_bf16 v[144:147], a[12:15], a[44:47], 0
    s_waitcnt lgkmcnt(7)
    v_mfma_f32_16x16x32_bf16 v[92:95], a[16:19], a[40:43], 0
    ds_read_b128 a[12:15], v3 offset:33792
    v_mfma_f32_16x16x32_bf16 v[148:151], a[16:19], a[44:47], 0
    s_waitcnt vmcnt(8) lgkmcnt(7)
    v_mfma_f32_16x16x32_bf16 v[40:43], a[20:23], a[48:51], v[40:43]
    ds_read_b128 a[16:19], v3 offset:34816
    v_mfma_f32_16x16x32_bf16 v[96:99], a[20:23], a[52:55], v[96:99]
    s_waitcnt lgkmcnt(7)
    v_mfma_f32_16x16x32_bf16 v[44:47], a[24:27], a[48:51], v[44:47]
    ds_read_b128 a[20:23], v3 offset:35840
    v_mfma_f32_16x16x32_bf16 v[100:103], a[24:27], a[52:55], v[100:103]
    s_waitcnt lgkmcnt(7)
    v_mfma_f32_16x16x32_bf16 v[48:51], a[28:31], a[48:51], v[48:51]
    ds_read_b128 a[24:27], v3 offset:36864
    v_mfma_f32_16x16x32_bf16 v[104:107], a[28:31], a[52:55], v[104:107]
    s_waitcnt lgkmcnt(7)
    v_mfma_f32_16x16x32_bf16 v[52:55], a[32:35], a[48:51], v[52:55]
    ds_read_b128 a[28:31], v3 offset:37888
    v_mfma_f32_16x16x32_bf16 v[108:111], a[32:35], a[52:55], v[108:111]
    s_waitcnt lgkmcnt(7)
    v_mfma_f32_16x16x32_bf16 v[56:59], a[0:3], a[48:51], v[56:59]
    ds_read_b128 a[32:35], v3 offset:38912
    v_mfma_f32_16x16x32_bf16 v[112:115], a[0:3], a[52:55], v[112:115]
    s_waitcnt lgkmcnt(7)
    v_mfma_f32_16x16x32_bf16 v[60:63], a[4:7], a[48:51], v[60:63]
    ds_read_b128 a[0:3], v3 offset:39936
    v_mfma_f32_16x16x32_bf16 v[116:119], a[4:7], a[52:55], v[116:119]
    s_waitcnt lgkmcnt(7)
    v_mfma_f32_16x16x32_bf16 v[64:67], a[8:11], a[48:51], v[64:67]
    ds_read_b128 a[4:7], v3 offset:40960
    v_mfma_f32_16x16x32_bf16 v[120:123], a[8:11], a[52:55], v[120:123]
    s_waitcnt lgkmcnt(7)
    v_mfma_f32_16x16x32_bf16 v[68:71], a[12:15], a[48:51], v[68:71]
    ds_read_b128 a[8:11], v3 offset:41984
    v_mfma_f32_16x16x32_bf16 v[124:127], a[12:15], a[52:55], v[124:127]
    s_waitcnt lgkmcnt(7)
    v_mfma_f32_16x16x32_bf16 v[72:75], a[16:19], a[48:51], v[72:75]
    ds_read_b128 a[12:15], v3 offset:43008
    v_mfma_f32_16x16x32_bf16 v[128:131], a[16:19], a[52:55], v[128:131]
    s_waitcnt lgkmcnt(7)
    v_mfma_f32_16x16x32_bf16 v[76:79], a[20:23], a[48:51], v[76:79]
    ds_read_b128 a[16:19], v3 offset:44032
    v_mfma_f32_16x16x32_bf16 v[132:135], a[20:23], a[52:55], v[132:135]
    s_waitcnt lgkmcnt(7)
    v_mfma_f32_16x16x32_bf16 v[80:83], a[24:27], a[48:51], v[80:83]
    ds_read_b128 a[20:23], v3 offset:45056
    v_mfma_f32_16x16x32_bf16 v[136:139], a[24:27], a[52:55], v[136:139]
    s_waitcnt lgkmcnt(7)
    v_mfma_f32_16x16x32_bf16 v[84:87], a[28:31], a[48:51], v[84:87]
    ds_read_b128 a[24:27], v3 offset:46080
    v_mfma_f32_16x16x32_bf16 v[140:143], a[28:31], a[52:55], v[140:143]
    s_waitcnt lgkmcnt(7)
    v_mfma_f32_16x16x32_bf16 v[88:91], a[32:35], a[48:51], v[88:91]
    ds_read_b128 a[28:31], v3 offset:47104
    v_mfma_f32_16x16x32_bf16 v[144:147], a[32:35], a[52:55], v[144:147]
    s_waitcnt lgkmcnt(7)
    v_mfma_f32_16x16x32_bf16 v[92:95], a[0:3], a[48:51], v[92:95]
    ds_read_b128 a[32:35], v3 offset:48128
    v_mfma_f32_16x16x32_bf16 v[148:151], a[0:3], a[52:55], v[148:151]
    s_waitcnt vmcnt(2) lgkmcnt(7)
    v_mfma_f32_16x16x32_bf16 v[40:43], a[4:7], a[56:59], v[40:43]
    ds_read_b128 a[0:3], v4 offset:32768
    v_add_f32 v26, v152, v154
    v_mfma_f32_16x16x32_bf16 v[96:99], a[4:7], a[60:63], v[96:99]
    v_add_f32 v28, v153, v155
    s_waitcnt lgkmcnt(7)
    v_mfma_f32_16x16x32_bf16 v[44:47], a[8:11], a[56:59], v[44:47]
    ds_read_b128 a[4:7], v4 offset:33792
    v_add_f32 v27, v156, v158
    v_mfma_f32_16x16x32_bf16 v[100:103], a[8:11], a[60:63], v[100:103]
    v_add_f32 v29, v157, v159
    s_waitcnt lgkmcnt(7)
    v_mfma_f32_16x16x32_bf16 v[48:51], a[12:15], a[56:59], v[48:51]
    ds_read_b128 a[8:11], v4 offset:34816
    v_mov_b32 v152, v26
    v_mfma_f32_16x16x32_bf16 v[104:107], a[12:15], a[60:63], v[104:107]
    v_mov_b32 v153, v27
    s_waitcnt lgkmcnt(7)
    v_mfma_f32_16x16x32_bf16 v[52:55], a[16:19], a[56:59], v[52:55]
    ds_read_b128 a[12:15], v4 offset:35840
    v_mov_b32 v154, v28
    v_mfma_f32_16x16x32_bf16 v[108:111], a[16:19], a[60:63], v[108:111]
    v_mov_b32 v155, v29
    s_waitcnt lgkmcnt(7)
    v_mfma_f32_16x16x32_bf16 v[56:59], a[20:23], a[56:59], v[56:59]
    ds_read_b128 a[16:19], v4 offset:36864
    v_permlane32_swap_b32 v152, v26
    v_mfma_f32_16x16x32_bf16 v[112:115], a[20:23], a[60:63], v[112:115]
    v_permlane32_swap_b32 v153, v27
    s_waitcnt lgkmcnt(7)
    v_mfma_f32_16x16x32_bf16 v[60:63], a[24:27], a[56:59], v[60:63]
    ds_read_b128 a[20:23], v4 offset:37888
    v_permlane32_swap_b32 v154, v28
    v_mfma_f32_16x16x32_bf16 v[116:119], a[24:27], a[60:63], v[116:119]
    v_permlane32_swap_b32 v155, v29
    s_waitcnt lgkmcnt(7)
    v_mfma_f32_16x16x32_bf16 v[64:67], a[28:31], a[56:59], v[64:67]
    ds_read_b128 a[24:27], v4 offset:38912
    v_add_f32 v26, v26, v152
    v_mfma_f32_16x16x32_bf16 v[120:123], a[28:31], a[60:63], v[120:123]
    v_add_f32 v27, v27, v153
    s_waitcnt lgkmcnt(7)
    v_mfma_f32_16x16x32_bf16 v[68:71], a[32:35], a[56:59], v[68:71]
    ds_read_b128 a[28:31], v4 offset:39936
    v_add_f32 v28, v28, v154
    v_mfma_f32_16x16x32_bf16 v[124:127], a[32:35], a[60:63], v[124:127]
    v_add_f32 v29, v29, v155
    s_waitcnt lgkmcnt(7)
    v_mfma_f32_16x16x32_bf16 v[72:75], a[0:3], a[56:59], v[72:75]
    ds_read_b128 a[32:35], v4 offset:40960
    v_mov_b32 v152, v26
    v_mfma_f32_16x16x32_bf16 v[128:131], a[0:3], a[60:63], v[128:131]
    v_mov_b32 v153, v27
    s_waitcnt lgkmcnt(7)
    v_mfma_f32_16x16x32_bf16 v[76:79], a[4:7], a[56:59], v[76:79]
    ds_read_b128 a[0:3], v4 offset:41984
    v_mov_b32 v154, v28
    v_mfma_f32_16x16x32_bf16 v[132:135], a[4:7], a[60:63], v[132:135]
    v_mov_b32 v155, v29
    s_waitcnt lgkmcnt(7)
    v_mfma_f32_16x16x32_bf16 v[80:83], a[8:11], a[56:59], v[80:83]
    ds_read_b128 a[4:7], v4 offset:43008
    v_permlane16_swap_b32 v152, v26
    v_mfma_f32_16x16x32_bf16 v[136:139], a[8:11], a[60:63], v[136:139]
    v_permlane16_swap_b32 v153, v27
    s_waitcnt lgkmcnt(7)
    v_mfma_f32_16x16x32_bf16 v[84:87], a[12:15], a[56:59], v[84:87]
    ds_read_b128 a[8:11], v4 offset:44032
    v_permlane16_swap_b32 v154, v28
    v_mfma_f32_16x16x32_bf16 v[140:143], a[12:15], a[60:63], v[140:143]
    v_permlane16_swap_b32 v155, v29
    s_waitcnt lgkmcnt(7)
    v_mfma_f32_16x16x32_bf16 v[88:91], a[16:19], a[56:59], v[88:91]
    ds_read_b128 a[12:15], v4 offset:45056
    v_add_f32 v26, v26, v152
    v_mfma_f32_16x16x32_bf16 v[144:147], a[16:19], a[60:63], v[144:147]
    v_add_f32 v27, v27, v153
    s_waitcnt lgkmcnt(7)
    v_mfma_f32_16x16x32_bf16 v[92:95], a[20:23], a[56:59], v[92:95]
    ds_read_b128 a[16:19], v4 offset:46080
    v_add_f32 v28, v28, v154
    v_mfma_f32_16x16x32_bf16 v[148:151], a[20:23], a[60:63], v[148:151]
    v_add_f32 v29, v29, v155
    s_waitcnt vmcnt(0) lgkmcnt(7)
    v_mfma_f32_16x16x32_bf16 v[40:43], a[24:27], a[64:67], v[40:43]
    ds_read_b128 a[20:23], v4 offset:47104
    v_mul_f32 v26, 0x3acccccd, v26
    v_mfma_f32_16x16x32_bf16 v[96:99], a[24:27], a[68:71], v[96:99]
    v_mul_f32 v27, 0x3acccccd, v27
    s_waitcnt lgkmcnt(7)
    v_mfma_f32_16x16x32_bf16 v[44:47], a[28:31], a[64:67], v[44:47]
    ds_read_b128 a[24:27], v4 offset:48128
    v_mul_f32 v28, 0x3acccccd, v28
    v_mfma_f32_16x16x32_bf16 v[100:103], a[28:31], a[68:71], v[100:103]
    v_mul_f32 v29, 0x3acccccd, v29
    s_waitcnt lgkmcnt(7)
    v_mfma_f32_16x16x32_bf16 v[48:51], a[32:35], a[64:67], v[48:51]
    ds_read_b128 a[28:31], v4 offset:49152
    v_fma_f32 v28, -v26, v26, v28
    v_mfma_f32_16x16x32_bf16 v[104:107], a[32:35], a[68:71], v[104:107]
    v_max_f32 v28, 0, v28
    s_waitcnt lgkmcnt(7)
    v_mfma_f32_16x16x32_bf16 v[52:55], a[0:3], a[64:67], v[52:55]
    ds_read_b128 a[32:35], v4 offset:50176
    v_add_f32 v28, 0x3727c5ac, v28
    v_mfma_f32_16x16x32_bf16 v[108:111], a[0:3], a[68:71], v[108:111]
    v_fma_f32 v29, -v27, v27, v29
    s_waitcnt lgkmcnt(7)
    v_mfma_f32_16x16x32_bf16 v[56:59], a[4:7], a[64:67], v[56:59]
    ds_read_b128 a[0:3], v4 offset:51200
    v_max_f32 v29, 0, v29
    v_mfma_f32_16x16x32_bf16 v[112:115], a[4:7], a[68:71], v[112:115]
    v_add_f32 v29, 0x3727c5ac, v29
    s_waitcnt lgkmcnt(7)
    v_mfma_f32_16x16x32_bf16 v[60:63], a[8:11], a[64:67], v[60:63]
    ds_read_b128 a[4:7], v4 offset:52224
    v_rcp_f32 v30, v28
    v_mfma_f32_16x16x32_bf16 v[116:119], a[8:11], a[68:71], v[116:119]
    v_rcp_f32 v31, v29
    s_waitcnt lgkmcnt(7)
    v_mfma_f32_16x16x32_bf16 v[64:67], a[12:15], a[64:67], v[64:67]
    s_barrier
    ds_read_b128 a[8:11], v3 offset:53248
    v_sub_f32 v28, 0, v27
    v_mfma_f32_16x16x32_bf16 v[120:123], a[12:15], a[68:71], v[120:123]
    ds_read_b128 a[72:75], v37 offset:53248
    v_sub_f32 v26, 0, v26
    s_waitcnt lgkmcnt(8)
    v_mfma_f32_16x16x32_bf16 v[68:71], a[16:19], a[64:67], v[68:71]
    ds_read_b128 a[12:15], v3 offset:54272
    v_mov_b32 v27, v30
    v_mfma_f32_16x16x32_bf16 v[124:127], a[16:19], a[68:71], v[124:127]
    ds_read_b128 a[76:79], v36 offset:49152
    v_mov_b32 v29, v31
    s_waitcnt lgkmcnt(9)
    v_mfma_f32_16x16x32_bf16 v[72:75], a[20:23], a[64:67], v[72:75]
    ds_read_b128 a[16:19], v3 offset:55296
    ds_read_b128 v[152:155], v13 offset:0
    v_mfma_f32_16x16x32_bf16 v[128:131], a[20:23], a[68:71], v[128:131]
    s_waitcnt lgkmcnt(10)
    v_mfma_f32_16x16x32_bf16 v[76:79], a[24:27], a[64:67], v[76:79]
    ds_read_b128 a[20:23], v3 offset:56320
    v_mfma_f32_16x16x32_bf16 v[132:135], a[24:27], a[68:71], v[132:135]
    s_waitcnt lgkmcnt(10)
    v_mfma_f32_16x16x32_bf16 v[80:83], a[28:31], a[64:67], v[80:83]
    ds_read_b128 a[24:27], v3 offset:57344
    v_mfma_f32_16x16x32_bf16 v[136:139], a[28:31], a[68:71], v[136:139]
    s_waitcnt lgkmcnt(10)
    v_mfma_f32_16x16x32_bf16 v[84:87], a[32:35], a[64:67], v[84:87]
    ds_read_b128 a[28:31], v3 offset:58368
    v_mfma_f32_16x16x32_bf16 v[140:143], a[32:35], a[68:71], v[140:143]
    s_waitcnt lgkmcnt(10)
    v_mfma_f32_16x16x32_bf16 v[88:91], a[0:3], a[64:67], v[88:91]
    ds_read_b128 a[32:35], v3 offset:59392
    ds_read_b128 v[156:159], v13 offset:64
    v_mfma_f32_16x16x32_bf16 v[144:147], a[0:3], a[68:71], v[144:147]
    s_waitcnt lgkmcnt(11)
    v_mfma_f32_16x16x32_bf16 v[92:95], a[4:7], a[64:67], v[92:95]
    ds_read_b128 a[0:3], v3 offset:60416
    v_mfma_f32_16x16x32_bf16 v[148:151], a[4:7], a[68:71], v[148:151]
    s_waitcnt lgkmcnt(8)
    v_mfma_f32_16x16x32_bf16 v[40:43], a[8:11], a[72:75], v[40:43]
    ds_read_b128 a[4:7], v3 offset:61440
    v_mfma_f32_16x16x32_bf16 v[96:99], a[8:11], a[76:79], v[96:99]
    s_waitcnt lgkmcnt(10)
    v_mfma_f32_16x16x32_bf16 v[44:47], a[12:15], a[72:75], v[44:47]
    ds_read_b128 a[8:11], v3 offset:62464
    v_mfma_f32_16x16x32_bf16 v[100:103], a[12:15], a[76:79], v[100:103]
    s_waitcnt lgkmcnt(9)
    v_mfma_f32_16x16x32_bf16 v[48:51], a[16:19], a[72:75], v[48:51]
    ds_read_b128 a[12:15], v3 offset:63488
    ds_read_b128 v[32:35], v13 offset:448
    v_mfma_f32_16x16x32_bf16 v[104:107], a[16:19], a[76:79], v[104:107]
    s_waitcnt lgkmcnt(9)
    v_mfma_f32_16x16x32_bf16 v[52:55], a[20:23], a[72:75], v[52:55]
    ds_read_b128 a[16:19], v3 offset:64512
    v_mfma_f32_16x16x32_bf16 v[108:111], a[20:23], a[76:79], v[108:111]
    s_waitcnt lgkmcnt(9)
    v_mfma_f32_16x16x32_bf16 v[56:59], a[24:27], a[72:75], v[56:59]
    ds_read_b128 a[20:23], v4 offset:0
    v_mfma_f32_16x16x32_bf16 v[112:115], a[24:27], a[76:79], v[112:115]
    s_waitcnt lgkmcnt(9)
    v_mfma_f32_16x16x32_bf16 v[60:63], a[28:31], a[72:75], v[60:63]
    ds_read_b128 a[24:27], v4 offset:1024
    v_fmac_f32 v40, v152, v26
    v_mfma_f32_16x16x32_bf16 v[116:119], a[28:31], a[76:79], v[116:119]
    v_fmac_f32 v41, v153, v26
    s_waitcnt lgkmcnt(9)
    v_mfma_f32_16x16x32_bf16 v[64:67], a[32:35], a[72:75], v[64:67]
    s_barrier
    ds_read_b128 a[28:31], v4 offset:2048
    v_fmac_f32 v42, v154, v26
    v_mfma_f32_16x16x32_bf16 v[120:123], a[32:35], a[76:79], v[120:123]
    ds_read_b128 a[80:83], v37 offset:4096
    v_fmac_f32 v43, v155, v26
    s_waitcnt lgkmcnt(9)
    v_mfma_f32_16x16x32_bf16 v[68:71], a[0:3], a[72:75], v[68:71]
    ds_read_b128 a[32:35], v4 offset:3072
    v_fmac_f32 v96, v152, v28
    v_mfma_f32_16x16x32_bf16 v[124:127], a[0:3], a[76:79], v[124:127]
    ds_read_b128 a[84:87], v37 offset:57344
    v_fmac_f32 v97, v153, v28
    s_waitcnt lgkmcnt(10)
    v_mfma_f32_16x16x32_bf16 v[72:75], a[4:7], a[72:75], v[72:75]
    ds_read_b128 a[0:3], v4 offset:61440
    v_fmac_f32 v98, v154, v28
    v_mfma_f32_16x16x32_bf16 v[128:131], a[4:7], a[76:79], v[128:131]
    v_fmac_f32 v99, v155, v28
    s_waitcnt lgkmcnt(10)
    v_mfma_f32_16x16x32_bf16 v[76:79], a[8:11], a[72:75], v[76:79]
    ds_read_b128 a[4:7], v4 offset:62464
    v_fmac_f32 v44, v156, v26
    v_fmac_f32 v45, v157, v26
    v_mfma_f32_16x16x32_bf16 v[132:135], a[8:11], a[76:79], v[132:135]
    ds_read_b128 v[152:155], v13 offset:128
    s_waitcnt lgkmcnt(11)
    v_mfma_f32_16x16x32_bf16 v[80:83], a[12:15], a[72:75], v[80:83]
    ds_read_b128 a[8:11], v4 offset:63488
    v_fmac_f32 v46, v158, v26
    v_mfma_f32_16x16x32_bf16 v[136:139], a[12:15], a[76:79], v[136:139]
    v_fmac_f32 v47, v159, v26
    s_waitcnt lgkmcnt(10)
    v_mfma_f32_16x16x32_bf16 v[84:87], a[16:19], a[72:75], v[84:87]
    ds_read_b128 a[12:15], v4 offset:64512
    v_fmac_f32 v100, v156, v28
    v_mfma_f32_16x16x32_bf16 v[140:143], a[16:19], a[76:79], v[140:143]
    v_fmac_f32 v101, v157, v28
    s_waitcnt lgkmcnt(10)
    v_mfma_f32_16x16x32_bf16 v[88:91], a[20:23], a[72:75], v[88:91]
    ds_read_b128 a[16:19], v5 offset:0
    v_fmac_f32 v102, v158, v28
    v_mfma_f32_16x16x32_bf16 v[144:147], a[20:23], a[76:79], v[144:147]
    v_fmac_f32 v103, v159, v28
    s_waitcnt lgkmcnt(10)
    v_mfma_f32_16x16x32_bf16 v[92:95], a[24:27], a[72:75], v[92:95]
    ds_read_b128 a[20:23], v5 offset:1024
    v_fmac_f32 v68, v32, v26
    v_fmac_f32 v69, v33, v26
    v_mfma_f32_16x16x32_bf16 v[148:151], a[24:27], a[76:79], v[148:151]
    ds_read_b128 v[156:159], v13 offset:192
    s_waitcnt lgkmcnt(8)
    v_mfma_f32_16x16x32_bf16 v[40:43], a[28:31], a[80:83], v[40:43]
    ds_read_b128 a[24:27], v5 offset:2048
    v_fmac_f32 v70, v34, v26
    v_mfma_f32_16x16x32_bf16 v[96:99], a[28:31], a[84:87], v[96:99]
    v_fmac_f32 v71, v35, v26
    s_waitcnt lgkmcnt(10)
    v_mfma_f32_16x16x32_bf16 v[44:47], a[32:35], a[80:83], v[44:47]
    ds_read_b128 a[28:31], v5 offset:3072
    v_fmac_f32 v124, v32, v28
    v_mfma_f32_16x16x32_bf16 v[100:103], a[32:35], a[84:87], v[100:103]
    v_fmac_f32 v125, v33, v28
    s_waitcnt lgkmcnt(9)
    v_mfma_f32_16x16x32_bf16 v[48:51], a[0:3], a[80:83], v[48:51]
    ds_read_b128 a[32:35], v5 offset:4096
    v_fmac_f32 v126, v34, v28
    v_mfma_f32_16x16x32_bf16 v[104:107], a[0:3], a[84:87], v[104:107]
    v_fmac_f32 v127, v35, v28
    s_waitcnt lgkmcnt(9)
    v_mfma_f32_16x16x32_bf16 v[52:55], a[4:7], a[80:83], v[52:55]
    ds_read_b128 a[0:3], v5 offset:5120
    ds_read_b128 v[32:35], v13 offset:512
    v_mfma_f32_16x16x32_bf16 v[108:111], a[4:7], a[84:87], v[108:111]
    s_waitcnt lgkmcnt(9)
    v_mfma_f32_16x16x32_bf16 v[56:59], a[8:11], a[80:83], v[56:59]
    ds_read_b128 a[4:7], v5 offset:6144
    v_mfma_f32_16x16x32_bf16 v[112:115], a[8:11], a[84:87], v[112:115]
    s_waitcnt lgkmcnt(9)
    v_mfma_f32_16x16x32_bf16 v[60:63], a[12:15], a[80:83], v[60:63]
    ds_read_b128 a[8:11], v5 offset:7168
    v_mfma_f32_16x16x32_bf16 v[116:119], a[12:15], a[84:87], v[116:119]
    s_waitcnt lgkmcnt(9)
    v_mfma_f32_16x16x32_bf16 v[64:67], a[16:19], a[80:83], v[64:67]
    s_barrier
    ds_read_b128 a[12:15], v3 offset:0
    v_fmac_f32 v48, v152, v26
    v_mfma_f32_16x16x32_bf16 v[120:123], a[16:19], a[84:87], v[120:123]
    ds_read_b128 a[88:91], v38 offset:8192
    v_fmac_f32 v49, v153, v26
    s_waitcnt lgkmcnt(10)
    v_mfma_f32_16x16x32_bf16 v[68:71], a[20:23], a[80:83], v[68:71]
    ds_read_b128 a[16:19], v3 offset:1024
    v_fmac_f32 v50, v154, v26
    v_mfma_f32_16x16x32_bf16 v[124:127], a[20:23], a[84:87], v[124:127]
    ds_read_b128 a[92:95], v38 offset:12288
    v_fmac_f32 v51, v155, v26
    s_waitcnt lgkmcnt(10)
    v_mfma_f32_16x16x32_bf16 v[72:75], a[24:27], a[80:83], v[72:75]
    ds_read_b128 a[20:23], v3 offset:2048
    v_fmac_f32 v104, v152, v28
    v_mfma_f32_16x16x32_bf16 v[128:131], a[24:27], a[84:87], v[128:131]
    v_fmac_f32 v105, v153, v28
    s_waitcnt lgkmcnt(10)
    v_mfma_f32_16x16x32_bf16 v[76:79], a[28:31], a[80:83], v[76:79]
    ds_read_b128 a[24:27], v3 offset:3072
    v_fmac_f32 v106, v154, v28
    v_mfma_f32_16x16x32_bf16 v[132:135], a[28:31], a[84:87], v[132:135]
    v_fmac_f32 v107, v155, v28
    s_waitcnt lgkmcnt(10)
    v_mfma_f32_16x16x32_bf16 v[80:83], a[32:35], a[80:83], v[80:83]
    ds_read_b128 a[28:31], v3 offset:4096
    v_fmac_f32 v52, v156, v26
    v_fmac_f32 v53, v157, v26
    v_mfma_f32_16x16x32_bf16 v[136:139], a[32:35], a[84:87], v[136:139]
    ds_read_b128 v[152:155], v13 offset:256
    s_waitcnt lgkmcnt(11)
    v_mfma_f32_16x16x32_bf16 v[84:87], a[0:3], a[80:83], v[84:87]
    ds_read_b128 a[32:35], v3 offset:5120
    v_fmac_f32 v54, v158, v26
    v_mfma_f32_16x16x32_bf16 v[140:143], a[0:3], a[84:87], v[140:143]
    v_fmac_f32 v55, v159, v26
    s_waitcnt lgkmcnt(10)
    v_mfma_f32_16x16x32_bf16 v[88:91], a[4:7], a[80:83], v[88:91]
    ds_read_b128 a[0:3], v3 offset:6144
    v_fmac_f32 v108, v156, v28
    v_mfma_f32_16x16x32_bf16 v[144:147], a[4:7], a[84:87], v[144:147]
    v_fmac_f32 v109, v157, v28
    s_waitcnt lgkmcnt(10)
    v_mfma_f32_16x16x32_bf16 v[92:95], a[8:11], a[80:83], v[92:95]
    ds_read_b128 a[4:7], v3 offset:7168
    v_fmac_f32 v110, v158, v28
    v_mfma_f32_16x16x32_bf16 v[148:151], a[8:11], a[84:87], v[148:151]
    v_fmac_f32 v111, v159, v28
    s_waitcnt lgkmcnt(7)
    v_mfma_f32_16x16x32_bf16 v[40:43], a[12:15], a[88:91], v[40:43]
    ds_read_b128 a[8:11], v3 offset:8192
    v_fmac_f32 v72, v32, v26
    v_fmac_f32 v73, v33, v26
    v_mfma_f32_16x16x32_bf16 v[96:99], a[12:15], a[92:95], v[96:99]
    ds_read_b128 v[156:159], v13 offset:320
    s_waitcnt lgkmcnt(10)
    v_mfma_f32_16x16x32_bf16 v[44:47], a[16:19], a[88:91], v[44:47]
    ds_read_b128 a[12:15], v3 offset:9216
    v_fmac_f32 v74, v34, v26
    v_mfma_f32_16x16x32_bf16 v[100:103], a[16:19], a[92:95], v[100:103]
    v_fmac_f32 v75, v35, v26
    s_waitcnt lgkmcnt(9)
    v_mfma_f32_16x16x32_bf16 v[48:51], a[20:23], a[88:91], v[48:51]
    ds_read_b128 a[16:19], v3 offset:10240
    v_fmac_f32 v128, v32, v28
    v_mfma_f32_16x16x32_bf16 v[104:107], a[20:23], a[92:95], v[104:107]
    v_fmac_f32 v129, v33, v28
    s_waitcnt lgkmcnt(9)
    v_mfma_f32_16x16x32_bf16 v[52:55], a[24:27], a[88:91], v[52:55]
    ds_read_b128 a[20:23], v3 offset:11264
    v_fmac_f32 v130, v34, v28
    v_mfma_f32_16x16x32_bf16 v[108:111], a[24:27], a[92:95], v[108:111]
    v_fmac_f32 v131, v35, v28
    s_waitcnt lgkmcnt(9)
    v_mfma_f32_16x16x32_bf16 v[56:59], a[28:31], a[88:91], v[56:59]
    ds_read_b128 a[24:27], v3 offset:12288
    ds_read_b128 v[32:35], v13 offset:576
    v_mfma_f32_16x16x32_bf16 v[112:115], a[28:31], a[92:95], v[112:115]
    s_waitcnt lgkmcnt(9)
    v_mfma_f32_16x16x32_bf16 v[60:63], a[32:35], a[88:91], v[60:63]
    ds_read_b128 a[28:31], v3 offset:13312
    v_mfma_f32_16x16x32_bf16 v[116:119], a[32:35], a[92:95], v[116:119]
    s_waitcnt lgkmcnt(9)
    v_mfma_f32_16x16x32_bf16 v[64:67], a[0:3], a[88:91], v[64:67]
    s_barrier
    ds_read_b128 a[32:35], v3 offset:14336
    v_mfma_f32_16x16x32_bf16 v[120:123], a[0:3], a[92:95], v[120:123]
    ds_read_b128 a[40:43], v36 offset:16384
    s_waitcnt lgkmcnt(10)
    v_mfma_f32_16x16x32_bf16 v[68:71], a[4:7], a[88:91], v[68:71]
    ds_read_b128 a[0:3], v3 offset:15360
    v_fmac_f32 v56, v152, v26
    v_mfma_f32_16x16x32_bf16 v[124:127], a[4:7], a[92:95], v[124:127]
    ds_read_b128 a[44:47], v36 offset:20480
    v_fmac_f32 v57, v153, v26
    s_waitcnt lgkmcnt(11)
    v_mfma_f32_16x16x32_bf16 v[72:75], a[8:11], a[88:91], v[72:75]
    ds_read_b128 a[4:7], v4 offset:8192
    v_fmac_f32 v58, v154, v26
    v_mfma_f32_16x16x32_bf16 v[128:131], a[8:11], a[92:95], v[128:131]
    v_fmac_f32 v59, v155, v26
    s_waitcnt lgkmcnt(10)
    v_mfma_f32_16x16x32_bf16 v[76:79], a[12:15], a[88:91], v[76:79]
    ds_read_b128 a[8:11], v4 offset:9216
    v_fmac_f32 v112, v152, v28
    v_mfma_f32_16x16x32_bf16 v[132:135], a[12:15], a[92:95], v[132:135]
    v_fmac_f32 v113, v153, v28
    s_waitcnt lgkmcnt(10)
    v_mfma_f32_16x16x32_bf16 v[80:83], a[16:19], a[88:91], v[80:83]
    ds_read_b128 a[12:15], v4 offset:10240
    v_fmac_f32 v114, v154, v28
    v_mfma_f32_16x16x32_bf16 v[136:139], a[16:19], a[92:95], v[136:139]
    v_fmac_f32 v115, v155, v28
    s_waitcnt lgkmcnt(10)
    v_mfma_f32_16x16x32_bf16 v[84:87], a[20:23], a[88:91], v[84:87]
    ds_read_b128 a[16:19], v4 offset:11264
    v_fmac_f32 v60, v156, v26
    v_mfma_f32_16x16x32_bf16 v[140:143], a[20:23], a[92:95], v[140:143]
    v_fmac_f32 v61, v157, v26
    s_waitcnt lgkmcnt(10)
    v_mfma_f32_16x16x32_bf16 v[88:91], a[24:27], a[88:91], v[88:91]
    ds_read_b128 a[20:23], v4 offset:12288
    v_fmac_f32 v62, v158, v26
    v_fmac_f32 v63, v159, v26
    v_mfma_f32_16x16x32_bf16 v[144:147], a[24:27], a[92:95], v[144:147]
    ds_read_b128 v[152:155], v13 offset:384
    s_waitcnt lgkmcnt(10)
    v_mfma_f32_16x16x32_bf16 v[92:95], a[28:31], a[88:91], v[92:95]
    ds_read_b128 a[24:27], v4 offset:13312
    v_fmac_f32 v116, v156, v28
    v_mfma_f32_16x16x32_bf16 v[148:151], a[28:31], a[92:95], v[148:151]
    v_fmac_f32 v117, v157, v28
    s_waitcnt lgkmcnt(7)
    v_mfma_f32_16x16x32_bf16 v[40:43], a[32:35], a[40:43], v[40:43]
    ds_read_b128 a[28:31], v4 offset:14336
    v_fmac_f32 v118, v158, v28
    v_mfma_f32_16x16x32_bf16 v[96:99], a[32:35], a[44:47], v[96:99]
    v_fmac_f32 v119, v159, v28
    s_waitcnt lgkmcnt(9)
    v_mfma_f32_16x16x32_bf16 v[44:47], a[0:3], a[40:43], v[44:47]
    ds_read_b128 a[32:35], v4 offset:15360
    v_fmac_f32 v76, v32, v26
    v_mfma_f32_16x16x32_bf16 v[100:103], a[0:3], a[44:47], v[100:103]
    v_fmac_f32 v77, v33, v26
    s_waitcnt lgkmcnt(8)
    v_mfma_f32_16x16x32_bf16 v[48:51], a[4:7], a[40:43], v[48:51]
    ds_read_b128 a[0:3], v4 offset:16384
    v_fmac_f32 v78, v34, v26
    v_fmac_f32 v79, v35, v26
    v_mfma_f32_16x16x32_bf16 v[104:107], a[4:7], a[44:47], v[104:107]
    ds_read_b128 v[156:159], v13 offset:640
    s_waitcnt lgkmcnt(9)
    v_mfma_f32_16x16x32_bf16 v[52:55], a[8:11], a[40:43], v[52:55]
    ds_read_b128 a[4:7], v4 offset:17408
    v_fmac_f32 v132, v32, v28
    v_mfma_f32_16x16x32_bf16 v[108:111], a[8:11], a[44:47], v[108:111]
    v_fmac_f32 v133, v33, v28
    s_waitcnt lgkmcnt(9)
    v_mfma_f32_16x16x32_bf16 v[56:59], a[12:15], a[40:43], v[56:59]
    ds_read_b128 a[8:11], v4 offset:18432
    v_fmac_f32 v134, v34, v28
    v_mfma_f32_16x16x32_bf16 v[112:115], a[12:15], a[44:47], v[112:115]
    v_fmac_f32 v135, v35, v28
    s_waitcnt lgkmcnt(9)
    v_mfma_f32_16x16x32_bf16 v[60:63], a[16:19], a[40:43], v[60:63]
    ds_read_b128 a[12:15], v4 offset:19456
    v_mfma_f32_16x16x32_bf16 v[116:119], a[16:19], a[44:47], v[116:119]
    s_waitcnt lgkmcnt(9)
    v_mfma_f32_16x16x32_bf16 v[64:67], a[20:23], a[40:43], v[64:67]
    s_barrier
    ds_read_b128 a[16:19], v4 offset:28672
    ds_read_b128 v[32:35], v13 offset:704
    v_mfma_f32_16x16x32_bf16 v[120:123], a[20:23], a[44:47], v[120:123]
    ds_read_b128 a[48:51], v37 offset:20480
    s_waitcnt lgkmcnt(10)
    v_mfma_f32_16x16x32_bf16 v[68:71], a[24:27], a[40:43], v[68:71]
    ds_read_b128 a[20:23], v4 offset:29696
    v_mfma_f32_16x16x32_bf16 v[124:127], a[24:27], a[44:47], v[124:127]
    ds_read_b128 a[52:55], v37 offset:24576
    s_waitcnt lgkmcnt(11)
    v_mfma_f32_16x16x32_bf16 v[72:75], a[28:31], a[40:43], v[72:75]
    ds_read_b128 a[24:27], v4 offset:30720
    v_mfma_f32_16x16x32_bf16 v[128:131], a[28:31], a[44:47], v[128:131]
    s_waitcnt lgkmcnt(11)
    v_mfma_f32_16x16x32_bf16 v[76:79], a[32:35], a[40:43], v[76:79]
    ds_read_b128 a[28:31], v4 offset:31744
    v_fmac_f32 v64, v152, v26
    v_mfma_f32_16x16x32_bf16 v[132:135], a[32:35], a[44:47], v[132:135]
    v_fmac_f32 v65, v153, v26
    s_waitcnt lgkmcnt(11)
    v_mfma_f32_16x16x32_bf16 v[80:83], a[0:3], a[40:43], v[80:83]
    ds_read_b128 a[32:35], v3 offset:24576
    v_fmac_f32 v66, v154, v26
    v_mfma_f32_16x16x32_bf16 v[136:139], a[0:3], a[44:47], v[136:139]
    v_fmac_f32 v67, v155, v26
    s_waitcnt lgkmcnt(10)
    v_mfma_f32_16x16x32_bf16 v[84:87], a[4:7], a[40:43], v[84:87]
    ds_read_b128 a[0:3], v3 offset:25600
    v_fmac_f32 v120, v152, v28
    v_mfma_f32_16x16x32_bf16 v[140:143], a[4:7], a[44:47], v[140:143]
    v_fmac_f32 v121, v153, v28
    s_waitcnt lgkmcnt(10)
    v_mfma_f32_16x16x32_bf16 v[88:91], a[8:11], a[40:43], v[88:91]
    ds_read_b128 a[4:7], v3 offset:26624
    v_fmac_f32 v122, v154, v28
    v_mfma_f32_16x16x32_bf16 v[144:147], a[8:11], a[44:47], v[144:147]
    v_fmac_f32 v123, v155, v28
    s_waitcnt lgkmcnt(10)
    v_mfma_f32_16x16x32_bf16 v[92:95], a[12:15], a[40:43], v[92:95]
    ds_read_b128 a[8:11], v3 offset:27648
    v_fmac_f32 v80, v156, v26
    v_mfma_f32_16x16x32_bf16 v[148:151], a[12:15], a[44:47], v[148:151]
    v_fmac_f32 v81, v157, v26
    s_waitcnt lgkmcnt(6)
    v_mfma_f32_16x16x32_bf16 v[40:43], a[16:19], a[48:51], v[40:43]
    ds_read_b128 a[12:15], v3 offset:28672
    v_fmac_f32 v82, v158, v26
    v_mfma_f32_16x16x32_bf16 v[96:99], a[16:19], a[52:55], v[96:99]
    v_fmac_f32 v83, v159, v26
    s_waitcnt lgkmcnt(8)
    v_mfma_f32_16x16x32_bf16 v[44:47], a[20:23], a[48:51], v[44:47]
    ds_read_b128 a[16:19], v3 offset:29696
    v_fmac_f32 v136, v156, v28
    v_mfma_f32_16x16x32_bf16 v[100:103], a[20:23], a[52:55], v[100:103]
    v_fmac_f32 v137, v157, v28
    s_waitcnt lgkmcnt(7)
    v_mfma_f32_16x16x32_bf16 v[48:51], a[24:27], a[48:51], v[48:51]
    ds_read_b128 a[20:23], v3 offset:30720
    v_fmac_f32 v138, v158, v28
    v_mfma_f32_16x16x32_bf16 v[104:107], a[24:27], a[52:55], v[104:107]
    v_fmac_f32 v139, v159, v28
    s_waitcnt lgkmcnt(7)
    v_mfma_f32_16x16x32_bf16 v[52:55], a[28:31], a[48:51], v[52:55]
    ds_read_b128 a[24:27], v3 offset:31744
    v_fmac_f32 v84, v32, v26
    v_mfma_f32_16x16x32_bf16 v[108:111], a[28:31], a[52:55], v[108:111]
    v_fmac_f32 v85, v33, v26
    s_waitcnt lgkmcnt(7)
    v_mfma_f32_16x16x32_bf16 v[56:59], a[32:35], a[48:51], v[56:59]
    ds_read_b128 a[28:31], v3 offset:32768
    v_fmac_f32 v86, v34, v26
    v_fmac_f32 v87, v35, v26
    v_mfma_f32_16x16x32_bf16 v[112:115], a[32:35], a[52:55], v[112:115]
    ds_read_b128 v[152:155], v13 offset:768
    s_waitcnt lgkmcnt(8)
    v_mfma_f32_16x16x32_bf16 v[60:63], a[0:3], a[48:51], v[60:63]
    ds_read_b128 a[32:35], v3 offset:33792
    v_fmac_f32 v140, v32, v28
    v_mfma_f32_16x16x32_bf16 v[116:119], a[0:3], a[52:55], v[116:119]
    v_fmac_f32 v141, v33, v28
    s_waitcnt lgkmcnt(8)
    v_mfma_f32_16x16x32_bf16 v[64:67], a[4:7], a[48:51], v[64:67]
    s_barrier
    ds_read_b128 a[0:3], v3 offset:34816
    v_fmac_f32 v142, v34, v28
    v_mfma_f32_16x16x32_bf16 v[120:123], a[4:7], a[52:55], v[120:123]
    ds_read_b128 a[56:59], v36 offset:36864
    v_fmac_f32 v143, v35, v28
    s_waitcnt lgkmcnt(9)
    v_mfma_f32_16x16x32_bf16 v[68:71], a[8:11], a[48:51], v[68:71]
    ds_read_b128 a[4:7], v3 offset:35840
    v_mfma_f32_16x16x32_bf16 v[124:127], a[8:11], a[52:55], v[124:127]
    ds_read_b128 a[60:63], v36 offset:40960
    s_waitcnt lgkmcnt(10)
    v_mfma_f32_16x16x32_bf16 v[72:75], a[12:15], a[48:51], v[72:75]
    ds_read_b128 a[8:11], v3 offset:45056
    ds_read_b128 v[156:159], v13 offset:832
    v_mfma_f32_16x16x32_bf16 v[128:131], a[12:15], a[52:55], v[128:131]
    s_waitcnt lgkmcnt(11)
    v_mfma_f32_16x16x32_bf16 v[76:79], a[16:19], a[48:51], v[76:79]
    ds_read_b128 a[12:15], v3 offset:46080
    v_mfma_f32_16x16x32_bf16 v[132:135], a[16:19], a[52:55], v[132:135]
    s_waitcnt lgkmcnt(11)
    v_mfma_f32_16x16x32_bf16 v[80:83], a[20:23], a[48:51], v[80:83]
    ds_read_b128 a[16:19], v3 offset:47104
    v_mfma_f32_16x16x32_bf16 v[136:139], a[20:23], a[52:55], v[136:139]
    s_waitcnt lgkmcnt(11)
    v_mfma_f32_16x16x32_bf16 v[84:87], a[24:27], a[48:51], v[84:87]
    ds_read_b128 a[20:23], v3 offset:48128
    v_mfma_f32_16x16x32_bf16 v[140:143], a[24:27], a[52:55], v[140:143]
    s_waitcnt lgkmcnt(11)
    v_mfma_f32_16x16x32_bf16 v[88:91], a[28:31], a[48:51], v[88:91]
    ds_read_b128 a[24:27], v4 offset:32768
    v_mfma_f32_16x16x32_bf16 v[144:147], a[28:31], a[52:55], v[144:147]
    s_waitcnt lgkmcnt(10)
    v_mfma_f32_16x16x32_bf16 v[92:95], a[32:35], a[48:51], v[92:95]
    ds_read_b128 a[28:31], v4 offset:33792
    v_mfma_f32_16x16x32_bf16 v[148:151], a[32:35], a[52:55], v[148:151]
    s_waitcnt lgkmcnt(7)
    v_mfma_f32_16x16x32_bf16 v[40:43], a[0:3], a[56:59], v[40:43]
    ds_read_b128 a[32:35], v4 offset:34816
    v_mfma_f32_16x16x32_bf16 v[96:99], a[0:3], a[60:63], v[96:99]
    s_waitcnt lgkmcnt(9)
    v_mfma_f32_16x16x32_bf16 v[44:47], a[4:7], a[56:59], v[44:47]
    ds_read_b128 a[0:3], v4 offset:35840
    v_fmac_f32 v88, v152, v26
    v_mfma_f32_16x16x32_bf16 v[100:103], a[4:7], a[60:63], v[100:103]
    v_fmac_f32 v89, v153, v26
    s_waitcnt lgkmcnt(8)
    v_mfma_f32_16x16x32_bf16 v[48:51], a[8:11], a[56:59], v[48:51]
    ds_read_b128 a[4:7], v4 offset:36864
    v_fmac_f32 v90, v154, v26
    v_mfma_f32_16x16x32_bf16 v[104:107], a[8:11], a[60:63], v[104:107]
    v_fmac_f32 v91, v155, v26
    s_waitcnt lgkmcnt(7)
    v_mfma_f32_16x16x32_bf16 v[52:55], a[12:15], a[56:59], v[52:55]
    ds_read_b128 a[8:11], v4 offset:37888
    v_fmac_f32 v144, v152, v28
    v_mfma_f32_16x16x32_bf16 v[108:111], a[12:15], a[60:63], v[108:111]
    v_fmac_f32 v145, v153, v28
    s_waitcnt lgkmcnt(7)
    v_mfma_f32_16x16x32_bf16 v[56:59], a[16:19], a[56:59], v[56:59]
    ds_read_b128 a[12:15], v4 offset:38912
    v_fmac_f32 v146, v154, v28
    v_mfma_f32_16x16x32_bf16 v[112:115], a[16:19], a[60:63], v[112:115]
    v_fmac_f32 v147, v155, v28
    s_waitcnt lgkmcnt(7)
    v_mfma_f32_16x16x32_bf16 v[60:63], a[20:23], a[56:59], v[60:63]
    ds_read_b128 a[16:19], v4 offset:39936
    v_fmac_f32 v92, v156, v26
    v_mfma_f32_16x16x32_bf16 v[116:119], a[20:23], a[60:63], v[116:119]
    v_fmac_f32 v93, v157, v26
    s_waitcnt lgkmcnt(7)
    v_mfma_f32_16x16x32_bf16 v[64:67], a[24:27], a[56:59], v[64:67]
    s_barrier
    ds_read_b128 a[20:23], v4 offset:49152
    v_fmac_f32 v94, v158, v26
    v_mfma_f32_16x16x32_bf16 v[120:123], a[24:27], a[60:63], v[120:123]
    ds_read_b128 a[64:67], v37 offset:40960
    v_fmac_f32 v95, v159, v26
    s_waitcnt lgkmcnt(8)
    v_mfma_f32_16x16x32_bf16 v[68:71], a[28:31], a[56:59], v[68:71]
    ds_read_b128 a[24:27], v4 offset:50176
    v_fmac_f32 v148, v156, v28
    v_mfma_f32_16x16x32_bf16 v[124:127], a[28:31], a[60:63], v[124:127]
    ds_read_b128 a[68:71], v37 offset:45056
    v_fmac_f32 v149, v157, v28
    s_waitcnt lgkmcnt(9)
    v_mfma_f32_16x16x32_bf16 v[72:75], a[32:35], a[56:59], v[72:75]
    ds_read_b128 a[28:31], v4 offset:51200
    v_fmac_f32 v150, v158, v28
    v_mfma_f32_16x16x32_bf16 v[128:131], a[32:35], a[60:63], v[128:131]
    v_fmac_f32 v151, v159, v28
    s_waitcnt lgkmcnt(9)
    v_mfma_f32_16x16x32_bf16 v[76:79], a[0:3], a[56:59], v[76:79]
    ds_read_b128 a[32:35], v4 offset:52224
    v_mfma_f32_16x16x32_bf16 v[132:135], a[0:3], a[60:63], v[132:135]
    s_waitcnt lgkmcnt(9)
    v_mfma_f32_16x16x32_bf16 v[80:83], a[4:7], a[56:59], v[80:83]
    ds_read_b128 a[0:3], v4 offset:53248
    v_mfma_f32_16x16x32_bf16 v[136:139], a[4:7], a[60:63], v[136:139]
    s_waitcnt lgkmcnt(9)
    v_mfma_f32_16x16x32_bf16 v[84:87], a[8:11], a[56:59], v[84:87]
    ds_read_b128 a[4:7], v4 offset:54272
    v_mfma_f32_16x16x32_bf16 v[140:143], a[8:11], a[60:63], v[140:143]
    s_waitcnt lgkmcnt(9)
    v_mfma_f32_16x16x32_bf16 v[88:91], a[12:15], a[56:59], v[88:91]
    ds_read_b128 a[8:11], v4 offset:55296
    v_mfma_f32_16x16x32_bf16 v[144:147], a[12:15], a[60:63], v[144:147]
    s_waitcnt lgkmcnt(9)
    v_mfma_f32_16x16x32_bf16 v[92:95], a[16:19], a[56:59], v[92:95]
    ds_read_b128 a[12:15], v4 offset:56320
    v_mfma_f32_16x16x32_bf16 v[148:151], a[16:19], a[60:63], v[148:151]
    s_waitcnt lgkmcnt(6)
    v_mfma_f32_16x16x32_bf16 v[40:43], a[20:23], a[64:67], v[40:43]
    ds_read_b128 a[16:19], v3 offset:49152
    v_mfma_f32_16x16x32_bf16 v[96:99], a[20:23], a[68:71], v[96:99]
    s_waitcnt lgkmcnt(8)
    v_mfma_f32_16x16x32_bf16 v[44:47], a[24:27], a[64:67], v[44:47]
    ds_read_b128 a[20:23], v3 offset:50176
    v_mfma_f32_16x16x32_bf16 v[100:103], a[24:27], a[68:71], v[100:103]
    s_waitcnt lgkmcnt(7)
    v_mfma_f32_16x16x32_bf16 v[48:51], a[28:31], a[64:67], v[48:51]
    ds_read_b128 a[24:27], v3 offset:51200
    v_mfma_f32_16x16x32_bf16 v[104:107], a[28:31], a[68:71], v[104:107]
    s_waitcnt lgkmcnt(7)
    v_mfma_f32_16x16x32_bf16 v[52:55], a[32:35], a[64:67], v[52:55]
    ds_read_b128 a[28:31], v3 offset:52224
    v_mfma_f32_16x16x32_bf16 v[108:111], a[32:35], a[68:71], v[108:111]
    s_waitcnt lgkmcnt(7)
    v_mfma_f32_16x16x32_bf16 v[56:59], a[0:3], a[64:67], v[56:59]
    ds_read_b128 a[32:35], v3 offset:53248
    v_mfma_f32_16x16x32_bf16 v[112:115], a[0:3], a[68:71], v[112:115]
    s_waitcnt lgkmcnt(7)
    v_mfma_f32_16x16x32_bf16 v[60:63], a[4:7], a[64:67], v[60:63]
    ds_read_b128 a[0:3], v3 offset:54272
    v_mfma_f32_16x16x32_bf16 v[116:119], a[4:7], a[68:71], v[116:119]
    s_waitcnt lgkmcnt(7)
    v_mfma_f32_16x16x32_bf16 v[64:67], a[8:11], a[64:67], v[64:67]
    s_barrier
    ds_read_b128 a[4:7], v3 offset:55296
    v_mfma_f32_16x16x32_bf16 v[120:123], a[8:11], a[68:71], v[120:123]
    ds_read_b128 a[72:75], v36 offset:57344
    s_waitcnt lgkmcnt(8)
    v_mfma_f32_16x16x32_bf16 v[68:71], a[12:15], a[64:67], v[68:71]
    ds_read_b128 a[8:11], v3 offset:56320
    v_mfma_f32_16x16x32_bf16 v[124:127], a[12:15], a[68:71], v[124:127]
    ds_read_b128 a[76:79], v36 offset:61440
    s_waitcnt lgkmcnt(9)
    v_mfma_f32_16x16x32_bf16 v[72:75], a[16:19], a[64:67], v[72:75]
    ds_read_b128 a[12:15], v4 offset:0
    v_mfma_f32_16x16x32_bf16 v[128:131], a[16:19], a[68:71], v[128:131]
    s_waitcnt lgkmcnt(9)
    v_mfma_f32_16x16x32_bf16 v[76:79], a[20:23], a[64:67], v[76:79]
    ds_read_b128 a[16:19], v4 offset:1024
    v_mfma_f32_16x16x32_bf16 v[132:135], a[20:23], a[68:71], v[132:135]
    s_waitcnt lgkmcnt(9)
    v_mfma_f32_16x16x32_bf16 v[80:83], a[24:27], a[64:67], v[80:83]
    ds_read_b128 a[20:23], v4 offset:2048
    v_mfma_f32_16x16x32_bf16 v[136:139], a[24:27], a[68:71], v[136:139]
    s_waitcnt lgkmcnt(9)
    v_mfma_f32_16x16x32_bf16 v[84:87], a[28:31], a[64:67], v[84:87]
    ds_read_b128 a[24:27], v4 offset:3072
    v_mfma_f32_16x16x32_bf16 v[140:143], a[28:31], a[68:71], v[140:143]
    s_waitcnt lgkmcnt(9)
    v_mfma_f32_16x16x32_bf16 v[88:91], a[32:35], a[64:67], v[88:91]
    ds_read_b128 a[28:31], v4 offset:4096
    v_mfma_f32_16x16x32_bf16 v[144:147], a[32:35], a[68:71], v[144:147]
    s_waitcnt lgkmcnt(9)
    v_mfma_f32_16x16x32_bf16 v[92:95], a[0:3], a[64:67], v[92:95]
    ds_read_b128 a[32:35], v4 offset:5120
    v_mfma_f32_16x16x32_bf16 v[148:151], a[0:3], a[68:71], v[148:151]
    s_waitcnt lgkmcnt(6)
    v_mfma_f32_16x16x32_bf16 v[40:43], a[4:7], a[72:75], v[40:43]
    ds_read_b128 a[0:3], v4 offset:6144
    v_mfma_f32_16x16x32_bf16 v[96:99], a[4:7], a[76:79], v[96:99]
    s_waitcnt lgkmcnt(8)
    v_mfma_f32_16x16x32_bf16 v[44:47], a[8:11], a[72:75], v[44:47]
    ds_read_b128 a[4:7], v4 offset:7168
    v_mfma_f32_16x16x32_bf16 v[100:103], a[8:11], a[76:79], v[100:103]
    s_waitcnt lgkmcnt(7)
    v_mfma_f32_16x16x32_bf16 v[48:51], a[12:15], a[72:75], v[48:51]
    ds_read_b128 a[8:11], v4 offset:57344
    v_mfma_f32_16x16x32_bf16 v[104:107], a[12:15], a[76:79], v[104:107]
    s_waitcnt lgkmcnt(7)
    v_mfma_f32_16x16x32_bf16 v[52:55], a[16:19], a[72:75], v[52:55]
    ds_read_b128 a[12:15], v4 offset:58368
    v_mfma_f32_16x16x32_bf16 v[108:111], a[16:19], a[76:79], v[108:111]
    s_waitcnt lgkmcnt(7)
    v_mfma_f32_16x16x32_bf16 v[56:59], a[20:23], a[72:75], v[56:59]
    ds_read_b128 a[16:19], v4 offset:59392
    v_mfma_f32_16x16x32_bf16 v[112:115], a[20:23], a[76:79], v[112:115]
    s_waitcnt lgkmcnt(7)
    v_mfma_f32_16x16x32_bf16 v[60:63], a[24:27], a[72:75], v[60:63]
    ds_read_b128 a[20:23], v4 offset:60416
    v_mfma_f32_16x16x32_bf16 v[116:119], a[24:27], a[76:79], v[116:119]
    s_waitcnt lgkmcnt(7)
    v_mfma_f32_16x16x32_bf16 v[64:67], a[28:31], a[72:75], v[64:67]
    s_barrier
    ds_read_b128 a[24:27], v5 offset:4096
    v_mfma_f32_16x16x32_bf16 v[120:123], a[28:31], a[76:79], v[120:123]
    ds_read_b128 a[80:83], v37 offset:61440
    s_waitcnt lgkmcnt(8)
    v_mfma_f32_16x16x32_bf16 v[68:71], a[32:35], a[72:75], v[68:71]
    ds_read_b128 a[28:31], v5 offset:5120
    v_mfma_f32_16x16x32_bf16 v[124:127], a[32:35], a[76:79], v[124:127]
    ds_read_b128 a[84:87], v38 offset:0
    s_waitcnt lgkmcnt(9)
    v_mfma_f32_16x16x32_bf16 v[72:75], a[0:3], a[72:75], v[72:75]
    ds_read_b128 a[32:35], v5 offset:6144
    v_mfma_f32_16x16x32_bf16 v[128:131], a[0:3], a[76:79], v[128:131]
    s_waitcnt lgkmcnt(9)
    v_mfma_f32_16x16x32_bf16 v[76:79], a[4:7], a[72:75], v[76:79]
    ds_read_b128 a[0:3], v5 offset:7168
    v_mfma_f32_16x16x32_bf16 v[132:135], a[4:7], a[76:79], v[132:135]
    s_waitcnt lgkmcnt(9)
    v_mfma_f32_16x16x32_bf16 v[80:83], a[8:11], a[72:75], v[80:83]
    ds_read_b128 a[4:7], v5 offset:8192
    v_mfma_f32_16x16x32_bf16 v[136:139], a[8:11], a[76:79], v[136:139]
    s_waitcnt lgkmcnt(9)
    v_mfma_f32_16x16x32_bf16 v[84:87], a[12:15], a[72:75], v[84:87]
    ds_read_b128 a[8:11], v5 offset:9216
    v_mfma_f32_16x16x32_bf16 v[140:143], a[12:15], a[76:79], v[140:143]
    s_waitcnt lgkmcnt(9)
    v_mfma_f32_16x16x32_bf16 v[88:91], a[16:19], a[72:75], v[88:91]
    ds_read_b128 a[12:15], v5 offset:10240
    v_mfma_f32_16x16x32_bf16 v[144:147], a[16:19], a[76:79], v[144:147]
    s_waitcnt lgkmcnt(9)
    v_mfma_f32_16x16x32_bf16 v[92:95], a[20:23], a[72:75], v[92:95]
    ds_read_b128 a[16:19], v5 offset:11264
    v_mfma_f32_16x16x32_bf16 v[148:151], a[20:23], a[76:79], v[148:151]
    s_waitcnt lgkmcnt(6)
    v_mfma_f32_16x16x32_bf16 v[40:43], a[24:27], a[80:83], v[40:43]
    ds_read_b128 a[20:23], v5 offset:12288
    v_mfma_f32_16x16x32_bf16 v[96:99], a[24:27], a[84:87], v[96:99]
    s_waitcnt lgkmcnt(8)
    v_mfma_f32_16x16x32_bf16 v[44:47], a[28:31], a[80:83], v[44:47]
    ds_read_b128 a[24:27], v5 offset:13312
    v_mfma_f32_16x16x32_bf16 v[100:103], a[28:31], a[84:87], v[100:103]
    s_waitcnt lgkmcnt(7)
    v_mfma_f32_16x16x32_bf16 v[48:51], a[32:35], a[80:83], v[48:51]
    ds_read_b128 a[28:31], v5 offset:14336
    v_mfma_f32_16x16x32_bf16 v[104:107], a[32:35], a[84:87], v[104:107]
    s_waitcnt lgkmcnt(7)
    v_mfma_f32_16x16x32_bf16 v[52:55], a[0:3], a[80:83], v[52:55]
    ds_read_b128 a[32:35], v5 offset:15360
    v_mfma_f32_16x16x32_bf16 v[108:111], a[0:3], a[84:87], v[108:111]
    s_waitcnt lgkmcnt(7)
    v_mfma_f32_16x16x32_bf16 v[56:59], a[4:7], a[80:83], v[56:59]
    ds_read_b128 a[0:3], v3 offset:0
    v_mfma_f32_16x16x32_bf16 v[112:115], a[4:7], a[84:87], v[112:115]
    s_waitcnt lgkmcnt(7)
    v_mfma_f32_16x16x32_bf16 v[60:63], a[8:11], a[80:83], v[60:63]
    ds_read_b128 a[4:7], v3 offset:1024
    v_mfma_f32_16x16x32_bf16 v[116:119], a[8:11], a[84:87], v[116:119]
    s_waitcnt lgkmcnt(7)
    v_mfma_f32_16x16x32_bf16 v[64:67], a[12:15], a[80:83], v[64:67]
    s_barrier
    ds_read_b128 a[8:11], v3 offset:2048
    v_mfma_f32_16x16x32_bf16 v[120:123], a[12:15], a[84:87], v[120:123]
    ds_read_b128 a[88:91], v36 offset:4096
    s_waitcnt lgkmcnt(8)
    v_mfma_f32_16x16x32_bf16 v[68:71], a[16:19], a[80:83], v[68:71]
    ds_read_b128 a[12:15], v3 offset:3072
    v_mfma_f32_16x16x32_bf16 v[124:127], a[16:19], a[84:87], v[124:127]
    ds_read_b128 a[92:95], v36 offset:8192
    s_waitcnt lgkmcnt(9)
    v_mfma_f32_16x16x32_bf16 v[72:75], a[20:23], a[80:83], v[72:75]
    ds_read_b128 a[16:19], v3 offset:12288
    v_mfma_f32_16x16x32_bf16 v[128:131], a[20:23], a[84:87], v[128:131]
    s_waitcnt lgkmcnt(9)
    v_mfma_f32_16x16x32_bf16 v[76:79], a[24:27], a[80:83], v[76:79]
    ds_read_b128 a[20:23], v3 offset:13312
    v_mfma_f32_16x16x32_bf16 v[132:135], a[24:27], a[84:87], v[132:135]
    s_waitcnt lgkmcnt(9)
    v_mfma_f32_16x16x32_bf16 v[80:83], a[28:31], a[80:83], v[80:83]
    ds_read_b128 a[24:27], v3 offset:14336
    v_mfma_f32_16x16x32_bf16 v[136:139], a[28:31], a[84:87], v[136:139]
    s_waitcnt lgkmcnt(9)
    v_mfma_f32_16x16x32_bf16 v[84:87], a[32:35], a[80:83], v[84:87]
    ds_read_b128 a[28:31], v3 offset:15360
    v_mfma_f32_16x16x32_bf16 v[140:143], a[32:35], a[84:87], v[140:143]
    s_waitcnt lgkmcnt(9)
    v_mfma_f32_16x16x32_bf16 v[88:91], a[0:3], a[80:83], v[88:91]
    ds_read_b128 a[32:35], v3 offset:16384
    v_mfma_f32_16x16x32_bf16 v[144:147], a[0:3], a[84:87], v[144:147]
    s_waitcnt lgkmcnt(9)
    v_mfma_f32_16x16x32_bf16 v[92:95], a[4:7], a[80:83], v[92:95]
    ds_read_b128 a[0:3], v3 offset:17408
    v_mfma_f32_16x16x32_bf16 v[148:151], a[4:7], a[84:87], v[148:151]
    s_waitcnt lgkmcnt(6)
    v_mfma_f32_16x16x32_bf16 v[40:43], a[8:11], a[88:91], v[40:43]
    ds_read_b128 a[4:7], v3 offset:18432
    v_mfma_f32_16x16x32_bf16 v[96:99], a[8:11], a[92:95], v[96:99]
    s_waitcnt lgkmcnt(8)
    v_mfma_f32_16x16x32_bf16 v[44:47], a[12:15], a[88:91], v[44:47]
    ds_read_b128 a[8:11], v3 offset:19456
    v_mfma_f32_16x16x32_bf16 v[100:103], a[12:15], a[92:95], v[100:103]
    s_waitcnt lgkmcnt(7)
    v_mfma_f32_16x16x32_bf16 v[48:51], a[16:19], a[88:91], v[48:51]
    ds_read_b128 a[12:15], v3 offset:20480
    v_mfma_f32_16x16x32_bf16 v[104:107], a[16:19], a[92:95], v[104:107]
    s_waitcnt lgkmcnt(7)
    v_mfma_f32_16x16x32_bf16 v[52:55], a[20:23], a[88:91], v[52:55]
    ds_read_b128 a[16:19], v3 offset:21504
    v_mfma_f32_16x16x32_bf16 v[108:111], a[20:23], a[92:95], v[108:111]
    s_waitcnt lgkmcnt(7)
    v_mfma_f32_16x16x32_bf16 v[56:59], a[24:27], a[88:91], v[56:59]
    ds_read_b128 a[20:23], v3 offset:22528
    v_mfma_f32_16x16x32_bf16 v[112:115], a[24:27], a[92:95], v[112:115]
    s_waitcnt lgkmcnt(7)
    v_mfma_f32_16x16x32_bf16 v[60:63], a[28:31], a[88:91], v[60:63]
    ds_read_b128 a[24:27], v3 offset:23552
    v_mfma_f32_16x16x32_bf16 v[116:119], a[28:31], a[92:95], v[116:119]
    s_waitcnt lgkmcnt(7)
    v_mfma_f32_16x16x32_bf16 v[64:67], a[32:35], a[88:91], v[64:67]
    s_barrier
    ds_read_b128 a[28:31], v4 offset:16384
    v_mfma_f32_16x16x32_bf16 v[120:123], a[32:35], a[92:95], v[120:123]
    ds_read_b128 a[40:43], v37 offset:8192
    s_waitcnt lgkmcnt(8)
    v_mfma_f32_16x16x32_bf16 v[68:71], a[0:3], a[88:91], v[68:71]
    ds_read_b128 a[32:35], v4 offset:17408
    v_mfma_f32_16x16x32_bf16 v[124:127], a[0:3], a[92:95], v[124:127]
    ds_read_b128 a[44:47], v37 offset:12288
    s_waitcnt lgkmcnt(9)
    v_mfma_f32_16x16x32_bf16 v[72:75], a[4:7], a[88:91], v[72:75]
    ds_read_b128 a[0:3], v4 offset:18432
    v_mfma_f32_16x16x32_bf16 v[128:131], a[4:7], a[92:95], v[128:131]
    s_waitcnt lgkmcnt(9)
    v_mfma_f32_16x16x32_bf16 v[76:79], a[8:11], a[88:91], v[76:79]
    ds_read_b128 a[4:7], v4 offset:19456
    v_mfma_f32_16x16x32_bf16 v[132:135], a[8:11], a[92:95], v[132:135]
    s_waitcnt lgkmcnt(9)
    v_mfma_f32_16x16x32_bf16 v[80:83], a[12:15], a[88:91], v[80:83]
    ds_read_b128 a[8:11], v4 offset:28672
    v_mfma_f32_16x16x32_bf16 v[136:139], a[12:15], a[92:95], v[136:139]
    ds_read_b128 a[48:51], v37 offset:20480
    s_waitcnt lgkmcnt(10)
    v_mfma_f32_16x16x32_bf16 v[84:87], a[16:19], a[88:91], v[84:87]
    ds_read_b128 a[12:15], v4 offset:29696
    v_mfma_f32_16x16x32_bf16 v[140:143], a[16:19], a[92:95], v[140:143]
    ds_read_b128 a[52:55], v37 offset:24576
    s_waitcnt lgkmcnt(11)
    v_mfma_f32_16x16x32_bf16 v[88:91], a[20:23], a[88:91], v[88:91]
    ds_read_b128 a[16:19], v4 offset:30720
    v_mfma_f32_16x16x32_bf16 v[144:147], a[20:23], a[92:95], v[144:147]
    s_waitcnt lgkmcnt(11)
    v_mfma_f32_16x16x32_bf16 v[92:95], a[24:27], a[88:91], v[92:95]
    ds_read_b128 a[20:23], v4 offset:31744
    v_mfma_f32_16x16x32_bf16 v[148:151], a[24:27], a[92:95], v[148:151]
    s_waitcnt lgkmcnt(8)
    v_mfma_f32_16x16x32_bf16 v[40:43], a[28:31], a[40:43], v[40:43]
    ds_read_b128 a[24:27], v3 offset:32768
    v_mfma_f32_16x16x32_bf16 v[96:99], a[28:31], a[44:47], v[96:99]
    ds_read_b128 a[56:59], v36 offset:24576
    s_waitcnt lgkmcnt(11)
    v_mfma_f32_16x16x32_bf16 v[44:47], a[32:35], a[40:43], v[44:47]
    ds_read_b128 a[28:31], v3 offset:33792
    v_mfma_f32_16x16x32_bf16 v[100:103], a[32:35], a[44:47], v[100:103]
    ds_read_b128 a[60:63], v36 offset:28672
    s_waitcnt lgkmcnt(11)
    v_mfma_f32_16x16x32_bf16 v[68:71], a[0:3], a[40:43], v[68:71]
    ds_read_b128 a[32:35], v3 offset:34816
    v_mfma_f32_16x16x32_bf16 v[124:127], a[0:3], a[44:47], v[124:127]
    s_waitcnt lgkmcnt(11)
    v_mfma_f32_16x16x32_bf16 v[72:75], a[4:7], a[40:43], v[72:75]
    ds_read_b128 a[0:3], v3 offset:35840
    v_mfma_f32_16x16x32_bf16 v[128:131], a[4:7], a[44:47], v[128:131]
    s_waitcnt lgkmcnt(8)
    v_mfma_f32_16x16x32_bf16 v[40:43], a[8:11], a[48:51], v[40:43]
    ds_read_b128 a[4:7], v3 offset:45056
    v_mfma_f32_16x16x32_bf16 v[96:99], a[8:11], a[52:55], v[96:99]
    ds_read_b128 a[64:67], v36 offset:36864
    s_waitcnt lgkmcnt(11)
    v_mfma_f32_16x16x32_bf16 v[44:47], a[12:15], a[48:51], v[44:47]
    ds_read_b128 a[8:11], v3 offset:46080
    v_mfma_f32_16x16x32_bf16 v[100:103], a[12:15], a[52:55], v[100:103]
    ds_read_b128 a[68:71], v36 offset:40960
    s_waitcnt lgkmcnt(11)
    v_mfma_f32_16x16x32_bf16 v[68:71], a[16:19], a[48:51], v[68:71]
    s_barrier
    ds_read_b128 a[12:15], v3 offset:47104
    v_mfma_f32_16x16x32_bf16 v[124:127], a[16:19], a[52:55], v[124:127]
    s_waitcnt lgkmcnt(11)
    v_mfma_f32_16x16x32_bf16 v[72:75], a[20:23], a[48:51], v[72:75]
    ds_read_b128 a[16:19], v3 offset:48128
    v_mfma_f32_16x16x32_bf16 v[128:131], a[20:23], a[52:55], v[128:131]
    s_waitcnt lgkmcnt(8)
    v_mfma_f32_16x16x32_bf16 v[40:43], a[24:27], a[56:59], v[40:43]
    ds_read_b128 a[20:23], v4 offset:40960
    v_mfma_f32_16x16x32_bf16 v[96:99], a[24:27], a[60:63], v[96:99]
    ds_read_b128 a[72:75], v37 offset:32768
    s_waitcnt lgkmcnt(11)
    v_mfma_f32_16x16x32_bf16 v[44:47], a[28:31], a[56:59], v[44:47]
    ds_read_b128 a[24:27], v4 offset:41984
    v_mfma_f32_16x16x32_bf16 v[100:103], a[28:31], a[60:63], v[100:103]
    ds_read_b128 a[76:79], v37 offset:36864
    s_waitcnt lgkmcnt(11)
    v_mfma_f32_16x16x32_bf16 v[68:71], a[32:35], a[56:59], v[68:71]
    ds_read_b128 a[28:31], v4 offset:43008
    v_mfma_f32_16x16x32_bf16 v[124:127], a[32:35], a[60:63], v[124:127]
    s_waitcnt lgkmcnt(11)
    v_mfma_f32_16x16x32_bf16 v[72:75], a[0:3], a[56:59], v[72:75]
    ds_read_b128 a[32:35], v4 offset:44032
    v_mfma_f32_16x16x32_bf16 v[128:131], a[0:3], a[60:63], v[128:131]
    s_waitcnt lgkmcnt(8)
    v_mfma_f32_16x16x32_bf16 v[40:43], a[4:7], a[64:67], v[40:43]
    ds_read_b128 a[0:3], v4 offset:53248
    v_mfma_f32_16x16x32_bf16 v[96:99], a[4:7], a[68:71], v[96:99]
    ds_read_b128 a[80:83], v37 offset:45056
    s_waitcnt lgkmcnt(11)
    v_mfma_f32_16x16x32_bf16 v[44:47], a[8:11], a[64:67], v[44:47]
    ds_read_b128 a[4:7], v4 offset:54272
    v_mfma_f32_16x16x32_bf16 v[100:103], a[8:11], a[68:71], v[100:103]
    ds_read_b128 a[84:87], v37 offset:49152
    s_waitcnt lgkmcnt(11)
    v_mfma_f32_16x16x32_bf16 v[68:71], a[12:15], a[64:67], v[68:71]
    ds_read_b128 a[8:11], v4 offset:55296
    v_mfma_f32_16x16x32_bf16 v[124:127], a[12:15], a[68:71], v[124:127]
    s_waitcnt lgkmcnt(11)
    v_mfma_f32_16x16x32_bf16 v[72:75], a[16:19], a[64:67], v[72:75]
    ds_read_b128 a[12:15], v4 offset:56320
    v_mfma_f32_16x16x32_bf16 v[128:131], a[16:19], a[68:71], v[128:131]
    s_waitcnt lgkmcnt(8)
    v_mfma_f32_16x16x32_bf16 v[40:43], a[20:23], a[72:75], v[40:43]
    ds_read_b128 a[16:19], v3 offset:49152
    v_mfma_f32_16x16x32_bf16 v[96:99], a[20:23], a[76:79], v[96:99]
    s_waitcnt lgkmcnt(10)
    v_mfma_f32_16x16x32_bf16 v[44:47], a[24:27], a[72:75], v[44:47]
    ds_read_b128 a[20:23], v3 offset:50176
    v_mfma_f32_16x16x32_bf16 v[100:103], a[24:27], a[76:79], v[100:103]
    s_waitcnt lgkmcnt(9)
    v_mfma_f32_16x16x32_bf16 v[68:71], a[28:31], a[72:75], v[68:71]
    ds_read_b128 a[24:27], v3 offset:51200
    v_mfma_f32_16x16x32_bf16 v[124:127], a[28:31], a[76:79], v[124:127]
    s_waitcnt lgkmcnt(9)
    v_mfma_f32_16x16x32_bf16 v[72:75], a[32:35], a[72:75], v[72:75]
    ds_read_b128 a[28:31], v3 offset:52224
    v_mfma_f32_16x16x32_bf16 v[128:131], a[32:35], a[76:79], v[128:131]
    s_waitcnt lgkmcnt(6)
    v_mfma_f32_16x16x32_bf16 v[40:43], a[0:3], a[80:83], v[40:43]
    s_barrier
    ds_read_b128 a[32:35], v3 offset:53248
    v_mfma_f32_16x16x32_bf16 v[96:99], a[0:3], a[84:87], v[96:99]
    s_waitcnt lgkmcnt(8)
    v_mfma_f32_16x16x32_bf16 v[44:47], a[4:7], a[80:83], v[44:47]
    ds_read_b128 a[0:3], v3 offset:54272
    v_mfma_f32_16x16x32_bf16 v[100:103], a[4:7], a[84:87], v[100:103]
    s_waitcnt lgkmcnt(7)
    v_mfma_f32_16x16x32_bf16 v[68:71], a[8:11], a[80:83], v[68:71]
    ds_read_b128 a[4:7], v3 offset:55296
    v_mfma_f32_16x16x32_bf16 v[124:127], a[8:11], a[84:87], v[124:127]
    s_waitcnt lgkmcnt(7)
    v_mfma_f32_16x16x32_bf16 v[72:75], a[12:15], a[80:83], v[72:75]
    ds_read_b128 a[8:11], v3 offset:56320
    v_mfma_f32_16x16x32_bf16 v[128:131], a[12:15], a[84:87], v[128:131]
    s_waitcnt lgkmcnt(7)
    v_mfma_f32_16x16x32_bf16 v[48:51], a[16:19], a[40:43], v[48:51]
    ds_read_b128 a[12:15], v3 offset:57344
    v_mfma_f32_16x16x32_bf16 v[104:107], a[16:19], a[44:47], v[104:107]
    s_waitcnt lgkmcnt(7)
    v_mfma_f32_16x16x32_bf16 v[52:55], a[20:23], a[40:43], v[52:55]
    ds_read_b128 a[16:19], v3 offset:58368
    v_mfma_f32_16x16x32_bf16 v[108:111], a[20:23], a[44:47], v[108:111]
    s_waitcnt lgkmcnt(7)
    v_mfma_f32_16x16x32_bf16 v[76:79], a[24:27], a[40:43], v[76:79]
    ds_read_b128 a[20:23], v3 offset:59392
    v_max_f32 v40, 0, v40
    v_max_f32 v41, 0, v41
    v_mfma_f32_16x16x32_bf16 v[132:135], a[24:27], a[44:47], v[132:135]
    v_max_f32 v42, 0, v42
    s_waitcnt lgkmcnt(7)
    v_mfma_f32_16x16x32_bf16 v[80:83], a[28:31], a[40:43], v[80:83]
    ds_read_b128 a[24:27], v3 offset:60416
    v_max_f32 v43, 0, v43
    v_mul_f32 v68, v68, v27
    v_mfma_f32_16x16x32_bf16 v[136:139], a[28:31], a[44:47], v[136:139]
    v_mul_f32 v69, v69, v27
    s_waitcnt lgkmcnt(7)
    v_mfma_f32_16x16x32_bf16 v[48:51], a[32:35], a[48:51], v[48:51]
    ds_read_b128 a[28:31], v3 offset:61440
    v_mul_f32 v70, v70, v27
    v_mul_f32 v71, v71, v27
    v_mfma_f32_16x16x32_bf16 v[104:107], a[32:35], a[52:55], v[104:107]
    v_mul_f32 v40, v40, v68
    s_waitcnt lgkmcnt(7)
    v_mfma_f32_16x16x32_bf16 v[52:55], a[0:3], a[48:51], v[52:55]
    ds_read_b128 a[32:35], v3 offset:62464
    v_mul_f32 v41, v41, v69
    v_mul_f32 v42, v42, v70
    v_mfma_f32_16x16x32_bf16 v[108:111], a[0:3], a[52:55], v[108:111]
    v_mul_f32 v43, v43, v71
    s_waitcnt lgkmcnt(7)
    v_mfma_f32_16x16x32_bf16 v[76:79], a[4:7], a[48:51], v[76:79]
    ds_read_b128 a[0:3], v3 offset:63488
    v_cvt_pk_bf16_f32 v40, v40, v41
    v_cvt_pk_bf16_f32 v41, v42, v43
    v_mfma_f32_16x16x32_bf16 v[132:135], a[4:7], a[52:55], v[132:135]
    v_max_f32 v44, 0, v44
    s_waitcnt lgkmcnt(7)
    v_mfma_f32_16x16x32_bf16 v[80:83], a[8:11], a[48:51], v[80:83]
    ds_read_b128 a[4:7], v3 offset:64512
    v_max_f32 v45, 0, v45
    v_max_f32 v46, 0, v46
    v_mfma_f32_16x16x32_bf16 v[136:139], a[8:11], a[52:55], v[136:139]
    v_max_f32 v47, 0, v47
    s_waitcnt lgkmcnt(7)
    v_mfma_f32_16x16x32_bf16 v[48:51], a[12:15], a[56:59], v[48:51]
    ds_read_b128 a[8:11], v4 offset:0
    v_mul_f32 v72, v72, v27
    v_mul_f32 v73, v73, v27
    v_mfma_f32_16x16x32_bf16 v[104:107], a[12:15], a[60:63], v[104:107]
    v_mul_f32 v74, v74, v27
    s_waitcnt lgkmcnt(7)
    v_mfma_f32_16x16x32_bf16 v[52:55], a[16:19], a[56:59], v[52:55]
    ds_read_b128 a[12:15], v4 offset:1024
    v_mul_f32 v75, v75, v27
    v_mul_f32 v44, v44, v72
    v_mfma_f32_16x16x32_bf16 v[108:111], a[16:19], a[60:63], v[108:111]
    v_mul_f32 v45, v45, v73
    s_waitcnt lgkmcnt(7)
    v_mfma_f32_16x16x32_bf16 v[76:79], a[20:23], a[56:59], v[76:79]
    s_barrier
    ds_read_b128 a[16:19], v4 offset:2048
    v_mul_f32 v46, v46, v74
    v_mul_f32 v47, v47, v75
    v_mfma_f32_16x16x32_bf16 v[132:135], a[20:23], a[60:63], v[132:135]
    v_cvt_pk_bf16_f32 v42, v44, v45
    s_waitcnt lgkmcnt(7)
    v_mfma_f32_16x16x32_bf16 v[80:83], a[24:27], a[56:59], v[80:83]
    ds_read_b128 a[20:23], v4 offset:3072
    v_cvt_pk_bf16_f32 v43, v46, v47
    buffer_store_dwordx4 v[40:43], v6, s[4:7], s26 offen offset:0 sc1
    v_mfma_f32_16x16x32_bf16 v[136:139], a[24:27], a[60:63], v[136:139]
    v_max_f32 v96, 0, v96
    s_waitcnt lgkmcnt(7)
    v_mfma_f32_16x16x32_bf16 v[48:51], a[28:31], a[64:67], v[48:51]
    ds_read_b128 a[24:27], v4 offset:4096
    v_max_f32 v97, 0, v97
    v_max_f32 v98, 0, v98
    v_mfma_f32_16x16x32_bf16 v[104:107], a[28:31], a[68:71], v[104:107]
    v_max_f32 v99, 0, v99
    s_waitcnt lgkmcnt(7)
    v_mfma_f32_16x16x32_bf16 v[52:55], a[32:35], a[64:67], v[52:55]
    ds_read_b128 a[28:31], v4 offset:5120
    v_mul_f32 v124, v124, v29
    v_mul_f32 v125, v125, v29
    v_mfma_f32_16x16x32_bf16 v[108:111], a[32:35], a[68:71], v[108:111]
    v_mul_f32 v126, v126, v29
    s_waitcnt lgkmcnt(7)
    v_mfma_f32_16x16x32_bf16 v[76:79], a[0:3], a[64:67], v[76:79]
    ds_read_b128 a[32:35], v4 offset:6144
    v_mul_f32 v127, v127, v29
    v_mul_f32 v96, v96, v124
    v_mfma_f32_16x16x32_bf16 v[132:135], a[0:3], a[68:71], v[132:135]
    v_mul_f32 v97, v97, v125
    s_waitcnt lgkmcnt(7)
    v_mfma_f32_16x16x32_bf16 v[80:83], a[4:7], a[64:67], v[80:83]
    ds_read_b128 a[0:3], v4 offset:7168
    v_mul_f32 v98, v98, v126
    v_mul_f32 v99, v99, v127
    v_mfma_f32_16x16x32_bf16 v[136:139], a[4:7], a[68:71], v[136:139]
    v_cvt_pk_bf16_f32 v96, v96, v97
    s_waitcnt lgkmcnt(7)
    v_mfma_f32_16x16x32_bf16 v[48:51], a[8:11], a[72:75], v[48:51]
    ds_read_b128 a[4:7], v4 offset:57344
    v_cvt_pk_bf16_f32 v97, v98, v99
    v_max_f32 v100, 0, v100
    v_mfma_f32_16x16x32_bf16 v[104:107], a[8:11], a[76:79], v[104:107]
    v_max_f32 v101, 0, v101
    s_waitcnt lgkmcnt(7)
    v_mfma_f32_16x16x32_bf16 v[52:55], a[12:15], a[72:75], v[52:55]
    ds_read_b128 a[8:11], v4 offset:58368
    v_max_f32 v102, 0, v102
    v_max_f32 v103, 0, v103
    v_mfma_f32_16x16x32_bf16 v[108:111], a[12:15], a[76:79], v[108:111]
    v_mul_f32 v128, v128, v29
    s_waitcnt lgkmcnt(7)
    v_mfma_f32_16x16x32_bf16 v[76:79], a[16:19], a[72:75], v[76:79]
    ds_read_b128 a[12:15], v4 offset:59392
    v_mul_f32 v129, v129, v29
    v_mul_f32 v130, v130, v29
    v_mfma_f32_16x16x32_bf16 v[132:135], a[16:19], a[76:79], v[132:135]
    v_mul_f32 v131, v131, v29
    s_waitcnt lgkmcnt(7)
    v_mfma_f32_16x16x32_bf16 v[80:83], a[20:23], a[72:75], v[80:83]
    ds_read_b128 a[16:19], v4 offset:60416
    v_mul_f32 v100, v100, v128
    v_mul_f32 v101, v101, v129
    v_mfma_f32_16x16x32_bf16 v[136:139], a[20:23], a[76:79], v[136:139]
    v_mul_f32 v102, v102, v130
    s_waitcnt lgkmcnt(7)
    v_mfma_f32_16x16x32_bf16 v[48:51], a[24:27], a[80:83], v[48:51]
    ds_read_b128 a[20:23], v4 offset:61440
    v_mul_f32 v103, v103, v131
    v_cvt_pk_bf16_f32 v98, v100, v101
    v_mfma_f32_16x16x32_bf16 v[104:107], a[24:27], a[84:87], v[104:107]
    v_cvt_pk_bf16_f32 v99, v102, v103
    s_waitcnt lgkmcnt(7)
    v_mfma_f32_16x16x32_bf16 v[52:55], a[28:31], a[80:83], v[52:55]
    ds_read_b128 a[24:27], v4 offset:62464
    buffer_store_dwordx4 v[96:99], v6, s[4:7], s26 offen offset:256 sc1
    v_mfma_f32_16x16x32_bf16 v[108:111], a[28:31], a[84:87], v[108:111]
    s_waitcnt lgkmcnt(7)
    v_mfma_f32_16x16x32_bf16 v[76:79], a[32:35], a[80:83], v[76:79]
    ds_read_b128 a[28:31], v4 offset:63488
    v_mfma_f32_16x16x32_bf16 v[132:135], a[32:35], a[84:87], v[132:135]
    s_waitcnt lgkmcnt(7)
    v_mfma_f32_16x16x32_bf16 v[80:83], a[0:3], a[80:83], v[80:83]
    ds_read_b128 a[32:35], v4 offset:64512
    v_mfma_f32_16x16x32_bf16 v[136:139], a[0:3], a[84:87], v[136:139]
    s_waitcnt lgkmcnt(7)
    v_mfma_f32_16x16x32_bf16 v[56:59], a[4:7], a[40:43], v[56:59]
    s_barrier
    ds_read_b128 a[0:3], v5 offset:0
    v_mfma_f32_16x16x32_bf16 v[112:115], a[4:7], a[44:47], v[112:115]
    s_waitcnt lgkmcnt(7)
    v_mfma_f32_16x16x32_bf16 v[60:63], a[8:11], a[40:43], v[60:63]
    ds_read_b128 a[4:7], v5 offset:1024
    v_mfma_f32_16x16x32_bf16 v[116:119], a[8:11], a[44:47], v[116:119]
    s_waitcnt lgkmcnt(7)
    v_mfma_f32_16x16x32_bf16 v[84:87], a[12:15], a[40:43], v[84:87]
    ds_read_b128 a[8:11], v5 offset:2048
    v_max_f32 v48, 0, v48
    v_max_f32 v49, 0, v49
    v_max_f32 v50, 0, v50
    v_mfma_f32_16x16x32_bf16 v[140:143], a[12:15], a[44:47], v[140:143]
    v_max_f32 v51, 0, v51
    v_mul_f32 v76, v76, v27
    v_mul_f32 v77, v77, v27
    s_waitcnt lgkmcnt(7)
    v_mfma_f32_16x16x32_bf16 v[88:91], a[16:19], a[40:43], v[88:91]
    ds_read_b128 a[12:15], v5 offset:3072
    v_mul_f32 v78, v78, v27
    v_mul_f32 v79, v79, v27
    v_mul_f32 v48, v48, v76
    v_mfma_f32_16x16x32_bf16 v[144:147], a[16:19], a[44:47], v[144:147]
    v_mul_f32 v49, v49, v77
    v_mul_f32 v50, v50, v78
    v_mul_f32 v51, v51, v79
    s_waitcnt lgkmcnt(7)
    v_mfma_f32_16x16x32_bf16 v[56:59], a[20:23], a[48:51], v[56:59]
    ds_read_b128 a[16:19], v5 offset:4096
    v_cvt_pk_bf16_f32 v48, v48, v49
    v_cvt_pk_bf16_f32 v49, v50, v51
    v_max_f32 v52, 0, v52
    v_mfma_f32_16x16x32_bf16 v[112:115], a[20:23], a[52:55], v[112:115]
    v_max_f32 v53, 0, v53
    v_max_f32 v54, 0, v54
    v_max_f32 v55, 0, v55
    s_waitcnt lgkmcnt(7)
    v_mfma_f32_16x16x32_bf16 v[60:63], a[24:27], a[48:51], v[60:63]
    ds_read_b128 a[20:23], v5 offset:5120
    v_mul_f32 v80, v80, v27
    v_mul_f32 v81, v81, v27
    v_mul_f32 v82, v82, v27
    v_mfma_f32_16x16x32_bf16 v[116:119], a[24:27], a[52:55], v[116:119]
    v_mul_f32 v83, v83, v27
    v_mul_f32 v52, v52, v80
    v_mul_f32 v53, v53, v81
    s_waitcnt lgkmcnt(7)
    v_mfma_f32_16x16x32_bf16 v[84:87], a[28:31], a[48:51], v[84:87]
    ds_read_b128 a[24:27], v5 offset:6144
    v_mul_f32 v54, v54, v82
    v_mul_f32 v55, v55, v83
    v_cvt_pk_bf16_f32 v50, v52, v53
    v_mfma_f32_16x16x32_bf16 v[140:143], a[28:31], a[52:55], v[140:143]
    v_cvt_pk_bf16_f32 v51, v54, v55
    buffer_store_dwordx4 v[48:51], v6, s[4:7], s26 offen offset:2048 sc1
    v_max_f32 v104, 0, v104
    s_waitcnt lgkmcnt(7)
    v_mfma_f32_16x16x32_bf16 v[88:91], a[32:35], a[48:51], v[88:91]
    ds_read_b128 a[28:31], v5 offset:7168
    v_max_f32 v105, 0, v105
    v_max_f32 v106, 0, v106
    v_max_f32 v107, 0, v107
    v_mfma_f32_16x16x32_bf16 v[144:147], a[32:35], a[52:55], v[144:147]
    v_mul_f32 v132, v132, v29
    v_mul_f32 v133, v133, v29
    v_mul_f32 v134, v134, v29
    s_waitcnt lgkmcnt(7)
    v_mfma_f32_16x16x32_bf16 v[56:59], a[0:3], a[56:59], v[56:59]
    ds_read_b128 a[32:35], v5 offset:8192
    v_mul_f32 v135, v135, v29
    v_mul_f32 v104, v104, v132
    v_mul_f32 v105, v105, v133
    v_mfma_f32_16x16x32_bf16 v[112:115], a[0:3], a[60:63], v[112:115]
    v_mul_f32 v106, v106, v134
    v_mul_f32 v107, v107, v135
    v_cvt_pk_bf16_f32 v104, v104, v105
    s_waitcnt lgkmcnt(7)
    v_mfma_f32_16x16x32_bf16 v[60:63], a[4:7], a[56:59], v[60:63]
    ds_read_b128 a[0:3], v5 offset:9216
    v_cvt_pk_bf16_f32 v105, v106, v107
    v_max_f32 v108, 0, v108
    v_max_f32 v109, 0, v109
    v_mfma_f32_16x16x32_bf16 v[116:119], a[4:7], a[60:63], v[116:119]
    v_max_f32 v110, 0, v110
    v_max_f32 v111, 0, v111
    v_mul_f32 v136, v136, v29
    s_waitcnt lgkmcnt(7)
    v_mfma_f32_16x16x32_bf16 v[84:87], a[8:11], a[56:59], v[84:87]
    ds_read_b128 a[4:7], v5 offset:10240
    v_mul_f32 v137, v137, v29
    v_mul_f32 v138, v138, v29
    v_mul_f32 v139, v139, v29
    v_mfma_f32_16x16x32_bf16 v[140:143], a[8:11], a[60:63], v[140:143]
    v_mul_f32 v108, v108, v136
    v_mul_f32 v109, v109, v137
    v_mul_f32 v110, v110, v138
    s_waitcnt lgkmcnt(7)
    v_mfma_f32_16x16x32_bf16 v[88:91], a[12:15], a[56:59], v[88:91]
    ds_read_b128 a[8:11], v5 offset:11264
    v_mul_f32 v111, v111, v139
    v_cvt_pk_bf16_f32 v106, v108, v109
    v_mfma_f32_16x16x32_bf16 v[144:147], a[12:15], a[60:63], v[144:147]
    v_cvt_pk_bf16_f32 v107, v110, v111
    buffer_store_dwordx4 v[104:107], v6, s[4:7], s26 offen offset:2304 sc1
    s_waitcnt lgkmcnt(7)
    v_mfma_f32_16x16x32_bf16 v[56:59], a[16:19], a[64:67], v[56:59]
    ds_read_b128 a[12:15], v5 offset:12288
    v_mfma_f32_16x16x32_bf16 v[112:115], a[16:19], a[68:71], v[112:115]
    s_waitcnt lgkmcnt(7)
    v_mfma_f32_16x16x32_bf16 v[60:63], a[20:23], a[64:67], v[60:63]
    ds_read_b128 a[16:19], v5 offset:13312
    v_mfma_f32_16x16x32_bf16 v[116:119], a[20:23], a[68:71], v[116:119]
    s_waitcnt lgkmcnt(7)
    v_mfma_f32_16x16x32_bf16 v[84:87], a[24:27], a[64:67], v[84:87]
    s_barrier
    ds_read_b128 a[20:23], v5 offset:14336
    v_mfma_f32_16x16x32_bf16 v[140:143], a[24:27], a[68:71], v[140:143]
    s_waitcnt lgkmcnt(7)
    v_mfma_f32_16x16x32_bf16 v[88:91], a[28:31], a[64:67], v[88:91]
    ds_read_b128 a[24:27], v5 offset:15360
    v_mfma_f32_16x16x32_bf16 v[144:147], a[28:31], a[68:71], v[144:147]
    s_waitcnt lgkmcnt(7)
    v_mfma_f32_16x16x32_bf16 v[56:59], a[32:35], a[72:75], v[56:59]
    ds_read_b128 a[28:31], v3 offset:0
    v_mfma_f32_16x16x32_bf16 v[112:115], a[32:35], a[76:79], v[112:115]
    s_waitcnt lgkmcnt(7)
    v_mfma_f32_16x16x32_bf16 v[60:63], a[0:3], a[72:75], v[60:63]
    ds_read_b128 a[32:35], v3 offset:1024
    v_mfma_f32_16x16x32_bf16 v[116:119], a[0:3], a[76:79], v[116:119]
    s_waitcnt lgkmcnt(7)
    v_mfma_f32_16x16x32_bf16 v[84:87], a[4:7], a[72:75], v[84:87]
    ds_read_b128 a[0:3], v3 offset:2048
    v_mfma_f32_16x16x32_bf16 v[140:143], a[4:7], a[76:79], v[140:143]
    s_waitcnt lgkmcnt(7)
    v_mfma_f32_16x16x32_bf16 v[88:91], a[8:11], a[72:75], v[88:91]
    ds_read_b128 a[4:7], v3 offset:3072
    v_mfma_f32_16x16x32_bf16 v[144:147], a[8:11], a[76:79], v[144:147]
    s_waitcnt lgkmcnt(7)
    v_mfma_f32_16x16x32_bf16 v[56:59], a[12:15], a[80:83], v[56:59]
    ds_read_b128 a[8:11], v3 offset:4096
    v_mfma_f32_16x16x32_bf16 v[112:115], a[12:15], a[84:87], v[112:115]
    s_waitcnt lgkmcnt(7)
    v_mfma_f32_16x16x32_bf16 v[60:63], a[16:19], a[80:83], v[60:63]
    ds_read_b128 a[12:15], v3 offset:5120
    v_mfma_f32_16x16x32_bf16 v[116:119], a[16:19], a[84:87], v[116:119]
    s_waitcnt lgkmcnt(7)
    v_mfma_f32_16x16x32_bf16 v[84:87], a[20:23], a[80:83], v[84:87]
    ds_read_b128 a[16:19], v3 offset:6144
    v_mfma_f32_16x16x32_bf16 v[140:143], a[20:23], a[84:87], v[140:143]
    s_waitcnt lgkmcnt(7)
    v_mfma_f32_16x16x32_bf16 v[88:91], a[24:27], a[80:83], v[88:91]
    ds_read_b128 a[20:23], v3 offset:7168
    v_mfma_f32_16x16x32_bf16 v[144:147], a[24:27], a[84:87], v[144:147]
    s_waitcnt lgkmcnt(7)
    v_mfma_f32_16x16x32_bf16 v[64:67], a[28:31], a[40:43], v[64:67]
    ds_read_b128 a[24:27], v3 offset:8192
    v_mfma_f32_16x16x32_bf16 v[120:123], a[28:31], a[44:47], v[120:123]
    s_waitcnt lgkmcnt(7)
    v_mfma_f32_16x16x32_bf16 v[92:95], a[32:35], a[40:43], v[92:95]
    ds_read_b128 a[28:31], v3 offset:9216
    v_mfma_f32_16x16x32_bf16 v[148:151], a[32:35], a[44:47], v[148:151]
    s_waitcnt lgkmcnt(7)
    v_mfma_f32_16x16x32_bf16 v[64:67], a[0:3], a[48:51], v[64:67]
    ds_read_b128 a[32:35], v3 offset:10240
    v_max_f32 v56, 0, v56
    v_max_f32 v57, 0, v57
    v_mfma_f32_16x16x32_bf16 v[120:123], a[0:3], a[52:55], v[120:123]
    v_max_f32 v58, 0, v58
    s_waitcnt lgkmcnt(7)
    v_mfma_f32_16x16x32_bf16 v[92:95], a[4:7], a[48:51], v[92:95]
    ds_read_b128 a[0:3], v3 offset:11264
    v_max_f32 v59, 0, v59
    v_mul_f32 v84, v84, v27
    v_mfma_f32_16x16x32_bf16 v[148:151], a[4:7], a[52:55], v[148:151]
    v_mul_f32 v85, v85, v27
    s_waitcnt lgkmcnt(7)
    v_mfma_f32_16x16x32_bf16 v[64:67], a[8:11], a[56:59], v[64:67]
    v_mul_f32 v86, v86, v27
    v_mul_f32 v87, v87, v27
    v_mfma_f32_16x16x32_bf16 v[120:123], a[8:11], a[60:63], v[120:123]
    v_mul_f32 v56, v56, v84
    s_waitcnt lgkmcnt(6)
    v_mfma_f32_16x16x32_bf16 v[92:95], a[12:15], a[56:59], v[92:95]
    v_mul_f32 v57, v57, v85
    v_mul_f32 v58, v58, v86
    v_mfma_f32_16x16x32_bf16 v[148:151], a[12:15], a[60:63], v[148:151]
    v_mul_f32 v59, v59, v87
    s_waitcnt lgkmcnt(5)
    v_mfma_f32_16x16x32_bf16 v[64:67], a[16:19], a[64:67], v[64:67]
    v_cvt_pk_bf16_f32 v56, v56, v57
    v_cvt_pk_bf16_f32 v57, v58, v59
    v_mfma_f32_16x16x32_bf16 v[120:123], a[16:19], a[68:71], v[120:123]
    v_max_f32 v60, 0, v60
    s_waitcnt lgkmcnt(4)
    v_mfma_f32_16x16x32_bf16 v[92:95], a[20:23], a[64:67], v[92:95]
    v_max_f32 v61, 0, v61
    v_max_f32 v62, 0, v62
    v_mfma_f32_16x16x32_bf16 v[148:151], a[20:23], a[68:71], v[148:151]
    v_max_f32 v63, 0, v63
    s_waitcnt lgkmcnt(3)
    v_mfma_f32_16x16x32_bf16 v[64:67], a[24:27], a[72:75], v[64:67]
    v_mul_f32 v88, v88, v27
    v_mul_f32 v89, v89, v27
    v_mfma_f32_16x16x32_bf16 v[120:123], a[24:27], a[76:79], v[120:123]
    v_mul_f32 v90, v90, v27
    s_waitcnt lgkmcnt(2)
    v_mfma_f32_16x16x32_bf16 v[92:95], a[28:31], a[72:75], v[92:95]
    v_mul_f32 v91, v91, v27
    v_mul_f32 v60, v60, v88
    v_mfma_f32_16x16x32_bf16 v[148:151], a[28:31], a[76:79], v[148:151]
    v_mul_f32 v61, v61, v89
    s_waitcnt lgkmcnt(1)
    v_mfma_f32_16x16x32_bf16 v[64:67], a[32:35], a[80:83], v[64:67]
    v_mul_f32 v62, v62, v90
    v_mul_f32 v63, v63, v91
    v_mfma_f32_16x16x32_bf16 v[120:123], a[32:35], a[84:87], v[120:123]
    v_cvt_pk_bf16_f32 v58, v60, v61
    s_waitcnt lgkmcnt(0)
    v_mfma_f32_16x16x32_bf16 v[92:95], a[0:3], a[80:83], v[92:95]
    v_cvt_pk_bf16_f32 v59, v62, v63
    buffer_store_dwordx4 v[56:59], v6, s[4:7], s27 offen offset:0 sc1
    v_mfma_f32_16x16x32_bf16 v[148:151], a[0:3], a[84:87], v[148:151]
    v_max_f32 v112, 0, v112
    s_waitcnt vmcnt(1)
    s_barrier
    v_max_f32 v113, 0, v113
    v_max_f32 v114, 0, v114
    v_max_f32 v115, 0, v115
    v_mul_f32 v140, v140, v29
    v_mul_f32 v141, v141, v29
    v_mul_f32 v142, v142, v29
    v_mul_f32 v143, v143, v29
    v_mul_f32 v112, v112, v140
    v_mul_f32 v113, v113, v141
    v_mul_f32 v114, v114, v142
    v_mul_f32 v115, v115, v143
    v_cvt_pk_bf16_f32 v112, v112, v113
    v_cvt_pk_bf16_f32 v113, v114, v115
    v_max_f32 v116, 0, v116
    v_max_f32 v117, 0, v117
    v_max_f32 v118, 0, v118
    v_max_f32 v119, 0, v119
    v_mul_f32 v144, v144, v29
    v_mul_f32 v145, v145, v29
    v_mul_f32 v146, v146, v29
    v_mul_f32 v147, v147, v29
    v_mul_f32 v116, v116, v144
    v_mul_f32 v117, v117, v145
    v_mul_f32 v118, v118, v146
    v_mul_f32 v119, v119, v147
    v_cvt_pk_bf16_f32 v114, v116, v117
    v_cvt_pk_bf16_f32 v115, v118, v119
    buffer_store_dwordx4 v[112:115], v6, s[4:7], s27 offen offset:256 sc1
    s_nop 7
    v_max_f32 v64, 0, v64
    v_max_f32 v65, 0, v65
    v_max_f32 v66, 0, v66
    v_max_f32 v67, 0, v67
    v_mul_f32 v92, v92, v27
    v_mul_f32 v93, v93, v27
    v_mul_f32 v94, v94, v27
    v_mul_f32 v95, v95, v27
    v_mul_f32 v64, v64, v92
    v_mul_f32 v65, v65, v93
    v_mul_f32 v66, v66, v94
    v_mul_f32 v67, v67, v95
    v_cvt_pk_bf16_f32 v64, v64, v65
    v_cvt_pk_bf16_f32 v65, v66, v67
    v_max_f32 v120, 0, v120
    v_max_f32 v121, 0, v121
    v_max_f32 v122, 0, v122
    v_max_f32 v123, 0, v123
    v_mul_f32 v148, v148, v29
    v_mul_f32 v149, v149, v29
    v_mul_f32 v150, v150, v29
    v_mul_f32 v151, v151, v29
    v_mul_f32 v120, v120, v148
    v_mul_f32 v121, v121, v149
    v_mul_f32 v122, v122, v150
    v_mul_f32 v123, v123, v151
    v_cvt_pk_bf16_f32 v66, v120, v121
    v_cvt_pk_bf16_f32 v67, v122, v123
    s_nop 1
    v_permlane16_swap_b32 v64, v66
    v_permlane16_swap_b32 v65, v67
    buffer_store_dwordx4 v[64:67], v14, s[4:7], s27 offen offset:2048 sc1
    s_lshl_b32 s53, s12, 4
    s_waitcnt vmcnt(0)
    v_mov_b32 v10, 148868
    v_mov_b32 v11, s44
    s_mov_b64 exec, 1
    ds_add_rtn_u32 v12, v10, v11
    s_mov_b64 exec, -1
    s_lshl_b32 s50, s53, 7
    s_add_u32 s50, s50, s18
    s_add_u32 s50, s50, 23986176
    v_lshlrev_b32 v10, 7, v1
    v_mov_b32 v11, 1
    s_waitcnt lgkmcnt(0)
    v_readfirstlane_b32 s51, v12
    s_bfe_u32 s45, s51, 0x20010
    s_and_b32 s52, s22, 4
    s_or_b32 s45, s45, s52
    s_and_b32 s51, s51, 3
    s_cmp_lg_u32 s51, 3
    s_cbranch_scc1 L_mega_kernel_sig_65
    s_mov_b32 exec_lo, 0xffff
    s_mov_b32 exec_hi, 0
    buffer_atomic_add v11, v10, s[4:7], s50 offen sc1
    s_mov_b64 exec, -1
L_mega_kernel_sig_65:
    v_lshrrev_b32 v14, 1, v8
    v_lshlrev_b32 v14, 9, v14
    v_lshl_add_u32 v14, v7, 4, v14
    s_lshl_b32 s24, s14, 1
    s_lshr_b32 s25, s23, 1
    s_add_u32 s24, s24, s25
    s_and_b32 s25, s23, 1
    s_lshl_b32 s25, s25, 8
    s_mul_i32 s20, s24, 114688
    s_add_u32 s20, s20, s25
    s_add_u32 s20, s20, s18
    s_add_u32 s20, s20, 16515072
    s_mul_i32 s26, s24, 40960
    s_mul_i32 s27, s15, 5120
    s_add_u32 s26, s26, s27
    s_add_u32 s26, s26, s25
    s_add_u32 s26, s26, s18
    s_add_u32 s26, s26, 24117248
    s_add_u32 s27, s26, 4096
    s_lshl_b32 s28, s15, 14
    s_lshl_b32 s29, s24, 8
    s_add_u32 s28, s28, s29
    s_lshr_b32 s29, s25, 1
    s_add_u32 s28, s28, s29
    s_add_u32 s28, s28, s18
    s_add_u32 s28, s28, 26738688
    v_add_u32 v36, s31, v3
    v_add_u32 v37, s31, v4
    v_add_u32 v38, s31, v5
    s_barrier
    ds_read_b128 a[0:3], v4 offset:8192
    ds_read_b128 a[4:7], v4 offset:9216
    ds_read_b128 a[8:11], v4 offset:10240
    ds_read_b128 a[12:15], v4 offset:11264
    ds_read_b128 a[16:19], v4 offset:12288
    ds_read_b128 a[20:23], v4 offset:13312
    ds_read_b128 a[24:27], v4 offset:14336
    ds_read_b128 a[28:31], v4 offset:15360
    ds_read_b128 a[32:35], v4 offset:16384
    ds_read_b128 a[76:79], v4 offset:17408
    ds_read_b128 a[80:83], v4 offset:18432
    ds_read_b128 a[84:87], v4 offset:19456
    s_waitcnt lgkmcnt(2)
    ds_read_b128 a[88:91], v4 offset:20480
    ds_read_b128 a[92:95], v4 offset:21504
    ds_read_b128 v[64:67], v4 offset:22528
    ds_read_b128 v[68:71], v4 offset:23552
    ds_read_b128 v[72:75], v4 offset:24576
    ds_read_b128 v[76:79], v4 offset:25600
    ds_read_b128 v[80:83], v4 offset:26624
    ds_read_b128 v[84:87], v4 offset:27648
    ds_read_b128 v[88:91], v4 offset:28672
    ds_read_b128 v[92:95], v4 offset:29696
    ds_read_b128 v[96:99], v4 offset:30720
    ds_read_b128 v[100:103], v4 offset:31744
    s_waitcnt lgkmcnt(2)
    ds_read_b128 v[104:107], v3 offset:24576
    ds_read_b128 v[108:111], v3 offset:25600
    ds_read_b128 v[112:115], v3 offset:26624
    ds_read_b128 v[116:119], v3 offset:27648
    ds_read_b128 v[120:123], v3 offset:28672
    ds_read_b128 v[124:127], v3 offset:29696
    ds_read_b128 v[128:131], v3 offset:30720
    ds_read_b128 v[132:135], v3 offset:31744
    v_mov_b32 v10, 148888
    s_add_u32 s21, s19, 1
    v_mov_b32 v11, s21
    s_cmp_lg_u32 s45, 0
    s_cbranch_scc1 L_mega_kernel_polls_68
    s_lshl_b32 s53, s14, 3
    s_add_u32 s53, s53, s15
    s_lshl_b32 s50, s53, 7
    s_add_u32 s50, s50, s18
    s_add_u32 s50, s50, 23986176
    s_add_u32 s53, s3, 16
    s_mov_b32 s52, 0x400000
L_mega_kernel_sp_69:
    s_buffer_load_dword s51, s[4:7], s50 glc
    s_sub_u32 s52, s52, 1
    s_waitcnt lgkmcnt(0)
    s_cmp_lg_u32 s51, s53
    s_cbranch_scc0 L_mega_kernel_po_71
    s_and_b32 s51, s52, 31
    s_cbranch_scc1 L_mega_kernel_sp_69
    buffer_load_dword v9, off, s[4:7], s50 sc1
    s_cmp_eq_u32 s52, 0
    s_cbranch_scc1 L_mega_kernel_po_71
    s_waitcnt vmcnt(0)
    v_readfirstlane_b32 s51, v9
    s_cmp_lg_u32 s51, s53
    s_cbranch_scc1 L_mega_kernel_sp_69
L_mega_kernel_po_71:
    ds_write_b32 v10, v11
    s_branch L_mega_kernel_lg_67
L_mega_kernel_polls_68:
    s_mov_b32 s52, 0x1000000
L_mega_kernel_lw_66:
    ds_read_b32 v12, v10
    s_sub_u32 s52, s52, 1
    s_waitcnt lgkmcnt(0)
    s_cbranch_scc1 L_mega_kernel_lg_67
    v_readfirstlane_b32 s51, v12
    s_cmp_lg_u32 s51, s21
    s_cbranch_scc1 L_mega_kernel_lw_66
L_mega_kernel_lg_67:
    buffer_load_dwordx4 a[40:43], v6, s[4:7], s20 offen offset:0 sc1
    buffer_load_dwordx4 a[44:47], v6, s[4:7], s20 offen offset:2048 sc1
    s_add_u32 s20, s20, 4096
    buffer_load_dwordx4 a[48:51], v6, s[4:7], s20 offen offset:0 sc1
    buffer_load_dwordx4 a[52:55], v6, s[4:7], s20 offen offset:2048 sc1
    s_add_u32 s20, s20, 4096
    buffer_load_dwordx4 a[56:59], v6, s[4:7], s20 offen offset:0 sc1
    buffer_load_dwordx4 a[60:63], v6, s[4:7], s20 offen offset:2048 sc1
    s_add_u32 s20, s20, 4096
    buffer_load_dwordx4 a[64:67], v6, s[4:7], s20 offen offset:0 sc1
    buffer_load_dwordx4 a[68:71], v6, s[4:7], s20 offen offset:2048 sc1
    s_add_u32 s20, s20, 4096
    s_waitcnt vmcnt(7) lgkmcnt(12)
    v_mfma_f32_16x16x32_bf16 v[40:43], a[0:3], a[40:43], 0
    ds_read_b128 v[136:139], v3 offset:32768
    s_waitcnt lgkmcnt(12)
    v_mfma_f32_16x16x32_bf16 v[44:47], a[4:7], a[40:43], 0
    ds_read_b128 v[140:143], v3 offset:33792
    buffer_load_dwordx4 a[72:75], v6, s[4:7], s20 offen offset:0 sc1
    s_waitcnt lgkmcnt(12)
    v_mfma_f32_16x16x32_bf16 v[48:51], a[8:11], a[40:43], 0
    ds_read_b128 v[144:147], v3 offset:34816
    s_waitcnt lgkmcnt(12)
    v_mfma_f32_16x16x32_bf16 v[52:55], a[12:15], a[40:43], 0
    ds_read_b128 v[148:151], v3 offset:35840
    s_waitcnt lgkmcnt(12)
    v_mfma_f32_16x16x32_bf16 v[56:59], a[16:19], a[40:43], 0
    ds_read_b128 v[152:155], v3 offset:36864
    s_waitcnt vmcnt(7) lgkmcnt(12)
    v_mfma_f32_16x16x32_bf16 v[40:43], a[20:23], a[44:47], v[40:43]
    ds_read_b128 v[156:159], v3 offset:37888
    s_waitcnt lgkmcnt(12)
    v_mfma_f32_16x16x32_bf16 v[44:47], a[24:27], a[44:47], v[44:47]
    ds_read_b128 a[0:3], v3 offset:38912
    buffer_load_dwordx4 a[40:43], v6, s[4:7], s20 offen offset:2048 sc1
    s_add_u32 s20, s20, 4096
    s_waitcnt lgkmcnt(12)
    v_mfma_f32_16x16x32_bf16 v[48:51], a[28:31], a[44:47], v[48:51]
    ds_read_b128 a[4:7], v3 offset:39936
    s_waitcnt lgkmcnt(12)
    v_mfma_f32_16x16x32_bf16 v[52:55], a[32:35], a[44:47], v[52:55]
    ds_read_b128 a[8:11], v3 offset:40960
    s_waitcnt lgkmcnt(12)
    v_mfma_f32_16x16x32_bf16 v[56:59], a[76:79], a[44:47], v[56:59]
    ds_read_b128 a[12:15], v3 offset:41984
    s_waitcnt vmcnt(7) lgkmcnt(12)
    v_mfma_f32_16x16x32_bf16 v[40:43], a[80:83], a[48:51], v[40:43]
    ds_read_b128 a[16:19], v3 offset:43008
    s_waitcnt lgkmcnt(12)
    v_mfma_f32_16x16x32_bf16 v[44:47], a[84:87], a[48:51], v[44:47]
    ds_read_b128 a[20:23], v3 offset:44032
    buffer_load_dwordx4 a[44:47], v6, s[4:7], s20 offen offset:0 sc1
    s_waitcnt lgkmcnt(12)
    v_mfma_f32_16x16x32_bf16 v[48:51], a[88:91], a[48:51], v[48:51]
    ds_read_b128 a[24:27], v3 offset:45056
    s_waitcnt lgkmcnt(12)
    v_mfma_f32_16x16x32_bf16 v[52:55], a[92:95], a[48:51], v[52:55]
    ds_read_b128 a[28:31], v3 offset:46080
    s_waitcnt lgkmcnt(12)
    v_mfma_f32_16x16x32_bf16 v[56:59], v[64:67], a[48:51], v[56:59]
    ds_read_b128 a[32:35], v3 offset:47104
    s_waitcnt vmcnt(7) lgkmcnt(12)
    v_mfma_f32_16x16x32_bf16 v[40:43], v[68:71], a[52:55], v[40:43]
    ds_read_b128 a[76:79], v3 offset:48128
    s_waitcnt lgkmcnt(12)
    v_mfma_f32_16x16x32_bf16 v[44:47], v[72:75], a[52:55], v[44:47]
    ds_read_b128 a[80:83], v4 offset:32768
    buffer_load_dwordx4 a[48:51], v6, s[4:7], s20 offen offset:2048 sc1
    s_add_u32 s20, s20, 4096
    s_waitcnt lgkmcnt(12)
    v_mfma_f32_16x16x32_bf16 v[48:51], v[76:79], a[52:55], v[48:51]
    ds_read_b128 a[84:87], v4 offset:33792
    s_waitcnt lgkmcnt(12)
    v_mfma_f32_16x16x32_bf16 v[52:55], v[80:83], a[52:55], v[52:55]
    ds_read_b128 a[88:91], v4 offset:34816
    s_waitcnt lgkmcnt(12)
    v_mfma_f32_16x16x32_bf16 v[56:59], v[84:87], a[52:55], v[56:59]
    ds_read_b128 a[92:95], v4 offset:35840
    s_waitcnt vmcnt(7) lgkmcnt(12)
    v_mfma_f32_16x16x32_bf16 v[40:43], v[88:91], a[56:59], v[40:43]
    ds_read_b128 v[64:67], v4 offset:36864
    s_waitcnt lgkmcnt(12)
    v_mfma_f32_16x16x32_bf16 v[44:47], v[92:95], a[56:59], v[44:47]
    ds_read_b128 v[68:71], v4 offset:37888
    buffer_load_dwordx4 a[52:55], v6, s[4:7], s20 offen offset:0 sc1
    s_waitcnt lgkmcnt(12)
    v_mfma_f32_16x16x32_bf16 v[48:51], v[96:99], a[56:59], v[48:51]
    ds_read_b128 v[72:75], v4 offset:38912
    s_waitcnt lgkmcnt(12)
    v_mfma_f32_16x16x32_bf16 v[52:55], v[100:103], a[56:59], v[52:55]
    ds_read_b128 v[76:79], v4 offset:39936
    s_waitcnt lgkmcnt(12)
    v_mfma_f32_16x16x32_bf16 v[56:59], v[104:107], a[56:59], v[56:59]
    ds_read_b128 v[80:83], v4 offset:40960
    s_waitcnt vmcnt(7) lgkmcnt(12)
    v_mfma_f32_16x16x32_bf16 v[40:43], v[108:111], a[60:63], v[40:43]
    ds_read_b128 v[84:87], v4 offset:41984
    s_waitcnt lgkmcnt(12)
    v_mfma_f32_16x16x32_bf16 v[44:47], v[112:115], a[60:63], v[44:47]
    ds_read_b128 v[88:91], v4 offset:43008
    buffer_load_dwordx4 a[56:59], v6, s[4:7], s20 offen offset:2048 sc1
    s_add_u32 s20, s20, 4096
    s_waitcnt lgkmcnt(12)
    v_mfma_f32_16x16x32_bf16 v[48:51], v[116:119], a[60:63], v[48:51]
    ds_read_b128 v[92:95], v4 offset:44032
    s_waitcnt lgkmcnt(12)
    v_mfma_f32_16x16x32_bf16 v[52:55], v[120:123], a[60:63], v[52:55]
    ds_read_b128 v[96:99], v4 offset:45056
    s_waitcnt lgkmcnt(12)
    v_mfma_f32_16x16x32_bf16 v[56:59], v[124:127], a[60:63], v[56:59]
    ds_read_b128 v[100:103], v4 offset:46080
    s_waitcnt vmcnt(7) lgkmcnt(12)
    v_mfma_f32_16x16x32_bf16 v[40:43], v[128:131], a[64:67], v[40:43]
    ds_read_b128 v[104:107], v4 offset:47104
    s_waitcnt lgkmcnt(12)
    v_mfma_f32_16x16x32_bf16 v[44:47], v[132:135], a[64:67], v[44:47]
    ds_read_b128 v[108:111], v4 offset:48128
    buffer_load_dwordx4 a[60:63], v6, s[4:7], s20 offen offset:0 sc1
    s_waitcnt lgkmcnt(12)
    v_mfma_f32_16x16x32_bf16 v[48:51], v[136:139], a[64:67], v[48:51]
    ds_read_b128 v[112:115], v4 offset:49152
    s_waitcnt lgkmcnt(12)
    v_mfma_f32_16x16x32_bf16 v[52:55], v[140:143], a[64:67], v[52:55]
    ds_read_b128 v[116:119], v4 offset:50176
    s_waitcnt lgkmcnt(12)
    v_mfma_f32_16x16x32_bf16 v[56:59], v[144:147], a[64:67], v[56:59]
    ds_read_b128 v[120:123], v4 offset:51200
    s_waitcnt vmcnt(7) lgkmcnt(12)
    v_mfma_f32_16x16x32_bf16 v[40:43], v[148:151], a[68:71], v[40:43]
    ds_read_b128 v[124:127], v4 offset:52224
    s_waitcnt lgkmcnt(12)
    v_mfma_f32_16x16x32_bf16 v[44:47], v[152:155], a[68:71], v[44:47]
    ds_read_b128 v[128:131], v4 offset:53248
    buffer_load_dwordx4 a[64:67], v6, s[4:7], s20 offen offset:2048 sc1
    s_add_u32 s20, s20, 4096
    s_waitcnt lgkmcnt(12)
    v_mfma_f32_16x16x32_bf16 v[48:51], v[156:159], a[68:71], v[48:51]
    ds_read_b128 v[132:135], v4 offset:54272
    s_waitcnt lgkmcnt(12)
    v_mfma_f32_16x16x32_bf16 v[52:55], a[0:3], a[68:71], v[52:55]
    ds_read_b128 v[136:139], v4 offset:55296
    s_waitcnt lgkmcnt(12)
    v_mfma_f32_16x16x32_bf16 v[56:59], a[4:7], a[68:71], v[56:59]
    ds_read_b128 v[140:143], v4 offset:56320
    s_waitcnt vmcnt(7) lgkmcnt(12)
    v_mfma_f32_16x16x32_bf16 v[40:43], a[8:11], a[72:75], v[40:43]
    ds_read_b128 v[144:147], v3 offset:49152
    s_waitcnt lgkmcnt(12)
    v_mfma_f32_16x16x32_bf16 v[44:47], a[12:15], a[72:75], v[44:47]
    ds_read_b128 v[148:151], v3 offset:50176
    buffer_load_dwordx4 a[68:71], v6, s[4:7], s20 offen offset:0 sc1
    s_waitcnt lgkmcnt(12)
    v_mfma_f32_16x16x32_bf16 v[48:51], a[16:19], a[72:75], v[48:51]
    ds_read_b128 v[152:155], v3 offset:51200
    s_waitcnt lgkmcnt(12)
    v_mfma_f32_16x16x32_bf16 v[52:55], a[20:23], a[72:75], v[52:55]
    ds_read_b128 v[156:159], v3 offset:52224
    s_waitcnt lgkmcnt(12)
    v_mfma_f32_16x16x32_bf16 v[56:59], a[24:27], a[72:75], v[56:59]
    ds_read_b128 a[0:3], v3 offset:53248
    s_waitcnt vmcnt(7) lgkmcnt(12)
    v_mfma_f32_16x16x32_bf16 v[40:43], a[28:31], a[40:43], v[40:43]
    ds_read_b128 a[4:7], v3 offset:54272
    s_waitcnt lgkmcnt(12)
    v_mfma_f32_16x16x32_bf16 v[44:47], a[32:35], a[40:43], v[44:47]
    ds_read_b128 a[8:11], v3 offset:55296
    buffer_load_dwordx4 a[72:75], v6, s[4:7], s20 offen offset:2048 sc1
    s_add_u32 s20, s20, 4096
    s_waitcnt lgkmcnt(12)
    v_mfma_f32_16x16x32_bf16 v[48:51], a[76:79], a[40:43], v[48:51]
    ds_read_b128 a[12:15], v3 offset:56320
    s_waitcnt lgkmcnt(12)
    v_mfma_f32_16x16x32_bf16 v[52:55], a[80:83], a[40:43], v[52:55]
    ds_read_b128 a[16:19], v3 offset:57344
    s_waitcnt lgkmcnt(12)
    v_mfma_f32_16x16x32_bf16 v[56:59], a[84:87], a[40:43], v[56:59]
    ds_read_b128 a[20:23], v3 offset:58368
    s_waitcnt vmcnt(7) lgkmcnt(12)
    v_mfma_f32_16x16x32_bf16 v[40:43], a[88:91], a[44:47], v[40:43]
    ds_read_b128 a[24:27], v3 offset:59392
    s_waitcnt lgkmcnt(12)
    v_mfma_f32_16x16x32_bf16 v[44:47], a[92:95], a[44:47], v[44:47]
    ds_read_b128 a[28:31], v3 offset:60416
    buffer_load_dwordx4 a[40:43], v6, s[4:7], s20 offen offset:0 sc1
    s_waitcnt lgkmcnt(12)
    v_mfma_f32_16x16x32_bf16 v[48:51], v[64:67], a[44:47], v[48:51]
    ds_read_b128 a[32:35], v3 offset:61440
    s_waitcnt lgkmcnt(12)
    v_mfma_f32_16x16x32_bf16 v[52:55], v[68:71], a[44:47], v[52:55]
    ds_read_b128 a[76:79], v3 offset:62464
    s_waitcnt lgkmcnt(12)
    v_mfma_f32_16x16x32_bf16 v[56:59], v[72:75], a[44:47], v[56:59]
    ds_read_b128 a[80:83], v3 offset:63488
    s_waitcnt vmcnt(7) lgkmcnt(12)
    v_mfma_f32_16x16x32_bf16 v[40:43], v[76:79], a[48:51], v[40:43]
    ds_read_b128 a[84:87], v3 offset:64512
    s_waitcnt lgkmcnt(12)
    v_mfma_f32_16x16x32_bf16 v[44:47], v[80:83], a[48:51], v[44:47]
    ds_read_b128 a[88:91], v4 offset:0
    buffer_load_dwordx4 a[44:47], v6, s[4:7], s20 offen offset:2048 sc1
    s_add_u32 s20, s20, 4096
    s_waitcnt lgkmcnt(12)
    v_mfma_f32_16x16x32_bf16 v[48:51], v[84:87], a[48:51], v[48:51]
    ds_read_b128 a[92:95], v4 offset:1024
    s_waitcnt lgkmcnt(12)
    v_mfma_f32_16x16x32_bf16 v[52:55], v[88:91], a[48:51], v[52:55]
    ds_read_b128 v[64:67], v4 offset:2048
    s_waitcnt lgkmcnt(12)
    v_mfma_f32_16x16x32_bf16 v[56:59], v[92:95], a[48:51], v[56:59]
    ds_read_b128 v[68:71], v4 offset:3072
    s_waitcnt vmcnt(7) lgkmcnt(12)
    v_mfma_f32_16x16x32_bf16 v[40:43], v[96:99], a[52:55], v[40:43]
    ds_read_b128 v[72:75], v4 offset:4096
    s_waitcnt lgkmcnt(12)
    v_mfma_f32_16x16x32_bf16 v[44:47], v[100:103], a[52:55], v[44:47]
    ds_read_b128 v[76:79], v4 offset:5120
    buffer_load_dwordx4 a[48:51], v6, s[4:7], s20 offen offset:0 sc1
    s_waitcnt lgkmcnt(12)
    v_mfma_f32_16x16x32_bf16 v[48:51], v[104:107], a[52:55], v[48:51]
    ds_read_b128 v[80:83], v4 offset:6144
    s_waitcnt lgkmcnt(12)
    v_mfma_f32_16x16x32_bf16 v[52:55], v[108:111], a[52:55], v[52:55]
    ds_read_b128 v[84:87], v4 offset:7168
    s_waitcnt lgkmcnt(0)
    s_barrier
    s_waitcnt lgkmcnt(12)
    v_mfma_f32_16x16x32_bf16 v[56:59], v[112:115], a[52:55], v[56:59]
    s_waitcnt vmcnt(7) lgkmcnt(12)
    v_mfma_f32_16x16x32_bf16 v[40:43], v[116:119], a[56:59], v[40:43]
    s_waitcnt lgkmcnt(12)
    v_mfma_f32_16x16x32_bf16 v[44:47], v[120:123], a[56:59], v[44:47]
    buffer_load_dwordx4 a[52:55], v6, s[4:7], s20 offen offset:2048 sc1
    s_add_u32 s20, s20, 4096
    s_waitcnt lgkmcnt(12)
    v_mfma_f32_16x16x32_bf16 v[48:51], v[124:127], a[56:59], v[48:51]
    s_waitcnt lgkmcnt(12)
    v_mfma_f32_16x16x32_bf16 v[52:55], v[128:131], a[56:59], v[52:55]
    s_waitcnt lgkmcnt(12)
    v_mfma_f32_16x16x32_bf16 v[56:59], v[132:135], a[56:59], v[56:59]
    s_waitcnt vmcnt(7) lgkmcnt(12)
    v_mfma_f32_16x16x32_bf16 v[40:43], v[136:139], a[60:63], v[40:43]
    s_waitcnt lgkmcnt(12)
    v_mfma_f32_16x16x32_bf16 v[44:47], v[140:143], a[60:63], v[44:47]
    buffer_load_dwordx4 a[56:59], v6, s[4:7], s20 offen offset:0 sc1
    s_waitcnt lgkmcnt(12)
    v_mfma_f32_16x16x32_bf16 v[48:51], v[144:147], a[60:63], v[48:51]
    s_waitcnt lgkmcnt(12)
    v_mfma_f32_16x16x32_bf16 v[52:55], v[148:151], a[60:63], v[52:55]
    s_waitcnt lgkmcnt(12)
    v_mfma_f32_16x16x32_bf16 v[56:59], v[152:155], a[60:63], v[56:59]
    s_waitcnt vmcnt(7) lgkmcnt(12)
    v_mfma_f32_16x16x32_bf16 v[40:43], v[156:159], a[64:67], v[40:43]
    s_waitcnt lgkmcnt(12)
    v_mfma_f32_16x16x32_bf16 v[44:47], a[0:3], a[64:67], v[44:47]
    buffer_load_dwordx4 a[60:63], v6, s[4:7], s20 offen offset:2048 sc1
    s_add_u32 s20, s20, 4096
    s_waitcnt lgkmcnt(12)
    v_mfma_f32_16x16x32_bf16 v[48:51], a[4:7], a[64:67], v[48:51]
    s_waitcnt lgkmcnt(12)
    v_mfma_f32_16x16x32_bf16 v[52:55], a[8:11], a[64:67], v[52:55]
    s_waitcnt lgkmcnt(12)
    v_mfma_f32_16x16x32_bf16 v[56:59], a[12:15], a[64:67], v[56:59]
    s_waitcnt vmcnt(7) lgkmcnt(12)
    v_mfma_f32_16x16x32_bf16 v[40:43], a[16:19], a[68:71], v[40:43]
    s_waitcnt lgkmcnt(12)
    v_mfma_f32_16x16x32_bf16 v[44:47], a[20:23], a[68:71], v[44:47]
    buffer_load_dwordx4 a[64:67], v6, s[4:7], s20 offen offset:0 sc1
    s_waitcnt lgkmcnt(12)
    v_mfma_f32_16x16x32_bf16 v[48:51], a[24:27], a[68:71], v[48:51]
    s_waitcnt lgkmcnt(12)
    v_mfma_f32_16x16x32_bf16 v[52:55], a[28:31], a[68:71], v[52:55]
    s_waitcnt lgkmcnt(11)
    v_mfma_f32_16x16x32_bf16 v[56:59], a[32:35], a[68:71], v[56:59]
    s_waitcnt vmcnt(7) lgkmcnt(10)
    v_mfma_f32_16x16x32_bf16 v[40:43], a[76:79], a[72:75], v[40:43]
    s_waitcnt lgkmcnt(9)
    v_mfma_f32_16x16x32_bf16 v[44:47], a[80:83], a[72:75], v[44:47]
    buffer_load_dwordx4 a[68:71], v6, s[4:7], s20 offen offset:2048 sc1
    s_add_u32 s20, s20, 4096
    s_waitcnt lgkmcnt(8)
    v_mfma_f32_16x16x32_bf16 v[48:51], a[84:87], a[72:75], v[48:51]
    s_waitcnt lgkmcnt(7)
    v_mfma_f32_16x16x32_bf16 v[52:55], a[88:91], a[72:75], v[52:55]
    ds_read_b128 v[88:91], v4 offset:57344
    s_waitcnt lgkmcnt(7)
    v_mfma_f32_16x16x32_bf16 v[56:59], a[92:95], a[72:75], v[56:59]
    ds_read_b128 v[92:95], v4 offset:58368
    s_waitcnt vmcnt(7) lgkmcnt(7)
    v_mfma_f32_16x16x32_bf16 v[40:43], v[64:67], a[40:43], v[40:43]
    ds_read_b128 v[96:99], v4 offset:59392
    s_waitcnt lgkmcnt(7)
    v_mfma_f32_16x16x32_bf16 v[44:47], v[68:71], a[40:43], v[44:47]
    ds_read_b128 v[100:103], v4 offset:60416
    buffer_load_dwordx4 a[72:75], v6, s[4:7], s20 offen offset:0 sc1
    s_waitcnt lgkmcnt(7)
    v_mfma_f32_16x16x32_bf16 v[48:51], v[72:75], a[40:43], v[48:51]
    ds_read_b128 v[104:107], v4 offset:61440
    s_waitcnt lgkmcnt(7)
    v_mfma_f32_16x16x32_bf16 v[52:55], v[76:79], a[40:43], v[52:55]
    ds_read_b128 v[108:111], v4 offset:62464
    s_waitcnt lgkmcnt(7)
    v_mfma_f32_16x16x32_bf16 v[56:59], v[80:83], a[40:43], v[56:59]
    ds_read_b128 v[112:115], v4 offset:63488
    s_waitcnt vmcnt(7) lgkmcnt(7)
    v_mfma_f32_16x16x32_bf16 v[40:43], v[84:87], a[44:47], v[40:43]
    ds_read_b128 v[116:119], v4 offset:64512
    s_waitcnt lgkmcnt(7)
    v_mfma_f32_16x16x32_bf16 v[44:47], v[88:91], a[44:47], v[44:47]
    ds_read_b128 v[120:123], v5 offset:0
    buffer_load_dwordx4 a[40:43], v6, s[4:7], s20 offen offset:2048 sc1
    s_add_u32 s20, s20, 4096
    s_waitcnt lgkmcnt(7)
    v_mfma_f32_16x16x32_bf16 v[48:51], v[92:95], a[44:47], v[48:51]
    ds_read_b128 v[124:127], v5 offset:1024
    s_waitcnt lgkmcnt(7)
    v_mfma_f32_16x16x32_bf16 v[52:55], v[96:99], a[44:47], v[52:55]
    ds_read_b128 v[128:131], v5 offset:2048
    s_waitcnt lgkmcnt(7)
    v_mfma_f32_16x16x32_bf16 v[56:59], v[100:103], a[44:47], v[56:59]
    ds_read_b128 v[132:135], v5 offset:3072
    s_waitcnt vmcnt(7) lgkmcnt(7)
    v_mfma_f32_16x16x32_bf16 v[40:43], v[104:107], a[48:51], v[40:43]
    ds_read_b128 v[136:139], v5 offset:4096
    s_waitcnt lgkmcnt(7)
    v_mfma_f32_16x16x32_bf16 v[44:47], v[108:111], a[48:51], v[44:47]
    ds_read_b128 v[140:143], v5 offset:5120
    buffer_load_dwordx4 a[44:47], v6, s[4:7], s20 offen offset:0 sc1
    s_waitcnt lgkmcnt(7)
    v_mfma_f32_16x16x32_bf16 v[48:51], v[112:115], a[48:51], v[48:51]
    ds_read_b128 v[144:147], v5 offset:6144
    s_waitcnt lgkmcnt(7)
    v_mfma_f32_16x16x32_bf16 v[52:55], v[116:119], a[48:51], v[52:55]
    ds_read_b128 v[148:151], v5 offset:7168
    s_waitcnt lgkmcnt(7)
    v_mfma_f32_16x16x32_bf16 v[56:59], v[120:123], a[48:51], v[56:59]
    ds_read_b128 v[152:155], v5 offset:8192
    s_waitcnt vmcnt(7) lgkmcnt(7)
    v_mfma_f32_16x16x32_bf16 v[40:43], v[124:127], a[52:55], v[40:43]
    ds_read_b128 v[156:159], v5 offset:9216
    s_waitcnt lgkmcnt(7)
    v_mfma_f32_16x16x32_bf16 v[44:47], v[128:131], a[52:55], v[44:47]
    ds_read_b128 a[0:3], v5 offset:10240
    buffer_load_dwordx4 a[48:51], v6, s[4:7], s20 offen offset:2048 sc1
    s_add_u32 s20, s20, 4096
    s_waitcnt lgkmcnt(7)
    v_mfma_f32_16x16x32_bf16 v[48:51], v[132:135], a[52:55], v[48:51]
    ds_read_b128 a[4:7], v5 offset:11264
    s_waitcnt lgkmcnt(7)
    v_mfma_f32_16x16x32_bf16 v[52:55], v[136:139], a[52:55], v[52:55]
    ds_read_b128 a[8:11], v5 offset:12288
    s_waitcnt lgkmcnt(7)
    v_mfma_f32_16x16x32_bf16 v[56:59], v[140:143], a[52:55], v[56:59]
    ds_read_b128 a[12:15], v5 offset:13312
    s_waitcnt vmcnt(7) lgkmcnt(7)
    v_mfma_f32_16x16x32_bf16 v[40:43], v[144:147], a[56:59], v[40:43]
    ds_read_b128 a[16:19], v5 offset:14336
    s_waitcnt lgkmcnt(7)
    v_mfma_f32_16x16x32_bf16 v[44:47], v[148:151], a[56:59], v[44:47]
    ds_read_b128 a[20:23], v5 offset:15360
    s_waitcnt lgkmcnt(7)
    v_mfma_f32_16x16x32_bf16 v[48:51], v[152:155], a[56:59], v[48:51]
    ds_read_b128 a[24:27], v3 offset:0
    s_waitcnt lgkmcnt(7)
    v_mfma_f32_16x16x32_bf16 v[52:55], v[156:159], a[56:59], v[52:55]
    ds_read_b128 a[28:31], v3 offset:1024
    s_waitcnt lgkmcnt(7)
    v_mfma_f32_16x16x32_bf16 v[56:59], a[0:3], a[56:59], v[56:59]
    ds_read_b128 a[32:35], v3 offset:2048
    s_waitcnt vmcnt(6) lgkmcnt(7)
    v_mfma_f32_16x16x32_bf16 v[40:43], a[4:7], a[60:63], v[40:43]
    ds_read_b128 a[76:79], v3 offset:3072
    s_waitcnt lgkmcnt(7)
    v_mfma_f32_16x16x32_bf16 v[44:47], a[8:11], a[60:63], v[44:47]
    ds_read_b128 a[80:83], v3 offset:4096
    s_waitcnt lgkmcnt(7)
    v_mfma_f32_16x16x32_bf16 v[48:51], a[12:15], a[60:63], v[48:51]
    ds_read_b128 a[84:87], v3 offset:5120
    s_waitcnt lgkmcnt(7)
    v_mfma_f32_16x16x32_bf16 v[52:55], a[16:19], a[60:63], v[52:55]
    ds_read_b128 a[88:91], v3 offset:6144
    s_waitcnt lgkmcnt(7)
    v_mfma_f32_16x16x32_bf16 v[56:59], a[20:23], a[60:63], v[56:59]
    ds_read_b128 a[92:95], v3 offset:7168
    s_waitcnt vmcnt(5) lgkmcnt(7)
    v_mfma_f32_16x16x32_bf16 v[40:43], a[24:27], a[64:67], v[40:43]
    ds_read_b128 v[64:67], v3 offset:8192
    s_waitcnt lgkmcnt(7)
    v_mfma_f32_16x16x32_bf16 v[44:47], a[28:31], a[64:67], v[44:47]
    ds_read_b128 v[68:71], v3 offset:9216
    s_waitcnt lgkmcnt(7)
    v_mfma_f32_16x16x32_bf16 v[48:51], a[32:35], a[64:67], v[48:51]
    ds_read_b128 v[72:75], v3 offset:10240
    s_waitcnt lgkmcnt(7)
    v_mfma_f32_16x16x32_bf16 v[52:55], a[76:79], a[64:67], v[52:55]
    ds_read_b128 v[76:79], v3 offset:11264
    s_waitcnt lgkmcnt(7)
    v_mfma_f32_16x16x32_bf16 v[56:59], a[80:83], a[64:67], v[56:59]
    ds_read_b128 v[80:83], v3 offset:12288
    s_waitcnt vmcnt(4) lgkmcnt(7)
    v_mfma_f32_16x16x32_bf16 v[40:43], a[84:87], a[68:71], v[40:43]
    ds_read_b128 v[84:87], v3 offset:13312
    s_waitcnt lgkmcnt(7)
    v_mfma_f32_16x16x32_bf16 v[44:47], a[88:91], a[68:71], v[44:47]
    ds_read_b128 v[88:91], v3 offset:14336
    s_waitcnt lgkmcnt(7)
    v_mfma_f32_16x16x32_bf16 v[48:51], a[92:95], a[68:71], v[48:51]
    ds_read_b128 v[92:95], v3 offset:15360
    s_waitcnt lgkmcnt(7)
    v_mfma_f32_16x16x32_bf16 v[52:55], v[64:67], a[68:71], v[52:55]
    ds_read_b128 v[96:99], v3 offset:16384
    s_waitcnt lgkmcnt(7)
    v_mfma_f32_16x16x32_bf16 v[56:59], v[68:71], a[68:71], v[56:59]
    ds_read_b128 v[100:103], v3 offset:17408
    s_waitcnt vmcnt(3) lgkmcnt(7)
    v_mfma_f32_16x16x32_bf16 v[40:43], v[72:75], a[72:75], v[40:43]
    ds_read_b128 v[104:107], v3 offset:18432
    s_waitcnt lgkmcnt(7)
    v_mfma_f32_16x16x32_bf16 v[44:47], v[76:79], a[72:75], v[44:47]
    ds_read_b128 v[108:111], v3 offset:19456
    s_waitcnt lgkmcnt(7)
    v_mfma_f32_16x16x32_bf16 v[48:51], v[80:83], a[72:75], v[48:51]
    ds_read_b128 v[112:115], v3 offset:20480
    s_waitcnt lgkmcnt(7)
    v_mfma_f32_16x16x32_bf16 v[52:55], v[84:87], a[72:75], v[52:55]
    ds_read_b128 v[116:119], v3 offset:21504
    s_waitcnt lgkmcnt(7)
    v_mfma_f32_16x16x32_bf16 v[56:59], v[88:91], a[72:75], v[56:59]
    ds_read_b128 v[120:123], v3 offset:22528
    s_waitcnt vmcnt(2) lgkmcnt(7)
    v_mfma_f32_16x16x32_bf16 v[40:43], v[92:95], a[40:43], v[40:43]
    ds_read_b128 v[124:127], v3 offset:23552
    s_waitcnt lgkmcnt(7)
    v_mfma_f32_16x16x32_bf16 v[44:47], v[96:99], a[40:43], v[44:47]
    ds_read_b128 v[128:131], v5 offset:18432
    s_waitcnt lgkmcnt(7)
    v_mfma_f32_16x16x32_bf16 v[48:51], v[100:103], a[40:43], v[48:51]
    ds_read_b128 v[132:135], v5 offset:19456
    s_waitcnt lgkmcnt(7)
    v_mfma_f32_16x16x32_bf16 v[52:55], v[104:107], a[40:43], v[52:55]
    ds_read_b128 v[136:139], v5 offset:20480
    s_waitcnt lgkmcnt(7)
    v_mfma_f32_16x16x32_bf16 v[56:59], v[108:111], a[40:43], v[56:59]
    ds_read_b128 v[140:143], v5 offset:21504
    s_waitcnt vmcnt(1) lgkmcnt(7)
    v_mfma_f32_16x16x32_bf16 v[40:43], v[112:115], a[44:47], v[40:43]
    ds_read_b128 v[144:147], v5 offset:22528
    s_waitcnt lgkmcnt(7)
    v_mfma_f32_16x16x32_bf16 v[44:47], v[116:119], a[44:47], v[44:47]
    ds_read_b128 v[148:151], v5 offset:23552
    s_waitcnt lgkmcnt(7)
    v_mfma_f32_16x16x32_bf16 v[48:51], v[120:123], a[44:47], v[48:51]
    s_waitcnt lgkmcnt(6)
    v_mfma_f32_16x16x32_bf16 v[52:55], v[124:127], a[44:47], v[52:55]
    s_waitcnt lgkmcnt(5)
    v_mfma_f32_16x16x32_bf16 v[56:59], v[128:131], a[44:47], v[56:59]
    s_waitcnt vmcnt(0) lgkmcnt(4)
    v_mfma_f32_16x16x32_bf16 v[40:43], v[132:135], a[48:51], v[40:43]
    s_waitcnt lgkmcnt(3)
    v_mfma_f32_16x16x32_bf16 v[44:47], v[136:139], a[48:51], v[44:47]
    s_waitcnt lgkmcnt(2)
    v_mfma_f32_16x16x32_bf16 v[48:51], v[140:143], a[48:51], v[48:51]
    s_waitcnt lgkmcnt(1)
    v_mfma_f32_16x16x32_bf16 v[52:55], v[144:147], a[48:51], v[52:55]
    s_waitcnt lgkmcnt(0)
    v_mfma_f32_16x16x32_bf16 v[56:59], v[148:151], a[48:51], v[56:59]
    s_mul_i32 s50, s23, 5120
    v_add_u32 v36, s50, v3
    v_add_u32 v37, 0x10000, v36
    s_barrier
    ds_read_b128 v[64:67], v37 offset:8192
    ds_read_b128 v[68:71], v37 offset:9216
    ds_read_b128 v[72:75], v37 offset:10240
    ds_read_b128 v[76:79], v37 offset:11264
    ds_read_b128 v[80:83], v37 offset:12288
    ds_read_b128 v[84:87], v36 offset:24576
    ds_read_b128 v[88:91], v36 offset:25600
    ds_read_b128 v[92:95], v36 offset:26624
    ds_read_b128 v[96:99], v36 offset:27648
    ds_read_b128 v[100:103], v36 offset:28672
    ds_read_b128 v[104:107], v37 offset:32768
    ds_read_b128 v[108:111], v37 offset:33792
    ds_read_b128 v[112:115], v37 offset:34816
    ds_read_b128 v[116:119], v37 offset:35840
    ds_read_b128 v[120:123], v37 offset:36864
    s_waitcnt lgkmcnt(10)
    v_pk_add_f32 v[40:41], v[40:41], v[64:65]
    v_pk_add_f32 v[42:43], v[42:43], v[66:67]
    v_pk_add_f32 v[44:45], v[44:45], v[68:69]
    v_pk_add_f32 v[46:47], v[46:47], v[70:71]
    v_pk_add_f32 v[48:49], v[48:49], v[72:73]
    v_pk_add_f32 v[50:51], v[50:51], v[74:75]
    v_pk_add_f32 v[52:53], v[52:53], v[76:77]
    v_pk_add_f32 v[54:55], v[54:55], v[78:79]
    v_pk_add_f32 v[56:57], v[56:57], v[80:81]
    v_pk_add_f32 v[58:59], v[58:59], v[82:83]
    ds_read_b128 v[124:127], v36 offset:49152
    ds_read_b128 v[128:131], v36 offset:50176
    ds_read_b128 v[132:135], v36 offset:51200
    ds_read_b128 v[136:139], v36 offset:52224
    ds_read_b128 v[140:143], v36 offset:53248
    s_waitcnt lgkmcnt(10)
    v_pk_add_f32 v[40:41], v[40:41], v[84:85]
    v_pk_add_f32 v[42:43], v[42:43], v[86:87]
    v_pk_add_f32 v[44:45], v[44:45], v[88:89]
    v_pk_add_f32 v[46:47], v[46:47], v[90:91]
    v_pk_add_f32 v[48:49], v[48:49], v[92:93]
    v_pk_add_f32 v[50:51], v[50:51], v[94:95]
    v_pk_add_f32 v[52:53], v[52:53], v[96:97]
    v_pk_add_f32 v[54:55], v[54:55], v[98:99]
    v_pk_add_f32 v[56:57], v[56:57], v[100:101]
    v_pk_add_f32 v[58:59], v[58:59], v[102:103]
    s_waitcnt lgkmcnt(5)
    v_pk_add_f32 v[40:41], v[40:41], v[104:105]
    v_pk_add_f32 v[42:43], v[42:43], v[106:107]
    v_pk_add_f32 v[44:45], v[44:45], v[108:109]
    v_pk_add_f32 v[46:47], v[46:47], v[110:111]
    v_pk_add_f32 v[48:49], v[48:49], v[112:113]
    v_pk_add_f32 v[50:51], v[50:51], v[114:115]
    v_pk_add_f32 v[52:53], v[52:53], v[116:117]
    v_pk_add_f32 v[54:55], v[54:55], v[118:119]
    v_pk_add_f32 v[56:57], v[56:57], v[120:121]
    v_pk_add_f32 v[58:59], v[58:59], v[122:123]
    s_waitcnt lgkmcnt(0)
    v_pk_add_f32 v[40:41], v[40:41], v[124:125]
    v_pk_add_f32 v[42:43], v[42:43], v[126:127]
    v_pk_add_f32 v[44:45], v[44:45], v[128:129]
    v_pk_add_f32 v[46:47], v[46:47], v[130:131]
    v_pk_add_f32 v[48:49], v[48:49], v[132:133]
    v_pk_add_f32 v[50:51], v[50:51], v[134:135]
    v_pk_add_f32 v[52:53], v[52:53], v[136:137]
    v_pk_add_f32 v[54:55], v[54:55], v[138:139]
    v_pk_add_f32 v[56:57], v[56:57], v[140:141]
    v_pk_add_f32 v[58:59], v[58:59], v[142:143]
    s_nop 0
    s_nop 4
    v_lshlrev_b32 v26, 16, v16
    v_and_b32 v27, 0xffff0000, v16
    v_lshlrev_b32 v28, 16, v17
    v_and_b32 v29, 0xffff0000, v17
    v_pk_add_f32 v[40:41], v[40:41], v[26:27]
    v_pk_add_f32 v[42:43], v[42:43], v[28:29]
    v_cvt_pk_bf16_f32 v16, v40, v41
    v_cvt_pk_bf16_f32 v17, v42, v43
    v_lshlrev_b32 v26, 16, v18
    v_and_b32 v27, 0xffff0000, v18
    v_lshlrev_b32 v28, 16, v19
    v_and_b32 v29, 0xffff0000, v19
    v_pk_add_f32 v[44:45], v[44:45], v[26:27]
    v_pk_add_f32 v[46:47], v[46:47], v[28:29]
    v_cvt_pk_bf16_f32 v18, v44, v45
    v_cvt_pk_bf16_f32 v19, v46, v47
    v_lshlrev_b32 v26, 16, v20
    v_and_b32 v27, 0xffff0000, v20
    v_lshlrev_b32 v28, 16, v21
    v_and_b32 v29, 0xffff0000, v21
    v_pk_add_f32 v[48:49], v[48:49], v[26:27]
    v_pk_add_f32 v[50:51], v[50:51], v[28:29]
    v_cvt_pk_bf16_f32 v20, v48, v49
    v_cvt_pk_bf16_f32 v21, v50, v51
    v_lshlrev_b32 v26, 16, v22
    v_and_b32 v27, 0xffff0000, v22
    v_lshlrev_b32 v28, 16, v23
    v_and_b32 v29, 0xffff0000, v23
    v_pk_add_f32 v[52:53], v[52:53], v[26:27]
    v_pk_add_f32 v[54:55], v[54:55], v[28:29]
    v_cvt_pk_bf16_f32 v22, v52, v53
    v_cvt_pk_bf16_f32 v23, v54, v55
    v_lshlrev_b32 v26, 16, v24
    v_and_b32 v27, 0xffff0000, v24
    v_lshlrev_b32 v28, 16, v25
    v_and_b32 v29, 0xffff0000, v25
    v_pk_add_f32 v[56:57], v[56:57], v[26:27]
    v_pk_add_f32 v[58:59], v[58:59], v[28:29]
    v_cvt_pk_bf16_f32 v24, v56, v57
    v_cvt_pk_bf16_f32 v25, v58, v59
    v_mov_b32 v30, v24
    v_mov_b32 v31, v25
    v_mov_b32 v32, v24
    v_mov_b32 v33, v25
    s_nop 1
    v_permlane16_swap_b32 v30, v32
    v_permlane16_swap_b32 v31, v33
    s_cmp_lg_u32 s19, 0
    s_cbranch_scc1 L_mega_kernel_final_55
    buffer_store_dwordx4 v[16:19], v6, s[4:7], s26 offen sc1
    buffer_store_dwordx4 v[20:23], v6, s[4:7], s26 offen offset:2048 sc1
    s_mov_b64 exec, s[36:37]
    buffer_store_dwordx4 v[30:33], v14, s[4:7], s27 offen sc1
    s_mov_b64 exec, -1
    s_mov_b32 s50, 0x3f803f80
    v_mov_b32 v26, 0
    v_mov_b32 v27, 0
    v_dot2c_f32_bf16 v26, s50, v16
    v_dot2c_f32_bf16 v27, v16, v16
    v_dot2c_f32_bf16 v26, s50, v17
    v_dot2c_f32_bf16 v27, v17, v17
    v_dot2c_f32_bf16 v26, s50, v18
    v_dot2c_f32_bf16 v27, v18, v18
    v_dot2c_f32_bf16 v26, s50, v19
    v_dot2c_f32_bf16 v27, v19, v19
    v_dot2c_f32_bf16 v26, s50, v20
    v_dot2c_f32_bf16 v27, v20, v20
    v_dot2c_f32_bf16 v26, s50, v21
    v_dot2c_f32_bf16 v27, v21, v21
    v_dot2c_f32_bf16 v26, s50, v22
    v_dot2c_f32_bf16 v27, v22, v22
    v_dot2c_f32_bf16 v26, s50, v23
    v_dot2c_f32_bf16 v27, v23, v23
    v_dot2c_f32_bf16 v26, s50, v24
    v_dot2c_f32_bf16 v27, v24, v24
    v_dot2c_f32_bf16 v26, s50, v25
    v_dot2c_f32_bf16 v27, v25, v25
    v_lshlrev_b32 v10, 3, v7
    s_nop 1
    v_mov_b32 v28, v26
    v_mov_b32 v29, v27
    s_nop 1
    v_permlane32_swap_b32 v28, v26
    v_permlane32_swap_b32 v29, v27
    s_nop 0
    v_add_f32 v26, v26, v28
    v_add_f32 v27, v27, v29
    v_mov_b32 v28, v26
    v_mov_b32 v29, v27
    s_nop 1
    v_permlane16_swap_b32 v28, v26
    v_permlane16_swap_b32 v29, v27
    s_nop 0
    v_add_f32 v26, v26, v28
    v_add_f32 v27, v27, v29
    s_mov_b64 exec, 0xffff
    buffer_store_dwordx2 v[26:27], v10, s[4:7], s28 offen sc1
    s_mov_b64 exec, -1
    s_mov_b32 s45, s22
    s_waitcnt vmcnt(0)
    s_barrier
    s_add_u32 s18, s18, 24117248
    s_add_u32 s19, s19, 1
L_mega_kernel_Cq_5:
    s_lshl_b32 s24, s12, 2
    s_add_u32 s24, s24, s23
    s_mul_i32 s20, s24, 40960
    s_add_u32 s20, s20, s18
    s_add_u32 s20, s20, 0
    v_lshlrev_b32 v13, 4, v8
    v_add_u32 v13, 147456, v13
    s_lshl_b32 s26, s13, 7
    s_add_u32 s26, s26, s24
    s_lshl_b32 s28, s26, 10
    s_add_u32 s28, s28, 2752512
    s_mul_i32 s26, s26, 3072
    s_add_u32 s29, s26, 4848640
    v_mov_b32 v14, s29
    v_mov_b32 v15, s28
    v_cndmask_b32 v14, v14, v15, s[32:33]
    v_add_u32 v14, v14, v6
    v_mov_b32 v15, 196608
    v_mov_b32 v10, 65536
    v_cndmask_b32 v15, v15, v10, s[32:33]
    v_add_u32 v15, v15, v14
    s_add_u32 s26, s26, s18
    s_add_u32 s26, s26, 4850688
    s_add_u32 s27, s26, 196608
    v_mov_b32 v12, 0x3f80
    v_add_u32 v36, s31, v3
    v_add_u32 v37, s31, v4
    v_add_u32 v38, s31, v5
    s_cmp_lg_u32 s45, 0
    s_cbranch_scc1 L_mega_kernel_polls_72
    s_lshl_b32 s53, s12, 4
    s_add_u32 s53, s53, s13
    s_lshl_b32 s50, s53, 7
    s_add_u32 s50, s50, s18
    s_add_u32 s50, s50, 23855104
    s_add_u32 s53, s3, 16
    s_mov_b32 s52, 0x400000
L_mega_kernel_sp_73:
    s_buffer_load_dword s51, s[4:7], s50 glc
    s_sub_u32 s52, s52, 1
    s_waitcnt lgkmcnt(0)
    s_cmp_lg_u32 s51, s53
    s_cbranch_scc0 L_mega_kernel_po_75
    s_and_b32 s51, s52, 31
    s_cbranch_scc1 L_mega_kernel_sp_73
    buffer_load_dword v9, off, s[4:7], s50 sc1
    s_cmp_eq_u32 s52, 0
    s_cbranch_scc1 L_mega_kernel_po_75
    s_waitcnt vmcnt(0)
    v_readfirstlane_b32 s51, v9
    s_cmp_lg_u32 s51, s53
    s_cbranch_scc1 L_mega_kernel_sp_73
L_mega_kernel_po_75:
L_mega_kernel_polls_72:
    s_barrier
    buffer_load_dwordx4 a[40:43], v6, s[4:7], s20 offen offset:0 sc1
    buffer_load_dwordx4 a[44:47], v6, s[4:7], s20 offen offset:256 sc1
    buffer_load_dwordx4 a[48:51], v6, s[4:7], s20 offen offset:2048 sc1
    buffer_load_dwordx4 a[52:55], v6, s[4:7], s20 offen offset:2304 sc1
    s_add_u32 s20, s20, 4096
    s_lshl_b32 s21, s24, 8
    s_add_u32 s21, s21, s18
    s_add_u32 s21, s21, 2621440
    s_add_u32 s25, s21, 16384
    v_lshlrev_b32 v10, 15, v8
    v_lshl_add_u32 v10, v7, 3, v10
    buffer_load_dwordx2 v[136:137], v10, s[4:7], s21 offen offset:0 sc1
    buffer_load_dwordx2 v[138:139], v10, s[4:7], s25 offen offset:0 sc1
    buffer_load_dwordx2 v[140:141], v10, s[4:7], s21 offen offset:128 sc1
    buffer_load_dwordx2 v[142:143], v10, s[4:7], s25 offen offset:128 sc1
    buffer_load_dwordx4 a[56:59], v6, s[4:7], s20 offen offset:0 sc1
    buffer_load_dwordx4 a[60:63], v6, s[4:7], s20 offen offset:256 sc1
    buffer_load_dwordx4 a[64:67], v6, s[4:7], s20 offen offset:2048 sc1
    buffer_load_dwordx4 a[68:71], v6, s[4:7], s20 offen offset:2304 sc1
    s_add_u32 s20, s20, 4096
    buffer_load_dwordx4 a[72:75], v6, s[4:7], s20 offen offset:0 sc1
    buffer_load_dwordx4 a[76:79], v6, s[4:7], s20 offen offset:256 sc1
    buffer_load_dwordx4 a[80:83], v6, s[4:7], s20 offen offset:2048 sc1
    buffer_load_dwordx4 a[84:87], v6, s[4:7], s20 offen offset:2304 sc1
    s_add_u32 s20, s20, 4096
    s_barrier
    ds_read_b128 a[0:3], v4 offset:57344
    ds_read_b128 a[4:7], v4 offset:58368
    ds_read_b128 a[8:11], v4 offset:59392
    ds_read_b128 a[12:15], v4 offset:60416
    ds_read_b128 a[16:19], v4 offset:61440
    ds_read_b128 a[20:23], v4 offset:62464
    ds_read_b128 a[24:27], v4 offset:63488
    ds_read_b128 a[28:31], v4 offset:64512
    s_waitcnt vmcnt(14) lgkmcnt(7)
    v_mfma_f32_16x16x32_bf16 v[40:43], a[0:3], a[40:43], 0
    ds_read_b128 a[32:35], v5 offset:0
    v_mfma_f32_16x16x32_bf16 v[72:75], a[0:3], a[44:47], 0
    s_waitcnt lgkmcnt(7)
    v_mfma_f32_16x16x32_bf16 v[44:47], a[4:7], a[40:43], 0
    ds_read_b128 a[0:3], v5 offset:1024
    v_mfma_f32_16x16x32_bf16 v[76:79], a[4:7], a[44:47], 0
    s_waitcnt lgkmcnt(7)
    v_mfma_f32_16x16x32_bf16 v[48:51], a[8:11], a[40:43], 0
    ds_read_b128 a[4:7], v5 offset:2048
    v_mfma_f32_16x16x32_bf16 v[80:83], a[8:11], a[44:47], 0
    s_waitcnt lgkmcnt(7)
    v_mfma_f32_16x16x32_bf16 v[52:55], a[12:15], a[40:43], 0
    ds_read_b128 a[8:11], v5 offset:3072
    v_mfma_f32_16x16x32_bf16 v[84:87], a[12:15], a[44:47], 0
    s_waitcnt lgkmcnt(7)
    v_mfma_f32_16x16x32_bf16 v[56:59], a[16:19], a[40:43], 0
    ds_read_b128 a[12:15], v5 offset:4096
    v_mfma_f32_16x16x32_bf16 v[88:91], a[16:19], a[44:47], 0
    s_waitcnt lgkmcnt(7)
    v_mfma_f32_16x16x32_bf16 v[60:63], a[20:23], a[40:43], 0
    ds_read_b128 a[16:19], v5 offset:5120
    v_mfma_f32_16x16x32_bf16 v[92:95], a[20:23], a[44:47], 0
    s_waitcnt lgkmcnt(7)
    v_mfma_f32_16x16x32_bf16 v[64:67], a[24:27], a[40:43], 0
    ds_read_b128 a[20:23], v5 offset:6144
    v_mfma_f32_16x16x32_bf16 v[96:99], a[24:27], a[44:47], 0
    s_waitcnt lgkmcnt(7)
    v_mfma_f32_16x16x32_bf16 v[68:71], a[28:31], a[40:43], 0
    ds_read_b128 a[24:27], v5 offset:7168
    v_mfma_f32_16x16x32_bf16 v[100:103], a[28:31], a[44:47], 0
    s_waitcnt vmcnt(12) lgkmcnt(7)
    v_mfma_f32_16x16x32_bf16 v[40:43], a[32:35], a[48:51], v[40:43]
    ds_read_b128 a[28:31], v5 offset:8192
    v_mfma_f32_16x16x32_bf16 v[72:75], a[32:35], a[52:55], v[72:75]
    s_waitcnt lgkmcnt(7)
    v_mfma_f32_16x16x32_bf16 v[44:47], a[0:3], a[48:51], v[44:47]
    ds_read_b128 a[32:35], v5 offset:9216
    v_mfma_f32_16x16x32_bf16 v[76:79], a[0:3], a[52:55], v[76:79]
    s_waitcnt lgkmcnt(7)
    v_mfma_f32_16x16x32_bf16 v[48:51], a[4:7], a[48:51], v[48:51]
    ds_read_b128 a[0:3], v5 offset:10240
    v_mfma_f32_16x16x32_bf16 v[80:83], a[4:7], a[52:55], v[80:83]
    s_waitcnt lgkmcnt(7)
    v_mfma_f32_16x16x32_bf16 v[52:55], a[8:11], a[48:51], v[52:55]
    ds_read_b128 a[4:7], v5 offset:11264
    v_mfma_f32_16x16x32_bf16 v[84:87], a[8:11], a[52:55], v[84:87]
    s_waitcnt lgkmcnt(7)
    v_mfma_f32_16x16x32_bf16 v[56:59], a[12:15], a[48:51], v[56:59]
    ds_read_b128 a[8:11], v5 offset:12288
    v_mfma_f32_16x16x32_bf16 v[88:91], a[12:15], a[52:55], v[88:91]
    s_waitcnt lgkmcnt(7)
    v_mfma_f32_16x16x32_bf16 v[60:63], a[16:19], a[48:51], v[60:63]
    ds_read_b128 a[12:15], v5 offset:13312
    v_mfma_f32_16x16x32_bf16 v[92:95], a[16:19], a[52:55], v[92:95]
    s_waitcnt lgkmcnt(7)
    v_mfma_f32_16x16x32_bf16 v[64:67], a[20:23], a[48:51], v[64:67]
    ds_read_b128 a[16:19], v5 offset:14336
    v_mfma_f32_16x16x32_bf16 v[96:99], a[20:23], a[52:55], v[96:99]
    s_waitcnt lgkmcnt(7)
    v_mfma_f32_16x16x32_bf16 v[68:71], a[24:27], a[48:51], v[68:71]
    ds_read_b128 a[20:23], v5 offset:15360
    v_mfma_f32_16x16x32_bf16 v[100:103], a[24:27], a[52:55], v[100:103]
    s_waitcnt vmcnt(6) lgkmcnt(7)
    v_mfma_f32_16x16x32_bf16 v[40:43], a[28:31], a[56:59], v[40:43]
    ds_read_b128 a[24:27], v3 offset:0
    v_add_f32 v26, v136, v138
    v_mfma_f32_16x16x32_bf16 v[72:75], a[28:31], a[60:63], v[72:75]
    v_add_f32 v28, v137, v139
    s_waitcnt lgkmcnt(7)
    v_mfma_f32_16x16x32_bf16 v[44:47], a[32:35], a[56:59], v[44:47]
    ds_read_b128 a[28:31], v3 offset:1024
    v_add_f32 v27, v140, v142
    v_mfma_f32_16x16x32_bf16 v[76:79], a[32:35], a[60:63], v[76:79]
    v_add_f32 v29, v141, v143
    s_waitcnt lgkmcnt(7)
    v_mfma_f32_16x16x32_bf16 v[48:51], a[0:3], a[56:59], v[48:51]
    ds_read_b128 a[32:35], v3 offset:2048
    v_mov_b32 v136, v26
    v_mfma_f32_16x16x32_bf16 v[80:83], a[0:3], a[60:63], v[80:83]
    v_mov_b32 v137, v27
    s_waitcnt lgkmcnt(7)
    v_mfma_f32_16x16x32_bf16 v[52:55], a[4:7], a[56:59], v[52:55]
    ds_read_b128 a[0:3], v3 offset:3072
    v_mov_b32 v138, v28
    v_mfma_f32_16x16x32_bf16 v[84:87], a[4:7], a[60:63], v[84:87]
    v_mov_b32 v139, v29
    s_waitcnt lgkmcnt(7)
    v_mfma_f32_16x16x32_bf16 v[56:59], a[8:11], a[56:59], v[56:59]
    ds_read_b128 a[4:7], v3 offset:4096
    v_permlane32_swap_b32 v136, v26
    v_mfma_f32_16x16x32_bf16 v[88:91], a[8:11], a[60:63], v[88:91]
    v_permlane32_swap_b32 v137, v27
    s_waitcnt lgkmcnt(7)
    v_mfma_f32_16x16x32_bf16 v[60:63], a[12:15], a[56:59], v[60:63]
    ds_read_b128 a[8:11], v3 offset:5120
    v_permlane32_swap_b32 v138, v28
    v_mfma_f32_16x16x32_bf16 v[92:95], a[12:15], a[60:63], v[92:95]
    v_permlane32_swap_b32 v139, v29
    s_waitcnt lgkmcnt(7)
    v_mfma_f32_16x16x32_bf16 v[64:67], a[16:19], a[56:59], v[64:67]
    ds_read_b128 a[12:15], v3 offset:6144
    v_add_f32 v26, v26, v136
    v_mfma_f32_16x16x32_bf16 v[96:99], a[16:19], a[60:63], v[96:99]
    v_add_f32 v27, v27, v137
    s_waitcnt lgkmcnt(7)
    v_mfma_f32_16x16x32_bf16 v[68:71], a[20:23], a[56:59], v[68:71]
    ds_read_b128 a[16:19], v3 offset:7168
    v_add_f32 v28, v28, v138
    v_mfma_f32_16x16x32_bf16 v[100:103], a[20:23], a[60:63], v[100:103]
    v_add_f32 v29, v29, v139
    s_waitcnt vmcnt(4) lgkmcnt(7)
    v_mfma_f32_16x16x32_bf16 v[40:43], a[24:27], a[64:67], v[40:43]
    ds_read_b128 a[20:23], v3 offset:8192
    v_mov_b32 v136, v26
    v_mfma_f32_16x16x32_bf16 v[72:75], a[24:27], a[68:71], v[72:75]
    v_mov_b32 v137, v27
    s_waitcnt lgkmcnt(7)
    v_mfma_f32_16x16x32_bf16 v[44:47], a[28:31], a[64:67], v[44:47]
    ds_read_b128 a[24:27], v3 offset:9216
    v_mov_b32 v138, v28
    v_mfma_f32_16x16x32_bf16 v[76:79], a[28:31], a[68:71], v[76:79]
    v_mov_b32 v139, v29
    s_waitcnt lgkmcnt(7)
    v_mfma_f32_16x16x32_bf16 v[48:51], a[32:35], a[64:67], v[48:51]
    ds_read_b128 a[28:31], v3 offset:10240
    v_permlane16_swap_b32 v136, v26
    v_mfma_f32_16x16x32_bf16 v[80:83], a[32:35], a[68:71], v[80:83]
    v_permlane16_swap_b32 v137, v27
    s_waitcnt lgkmcnt(7)
    v_mfma_f32_16x16x32_bf16 v[52:55], a[0:3], a[64:67], v[52:55]
    ds_read_b128 a[32:35], v3 offset:11264
    v_permlane16_swap_b32 v138, v28
    v_mfma_f32_16x16x32_bf16 v[84:87], a[0:3], a[68:71], v[84:87]
    v_permlane16_swap_b32 v139, v29
    s_waitcnt lgkmcnt(7)
    v_mfma_f32_16x16x32_bf16 v[56:59], a[4:7], a[64:67], v[56:59]
    ds_read_b128 a[0:3], v3 offset:12288
    v_add_f32 v26, v26, v136
    v_add_f32 v27, v27, v137
    v_mfma_f32_16x16x32_bf16 v[88:91], a[4:7], a[68:71], v[88:91]
    ds_read_b128 v[104:107], v13 offset:256
    s_waitcnt lgkmcnt(8)
    v_mfma_f32_16x16x32_bf16 v[60:63], a[8:11], a[64:67], v[60:63]
    ds_read_b128 a[4:7], v3 offset:13312
    v_add_f32 v28, v28, v138
    v_mfma_f32_16x16x32_bf16 v[92:95], a[8:11], a[68:71], v[92:95]
    v_add_f32 v29, v29, v139
    s_waitcnt lgkmcnt(8)
    v_mfma_f32_16x16x32_bf16 v[64:67], a[12:15], a[64:67], v[64:67]
    ds_read_b128 a[8:11], v3 offset:14336
    v_mul_f32 v26, 0x3acccccd, v26
    v_mfma_f32_16x16x32_bf16 v[96:99], a[12:15], a[68:71], v[96:99]
    v_mul_f32 v27, 0x3acccccd, v27
    s_waitcnt lgkmcnt(8)
    v_mfma_f32_16x16x32_bf16 v[68:71], a[16:19], a[64:67], v[68:71]
    ds_read_b128 a[12:15], v3 offset:15360
    v_mul_f32 v28, 0x3acccccd, v28
    v_mfma_f32_16x16x32_bf16 v[100:103], a[16:19], a[68:71], v[100:103]
    v_mul_f32 v29, 0x3acccccd, v29
    s_waitcnt vmcnt(2) lgkmcnt(8)
    v_mfma_f32_16x16x32_bf16 v[40:43], a[20:23], a[72:75], v[40:43]
    ds_read_b128 a[16:19], v3 offset:16384
    v_fma_f32 v28, -v26, v26, v28
    v_max_f32 v28, 0, v28
    v_mfma_f32_16x16x32_bf16 v[72:75], a[20:23], a[76:79], v[72:75]
    ds_read_b128 v[108:111], v13 offset:0
    s_waitcnt lgkmcnt(9)
    v_mfma_f32_16x16x32_bf16 v[44:47], a[24:27], a[72:75], v[44:47]
    ds_read_b128 a[20:23], v3 offset:17408
    v_add_f32 v28, 0x3727c5ac, v28
    v_mfma_f32_16x16x32_bf16 v[76:79], a[24:27], a[76:79], v[76:79]
    v_fma_f32 v29, -v27, v27, v29
    s_waitcnt lgkmcnt(9)
    v_mfma_f32_16x16x32_bf16 v[48:51], a[28:31], a[72:75], v[48:51]
    ds_read_b128 a[24:27], v3 offset:18432
    v_max_f32 v29, 0, v29
    v_mfma_f32_16x16x32_bf16 v[80:83], a[28:31], a[76:79], v[80:83]
    v_add_f32 v29, 0x3727c5ac, v29
    s_waitcnt lgkmcnt(9)
    v_mfma_f32_16x16x32_bf16 v[52:55], a[32:35], a[72:75], v[52:55]
    ds_read_b128 a[28:31], v3 offset:19456
    v_rsq_f32 v31, v28
    v_mfma_f32_16x16x32_bf16 v[84:87], a[32:35], a[76:79], v[84:87]
    v_rsq_f32 v33, v29
    s_waitcnt lgkmcnt(9)
    v_mfma_f32_16x16x32_bf16 v[56:59], a[0:3], a[72:75], v[56:59]
    ds_read_b128 a[32:35], v3 offset:20480
    v_sub_f32 v26, 0, v26
    v_mfma_f32_16x16x32_bf16 v[88:91], a[0:3], a[76:79], v[88:91]
    v_sub_f32 v27, 0, v27
    s_waitcnt lgkmcnt(8)
    v_mfma_f32_16x16x32_bf16 v[60:63], a[4:7], a[72:75], v[60:63]
    ds_read_b128 a[0:3], v3 offset:21504
    v_mul_f32 v30, 0x3f1166db, v31
    v_mul_f32 v32, 0x3f1166db, v33
    v_mfma_f32_16x16x32_bf16 v[92:95], a[4:7], a[76:79], v[92:95]
    ds_read_b128 v[112:115], v13 offset:320
    s_waitcnt lgkmcnt(9)
    v_mfma_f32_16x16x32_bf16 v[64:67], a[8:11], a[72:75], v[64:67]
    ds_read_b128 a[4:7], v3 offset:22528
    v_cndmask_b32 v31, v31, v30, s[40:41]
    v_mfma_f32_16x16x32_bf16 v[96:99], a[8:11], a[76:79], v[96:99]
    v_cndmask_b32 v33, v33, v32, s[40:41]
    s_waitcnt lgkmcnt(9)
    v_mfma_f32_16x16x32_bf16 v[68:71], a[12:15], a[72:75], v[68:71]
    ds_read_b128 a[8:11], v3 offset:23552
    v_fmac_f32 v56, v104, v26
    v_mfma_f32_16x16x32_bf16 v[100:103], a[12:15], a[76:79], v[100:103]
    v_fmac_f32 v57, v105, v26
    s_waitcnt vmcnt(0) lgkmcnt(9)
    v_mfma_f32_16x16x32_bf16 v[40:43], a[16:19], a[80:83], v[40:43]
    s_barrier
    ds_read_b128 a[12:15], v4 offset:16384
    v_fmac_f32 v58, v106, v26
    v_mfma_f32_16x16x32_bf16 v[72:75], a[16:19], a[84:87], v[72:75]
    ds_read_b128 a[88:91], v37 offset:8192
    v_fmac_f32 v59, v107, v26
    s_waitcnt lgkmcnt(9)
    v_mfma_f32_16x16x32_bf16 v[44:47], a[20:23], a[80:83], v[44:47]
    ds_read_b128 a[16:19], v4 offset:17408
    v_fmac_f32 v88, v104, v27
    v_mfma_f32_16x16x32_bf16 v[76:79], a[20:23], a[84:87], v[76:79]
    ds_read_b128 a[92:95], v37 offset:12288
    v_fmac_f32 v89, v105, v27
    s_waitcnt lgkmcnt(10)
    v_mfma_f32_16x16x32_bf16 v[48:51], a[24:27], a[80:83], v[48:51]
    ds_read_b128 a[20:23], v4 offset:18432
    v_fmac_f32 v90, v106, v27
    v_mfma_f32_16x16x32_bf16 v[80:83], a[24:27], a[84:87], v[80:83]
    v_fmac_f32 v91, v107, v27
    s_waitcnt lgkmcnt(10)
    v_mfma_f32_16x16x32_bf16 v[52:55], a[28:31], a[80:83], v[52:55]
    ds_read_b128 a[24:27], v4 offset:19456
    v_fmac_f32 v40, v108, v26
    v_fmac_f32 v41, v109, v26
    v_mfma_f32_16x16x32_bf16 v[84:87], a[28:31], a[84:87], v[84:87]
    ds_read_b128 v[104:107], v13 offset:192
    s_waitcnt lgkmcnt(11)
    v_mfma_f32_16x16x32_bf16 v[56:59], a[32:35], a[80:83], v[56:59]
    ds_read_b128 a[28:31], v4 offset:20480
    v_fmac_f32 v42, v110, v26
    v_mfma_f32_16x16x32_bf16 v[88:91], a[32:35], a[84:87], v[88:91]
    v_fmac_f32 v43, v111, v26
    s_waitcnt lgkmcnt(11)
    v_mfma_f32_16x16x32_bf16 v[60:63], a[0:3], a[80:83], v[60:63]
    ds_read_b128 a[32:35], v4 offset:21504
    v_fmac_f32 v72, v108, v27
    v_mfma_f32_16x16x32_bf16 v[92:95], a[0:3], a[84:87], v[92:95]
    v_fmac_f32 v73, v109, v27
    s_waitcnt lgkmcnt(10)
    v_mfma_f32_16x16x32_bf16 v[64:67], a[4:7], a[80:83], v[64:67]
    ds_read_b128 a[0:3], v4 offset:22528
    v_fmac_f32 v74, v110, v27
    v_mfma_f32_16x16x32_bf16 v[96:99], a[4:7], a[84:87], v[96:99]
    v_fmac_f32 v75, v111, v27
    s_waitcnt lgkmcnt(10)
    v_mfma_f32_16x16x32_bf16 v[68:71], a[8:11], a[80:83], v[68:71]
    ds_read_b128 a[4:7], v4 offset:23552
    ds_read_b128 v[108:111], v13 offset:448
    v_mfma_f32_16x16x32_bf16 v[100:103], a[8:11], a[84:87], v[100:103]
    s_waitcnt lgkmcnt(8)
    v_mfma_f32_16x16x32_bf16 v[40:43], a[12:15], a[88:91], v[40:43]
    ds_read_b128 a[8:11], v3 offset:24576
    v_fmac_f32 v60, v112, v26
    v_mfma_f32_16x16x32_bf16 v[72:75], a[12:15], a[92:95], v[72:75]
    ds_read_b128 v[116:119], v37 offset:24576
    v_fmac_f32 v61, v113, v26
    s_waitcnt lgkmcnt(11)
    v_mfma_f32_16x16x32_bf16 v[44:47], a[16:19], a[88:91], v[44:47]
    ds_read_b128 a[12:15], v3 offset:25600
    v_fmac_f32 v62, v114, v26
    v_mfma_f32_16x16x32_bf16 v[76:79], a[16:19], a[92:95], v[76:79]
    ds_read_b128 v[120:123], v37 offset:28672
    v_fmac_f32 v63, v115, v26
    s_waitcnt lgkmcnt(11)
    v_mfma_f32_16x16x32_bf16 v[48:51], a[20:23], a[88:91], v[48:51]
    ds_read_b128 a[16:19], v3 offset:26624
    v_fmac_f32 v92, v112, v27
    v_mfma_f32_16x16x32_bf16 v[80:83], a[20:23], a[92:95], v[80:83]
    v_fmac_f32 v93, v113, v27
    s_waitcnt lgkmcnt(11)
    v_mfma_f32_16x16x32_bf16 v[52:55], a[24:27], a[88:91], v[52:55]
    ds_read_b128 a[20:23], v3 offset:27648
    v_fmac_f32 v94, v114, v27
    v_mfma_f32_16x16x32_bf16 v[84:87], a[24:27], a[92:95], v[84:87]
    v_fmac_f32 v95, v115, v27
    s_waitcnt lgkmcnt(10)
    v_mfma_f32_16x16x32_bf16 v[56:59], a[28:31], a[88:91], v[56:59]
    ds_read_b128 a[24:27], v3 offset:28672
    v_mfma_f32_16x16x32_bf16 v[88:91], a[28:31], a[92:95], v[88:91]
    s_waitcnt lgkmcnt(10)
    v_mfma_f32_16x16x32_bf16 v[60:63], a[32:35], a[88:91], v[60:63]
    ds_read_b128 a[28:31], v3 offset:29696
    v_mfma_f32_16x16x32_bf16 v[92:95], a[32:35], a[92:95], v[92:95]
    s_waitcnt lgkmcnt(10)
    v_mfma_f32_16x16x32_bf16 v[64:67], a[0:3], a[88:91], v[64:67]
    ds_read_b128 a[32:35], v3 offset:30720
    v_fmac_f32 v52, v104, v26
    v_fmac_f32 v53, v105, v26
    v_mfma_f32_16x16x32_bf16 v[96:99], a[0:3], a[92:95], v[96:99]
    ds_read_b128 v[112:115], v13 offset:384
    s_waitcnt lgkmcnt(11)
    v_mfma_f32_16x16x32_bf16 v[68:71], a[4:7], a[88:91], v[68:71]
    ds_read_b128 a[0:3], v3 offset:31744
    v_fmac_f32 v54, v106, v26
    v_mfma_f32_16x16x32_bf16 v[100:103], a[4:7], a[92:95], v[100:103]
    v_fmac_f32 v55, v107, v26
    s_waitcnt lgkmcnt(7)
    v_mfma_f32_16x16x32_bf16 v[40:43], a[8:11], v[116:119], v[40:43]
    s_barrier
    ds_read_b128 a[4:7], v3 offset:40960
    v_fmac_f32 v84, v104, v27
    v_mfma_f32_16x16x32_bf16 v[72:75], a[8:11], v[120:123], v[72:75]
    ds_read_b128 v[124:127], v36 offset:32768
    v_fmac_f32 v85, v105, v27
    s_waitcnt lgkmcnt(10)
    v_mfma_f32_16x16x32_bf16 v[44:47], a[12:15], v[116:119], v[44:47]
    ds_read_b128 a[8:11], v3 offset:41984
    v_fmac_f32 v86, v106, v27
    v_mfma_f32_16x16x32_bf16 v[76:79], a[12:15], v[120:123], v[76:79]
    ds_read_b128 v[128:131], v36 offset:36864
    v_fmac_f32 v87, v107, v27
    s_waitcnt lgkmcnt(10)
    v_mfma_f32_16x16x32_bf16 v[48:51], a[16:19], v[116:119], v[48:51]
    ds_read_b128 a[12:15], v3 offset:43008
    v_fmac_f32 v68, v108, v26
    v_fmac_f32 v69, v109, v26
    v_mfma_f32_16x16x32_bf16 v[80:83], a[16:19], v[120:123], v[80:83]
    ds_read_b128 v[104:107], v13 offset:128
    s_waitcnt lgkmcnt(11)
    v_mfma_f32_16x16x32_bf16 v[52:55], a[20:23], v[116:119], v[52:55]
    ds_read_b128 a[16:19], v3 offset:44032
    v_fmac_f32 v70, v110, v26
    v_mfma_f32_16x16x32_bf16 v[84:87], a[20:23], v[120:123], v[84:87]
    v_fmac_f32 v71, v111, v26
    s_waitcnt lgkmcnt(11)
    v_mfma_f32_16x16x32_bf16 v[56:59], a[24:27], v[116:119], v[56:59]
    ds_read_b128 a[20:23], v3 offset:45056
    v_fmac_f32 v100, v108, v27
    v_mfma_f32_16x16x32_bf16 v[88:91], a[24:27], v[120:123], v[88:91]
    v_fmac_f32 v101, v109, v27
    s_waitcnt lgkmcnt(11)
    v_mfma_f32_16x16x32_bf16 v[60:63], a[28:31], v[116:119], v[60:63]
    ds_read_b128 a[24:27], v3 offset:46080
    v_fmac_f32 v102, v110, v27
    v_mfma_f32_16x16x32_bf16 v[92:95], a[28:31], v[120:123], v[92:95]
    v_fmac_f32 v103, v111, v27
    s_waitcnt lgkmcnt(11)
    v_mfma_f32_16x16x32_bf16 v[64:67], a[32:35], v[116:119], v[64:67]
    ds_read_b128 a[28:31], v3 offset:47104
    v_mfma_f32_16x16x32_bf16 v[96:99], a[32:35], v[120:123], v[96:99]
    s_waitcnt lgkmcnt(10)
    v_mfma_f32_16x16x32_bf16 v[68:71], a[0:3], v[116:119], v[68:71]
    ds_read_b128 a[32:35], v3 offset:48128
    v_mfma_f32_16x16x32_bf16 v[100:103], a[0:3], v[120:123], v[100:103]
    s_waitcnt lgkmcnt(7)
    v_mfma_f32_16x16x32_bf16 v[40:43], a[4:7], v[124:127], v[40:43]
    ds_read_b128 a[0:3], v4 offset:40960
    v_mfma_f32_16x16x32_bf16 v[72:75], a[4:7], v[128:131], v[72:75]
    ds_read_b128 v[144:147], v37 offset:32768
    s_waitcnt lgkmcnt(10)
    v_mfma_f32_16x16x32_bf16 v[44:47], a[8:11], v[124:127], v[44:47]
    ds_read_b128 a[4:7], v4 offset:41984
    v_fmac_f32 v64, v112, v26
    v_fmac_f32 v65, v113, v26
    v_mfma_f32_16x16x32_bf16 v[76:79], a[8:11], v[128:131], v[76:79]
    ds_read_b128 v[148:151], v37 offset:36864
    ds_read_b128 v[108:111], v13 offset:64
    s_waitcnt lgkmcnt(11)
    v_mfma_f32_16x16x32_bf16 v[48:51], a[12:15], v[124:127], v[48:51]
    ds_read_b128 a[8:11], v4 offset:43008
    v_fmac_f32 v66, v114, v26
    v_mfma_f32_16x16x32_bf16 v[80:83], a[12:15], v[128:131], v[80:83]
    v_fmac_f32 v67, v115, v26
    s_waitcnt lgkmcnt(10)
    v_mfma_f32_16x16x32_bf16 v[52:55], a[16:19], v[124:127], v[52:55]
    ds_read_b128 a[12:15], v4 offset:44032
    v_fmac_f32 v96, v112, v27
    v_mfma_f32_16x16x32_bf16 v[84:87], a[16:19], v[128:131], v[84:87]
    v_fmac_f32 v97, v113, v27
    s_waitcnt lgkmcnt(10)
    v_mfma_f32_16x16x32_bf16 v[56:59], a[20:23], v[124:127], v[56:59]
    ds_read_b128 a[16:19], v4 offset:45056
    v_fmac_f32 v98, v114, v27
    v_mfma_f32_16x16x32_bf16 v[88:91], a[20:23], v[128:131], v[88:91]
    v_fmac_f32 v99, v115, v27
    s_waitcnt lgkmcnt(10)
    v_mfma_f32_16x16x32_bf16 v[60:63], a[24:27], v[124:127], v[60:63]
    ds_read_b128 a[20:23], v4 offset:46080
    v_fmac_f32 v48, v104, v26
    v_mfma_f32_16x16x32_bf16 v[92:95], a[24:27], v[128:131], v[92:95]
    v_fmac_f32 v49, v105, v26
    s_waitcnt lgkmcnt(10)
    v_mfma_f32_16x16x32_bf16 v[64:67], a[28:31], v[124:127], v[64:67]
    ds_read_b128 a[24:27], v4 offset:47104
    v_fmac_f32 v50, v106, v26
    v_mfma_f32_16x16x32_bf16 v[96:99], a[28:31], v[128:131], v[96:99]
    v_fmac_f32 v51, v107, v26
    s_waitcnt lgkmcnt(10)
    v_mfma_f32_16x16x32_bf16 v[68:71], a[32:35], v[124:127], v[68:71]
    ds_read_b128 a[28:31], v4 offset:48128
    v_fmac_f32 v80, v104, v27
    v_mfma_f32_16x16x32_bf16 v[100:103], a[32:35], v[128:131], v[100:103]
    v_fmac_f32 v81, v105, v27
    s_waitcnt lgkmcnt(7)
    v_mfma_f32_16x16x32_bf16 v[40:43], a[0:3], v[144:147], v[40:43]
    s_barrier
    ds_read_b128 a[32:35], v3 offset:49152
    v_fmac_f32 v82, v106, v27
    v_mfma_f32_16x16x32_bf16 v[72:75], a[0:3], v[148:151], v[72:75]
    ds_read_b128 v[152:155], v37 offset:49152
    v_fmac_f32 v83, v107, v27
    s_waitcnt lgkmcnt(10)
    v_mfma_f32_16x16x32_bf16 v[44:47], a[4:7], v[144:147], v[44:47]
    ds_read_b128 a[0:3], v3 offset:50176
    v_mfma_f32_16x16x32_bf16 v[76:79], a[4:7], v[148:151], v[76:79]
    ds_read_b128 v[156:159], v37 offset:53248
    s_waitcnt lgkmcnt(9)
    v_mfma_f32_16x16x32_bf16 v[48:51], a[8:11], v[144:147], v[48:51]
    ds_read_b128 a[4:7], v3 offset:51200
    v_mfma_f32_16x16x32_bf16 v[80:83], a[8:11], v[148:151], v[80:83]
    ds_read_b128 a[40:43], v36 offset:53248
    s_waitcnt lgkmcnt(10)
    v_mfma_f32_16x16x32_bf16 v[52:55], a[12:15], v[144:147], v[52:55]
    ds_read_b128 a[8:11], v3 offset:52224
    v_mfma_f32_16x16x32_bf16 v[84:87], a[12:15], v[148:151], v[84:87]
    ds_read_b128 a[44:47], v36 offset:57344
    s_waitcnt lgkmcnt(11)
    v_mfma_f32_16x16x32_bf16 v[56:59], a[16:19], v[144:147], v[56:59]
    ds_read_b128 a[12:15], v4 offset:4096
    v_fmac_f32 v44, v108, v26
    v_mfma_f32_16x16x32_bf16 v[88:91], a[16:19], v[148:151], v[88:91]
    ds_read_b128 a[48:51], v36 offset:61440
    v_fmac_f32 v45, v109, v26
    s_waitcnt lgkmcnt(12)
    v_mfma_f32_16x16x32_bf16 v[60:63], a[20:23], v[144:147], v[60:63]
    ds_read_b128 a[16:19], v4 offset:5120
    v_fmac_f32 v46, v110, v26
    v_mfma_f32_16x16x32_bf16 v[92:95], a[20:23], v[148:151], v[92:95]
    ds_read_b128 a[52:55], v37 offset:0
    v_fmac_f32 v47, v111, v26
    s_waitcnt lgkmcnt(12)
    v_mfma_f32_16x16x32_bf16 v[64:67], a[24:27], v[144:147], v[64:67]
    ds_read_b128 a[20:23], v4 offset:6144
    v_fmac_f32 v76, v108, v27
    v_mfma_f32_16x16x32_bf16 v[96:99], a[24:27], v[148:151], v[96:99]
    ds_read_b128 a[56:59], v37 offset:57344
    v_fmac_f32 v77, v109, v27
    s_waitcnt lgkmcnt(12)
    v_mfma_f32_16x16x32_bf16 v[68:71], a[28:31], v[144:147], v[68:71]
    ds_read_b128 a[24:27], v4 offset:7168
    v_fmac_f32 v78, v110, v27
    v_mfma_f32_16x16x32_bf16 v[100:103], a[28:31], v[148:151], v[100:103]
    ds_read_b128 a[60:63], v37 offset:61440
    v_fmac_f32 v79, v111, v27
    s_waitcnt lgkmcnt(12)
    v_mfma_f32_16x16x32_bf16 v[40:43], a[32:35], v[152:155], v[40:43]
    ds_read_b128 a[28:31], v5 offset:8192
    v_mfma_f32_16x16x32_bf16 v[72:75], a[32:35], v[156:159], v[72:75]
    ds_read_b128 a[64:67], v38 offset:0
    s_waitcnt lgkmcnt(12)
    v_mfma_f32_16x16x32_bf16 v[44:47], a[0:3], v[152:155], v[44:47]
    ds_read_b128 a[32:35], v5 offset:9216
    v_mfma_f32_16x16x32_bf16 v[76:79], a[0:3], v[156:159], v[76:79]
    ds_read_b128 a[68:71], v38 offset:4096
    s_waitcnt lgkmcnt(12)
    v_mfma_f32_16x16x32_bf16 v[40:43], a[4:7], a[40:43], v[40:43]
    ds_read_b128 a[0:3], v5 offset:10240
    v_mfma_f32_16x16x32_bf16 v[72:75], a[4:7], a[44:47], v[72:75]
    ds_read_b128 a[72:75], v38 offset:12288
    s_waitcnt lgkmcnt(12)
    v_mfma_f32_16x16x32_bf16 v[44:47], a[8:11], a[40:43], v[44:47]
    ds_read_b128 a[4:7], v5 offset:11264
    v_mfma_f32_16x16x32_bf16 v[76:79], a[8:11], a[44:47], v[76:79]
    ds_read_b128 a[76:79], v36 offset:0
    s_waitcnt lgkmcnt(12)
    v_mfma_f32_16x16x32_bf16 v[40:43], a[12:15], a[48:51], v[40:43]
    ds_read_b128 a[8:11], v3 offset:12288
    v_mfma_f32_16x16x32_bf16 v[72:75], a[12:15], a[52:55], v[72:75]
    ds_read_b128 a[80:83], v36 offset:4096
    s_waitcnt lgkmcnt(12)
    v_mfma_f32_16x16x32_bf16 v[44:47], a[16:19], a[48:51], v[44:47]
    ds_read_b128 a[12:15], v3 offset:13312
    v_mfma_f32_16x16x32_bf16 v[76:79], a[16:19], a[52:55], v[76:79]
    ds_read_b128 a[84:87], v36 offset:8192
    s_waitcnt lgkmcnt(12)
    v_mfma_f32_16x16x32_bf16 v[40:43], a[20:23], a[56:59], v[40:43]
    ds_read_b128 a[16:19], v3 offset:14336
    v_mfma_f32_16x16x32_bf16 v[72:75], a[20:23], a[60:63], v[72:75]
    ds_read_b128 a[88:91], v36 offset:16384
    s_waitcnt lgkmcnt(12)
    v_mfma_f32_16x16x32_bf16 v[44:47], a[24:27], a[56:59], v[44:47]
    ds_read_b128 a[20:23], v3 offset:15360
    v_mfma_f32_16x16x32_bf16 v[76:79], a[24:27], a[60:63], v[76:79]
    ds_read_b128 a[92:95], v36 offset:20480
    s_waitcnt lgkmcnt(12)
    v_mfma_f32_16x16x32_bf16 v[40:43], a[28:31], a[64:67], v[40:43]
    s_barrier
    ds_read_b128 a[24:27], v4 offset:16384
    v_mfma_f32_16x16x32_bf16 v[72:75], a[28:31], a[68:71], v[72:75]
    ds_read_b128 v[116:119], v37 offset:8192
    s_waitcnt lgkmcnt(12)
    v_mfma_f32_16x16x32_bf16 v[44:47], a[32:35], a[64:67], v[44:47]
    ds_read_b128 a[28:31], v4 offset:17408
    v_mfma_f32_16x16x32_bf16 v[76:79], a[32:35], a[68:71], v[76:79]
    ds_read_b128 v[120:123], v37 offset:12288
    s_waitcnt lgkmcnt(12)
    v_mfma_f32_16x16x32_bf16 v[40:43], a[0:3], a[72:75], v[40:43]
    ds_read_b128 a[32:35], v4 offset:18432
    v_mfma_f32_16x16x32_bf16 v[72:75], a[0:3], a[76:79], v[72:75]
    ds_read_b128 v[124:127], v37 offset:20480
    s_waitcnt lgkmcnt(12)
    v_mfma_f32_16x16x32_bf16 v[44:47], a[4:7], a[72:75], v[44:47]
    ds_read_b128 a[0:3], v4 offset:19456
    v_mfma_f32_16x16x32_bf16 v[76:79], a[4:7], a[76:79], v[76:79]
    ds_read_b128 v[128:131], v37 offset:24576
    s_waitcnt lgkmcnt(12)
    v_mfma_f32_16x16x32_bf16 v[40:43], a[8:11], a[80:83], v[40:43]
    ds_read_b128 a[4:7], v4 offset:28672
    v_mfma_f32_16x16x32_bf16 v[72:75], a[8:11], a[84:87], v[72:75]
    s_waitcnt lgkmcnt(12)
    v_mfma_f32_16x16x32_bf16 v[44:47], a[12:15], a[80:83], v[44:47]
    ds_read_b128 a[8:11], v4 offset:29696
    v_mfma_f32_16x16x32_bf16 v[76:79], a[12:15], a[84:87], v[76:79]
    s_waitcnt lgkmcnt(10)
    v_mfma_f32_16x16x32_bf16 v[40:43], a[16:19], a[88:91], v[40:43]
    ds_read_b128 a[12:15], v4 offset:30720
    v_mfma_f32_16x16x32_bf16 v[72:75], a[16:19], a[92:95], v[72:75]
    s_waitcnt lgkmcnt(12)
    v_mfma_f32_16x16x32_bf16 v[44:47], a[20:23], a[88:91], v[44:47]
    ds_read_b128 a[16:19], v4 offset:31744
    v_mfma_f32_16x16x32_bf16 v[76:79], a[20:23], a[92:95], v[76:79]
    s_waitcnt lgkmcnt(8)
    v_mfma_f32_16x16x32_bf16 v[40:43], a[24:27], v[116:119], v[40:43]
    ds_read_b128 a[20:23], v3 offset:24576
    v_mfma_f32_16x16x32_bf16 v[72:75], a[24:27], v[120:123], v[72:75]
    s_waitcnt lgkmcnt(10)
    v_mfma_f32_16x16x32_bf16 v[44:47], a[28:31], v[116:119], v[44:47]
    ds_read_b128 a[24:27], v3 offset:25600
    v_mfma_f32_16x16x32_bf16 v[76:79], a[28:31], v[120:123], v[76:79]
    s_waitcnt lgkmcnt(6)
    v_mfma_f32_16x16x32_bf16 v[40:43], a[32:35], v[124:127], v[40:43]
    ds_read_b128 a[28:31], v3 offset:26624
    v_mfma_f32_16x16x32_bf16 v[72:75], a[32:35], v[128:131], v[72:75]
    s_waitcnt lgkmcnt(8)
    v_mfma_f32_16x16x32_bf16 v[44:47], a[0:3], v[124:127], v[44:47]
    ds_read_b128 a[32:35], v3 offset:27648
    v_mfma_f32_16x16x32_bf16 v[76:79], a[0:3], v[128:131], v[76:79]
    s_waitcnt lgkmcnt(7)
    v_mfma_f32_16x16x32_bf16 v[56:59], a[4:7], v[152:155], v[56:59]
    ds_read_b128 a[0:3], v3 offset:28672
    v_mfma_f32_16x16x32_bf16 v[88:91], a[4:7], v[156:159], v[88:91]
    s_waitcnt lgkmcnt(7)
    v_mfma_f32_16x16x32_bf16 v[60:63], a[8:11], v[152:155], v[60:63]
    ds_read_b128 a[4:7], v3 offset:29696
    v_mfma_f32_16x16x32_bf16 v[92:95], a[8:11], v[156:159], v[92:95]
    s_waitcnt lgkmcnt(7)
    v_mfma_f32_16x16x32_bf16 v[56:59], a[12:15], a[40:43], v[56:59]
    ds_read_b128 a[8:11], v3 offset:30720
    v_mul_f32 v40, v40, v30
    v_mul_f32 v41, v41, v30
    v_mfma_f32_16x16x32_bf16 v[88:91], a[12:15], a[44:47], v[88:91]
    v_mul_f32 v42, v42, v30
    s_waitcnt lgkmcnt(7)
    v_mfma_f32_16x16x32_bf16 v[60:63], a[16:19], a[40:43], v[60:63]
    ds_read_b128 a[12:15], v3 offset:31744
    v_mul_f32 v43, v43, v30
    v_mul_f32 v44, v44, v30
    v_mfma_f32_16x16x32_bf16 v[92:95], a[16:19], a[44:47], v[92:95]
    v_mul_f32 v45, v45, v30
    s_waitcnt lgkmcnt(7)
    v_mfma_f32_16x16x32_bf16 v[56:59], a[20:23], a[48:51], v[56:59]
    s_barrier
    ds_read_b128 a[16:19], v3 offset:32768
    v_mul_f32 v46, v46, v30
    v_mul_f32 v47, v47, v30
    v_mfma_f32_16x16x32_bf16 v[88:91], a[20:23], a[52:55], v[88:91]
    v_cvt_pk_bf16_f32 v40, v40, v41
    s_waitcnt lgkmcnt(7)
    v_mfma_f32_16x16x32_bf16 v[60:63], a[24:27], a[48:51], v[60:63]
    ds_read_b128 a[20:23], v3 offset:33792
    v_cvt_pk_bf16_f32 v41, v42, v43
    v_cvt_pk_bf16_f32 v42, v44, v45
    v_mfma_f32_16x16x32_bf16 v[92:95], a[24:27], a[52:55], v[92:95]
    v_cvt_pk_bf16_f32 v43, v46, v47
    s_waitcnt lgkmcnt(7)
    v_mfma_f32_16x16x32_bf16 v[56:59], a[28:31], a[56:59], v[56:59]
    ds_read_b128 a[24:27], v3 offset:34816
    buffer_store_dwordx4 v[40:43], v14, s[4:7], s18 offen offset:0 sc1
    v_mul_f32 v72, v72, v32
    v_mfma_f32_16x16x32_bf16 v[88:91], a[28:31], a[60:63], v[88:91]
    v_mul_f32 v73, v73, v32
    s_waitcnt lgkmcnt(7)
    v_mfma_f32_16x16x32_bf16 v[60:63], a[32:35], a[56:59], v[60:63]
    ds_read_b128 a[28:31], v3 offset:35840
    v_mul_f32 v74, v74, v32
    v_mul_f32 v75, v75, v32
    v_mfma_f32_16x16x32_bf16 v[92:95], a[32:35], a[60:63], v[92:95]
    v_mul_f32 v76, v76, v32
    s_waitcnt lgkmcnt(7)
    v_mfma_f32_16x16x32_bf16 v[56:59], a[0:3], a[64:67], v[56:59]
    ds_read_b128 a[32:35], v3 offset:36864
    v_mul_f32 v77, v77, v32
    v_mul_f32 v78, v78, v32
    v_mfma_f32_16x16x32_bf16 v[88:91], a[0:3], a[68:71], v[88:91]
    v_mul_f32 v79, v79, v32
    s_waitcnt lgkmcnt(7)
    v_mfma_f32_16x16x32_bf16 v[60:63], a[4:7], a[64:67], v[60:63]
    ds_read_b128 a[0:3], v3 offset:37888
    v_cvt_pk_bf16_f32 v72, v72, v73
    v_cvt_pk_bf16_f32 v73, v74, v75
    v_mfma_f32_16x16x32_bf16 v[92:95], a[4:7], a[68:71], v[92:95]
    v_cvt_pk_bf16_f32 v74, v76, v77
    s_waitcnt lgkmcnt(7)
    v_mfma_f32_16x16x32_bf16 v[56:59], a[8:11], a[72:75], v[56:59]
    ds_read_b128 a[4:7], v3 offset:38912
    v_cvt_pk_bf16_f32 v75, v78, v79
    v_mfma_f32_16x16x32_bf16 v[88:91], a[8:11], a[76:79], v[88:91]
    buffer_store_dwordx4 v[72:75], v14, s[4:7], s18 offen offset:256 sc1
    s_waitcnt lgkmcnt(7)
    v_mfma_f32_16x16x32_bf16 v[60:63], a[12:15], a[72:75], v[60:63]
    ds_read_b128 a[8:11], v3 offset:39936
    v_mfma_f32_16x16x32_bf16 v[92:95], a[12:15], a[76:79], v[92:95]
    s_waitcnt lgkmcnt(7)
    v_mfma_f32_16x16x32_bf16 v[56:59], a[16:19], a[80:83], v[56:59]
    ds_read_b128 a[12:15], v3 offset:40960
    v_mfma_f32_16x16x32_bf16 v[88:91], a[16:19], a[84:87], v[88:91]
    s_waitcnt lgkmcnt(7)
    v_mfma_f32_16x16x32_bf16 v[60:63], a[20:23], a[80:83], v[60:63]
    ds_read_b128 a[16:19], v3 offset:41984
    v_mfma_f32_16x16x32_bf16 v[92:95], a[20:23], a[84:87], v[92:95]
    s_waitcnt lgkmcnt(7)
    v_mfma_f32_16x16x32_bf16 v[56:59], a[24:27], a[88:91], v[56:59]
    ds_read_b128 a[20:23], v3 offset:43008
    v_mfma_f32_16x16x32_bf16 v[88:91], a[24:27], a[92:95], v[88:91]
    s_waitcnt lgkmcnt(7)
    v_mfma_f32_16x16x32_bf16 v[60:63], a[28:31], a[88:91], v[60:63]
    ds_read_b128 a[24:27], v3 offset:44032
    v_mfma_f32_16x16x32_bf16 v[92:95], a[28:31], a[92:95], v[92:95]
    s_waitcnt lgkmcnt(7)
    v_mfma_f32_16x16x32_bf16 v[56:59], a[32:35], v[116:119], v[56:59]
    ds_read_b128 a[28:31], v3 offset:45056
    v_mfma_f32_16x16x32_bf16 v[88:91], a[32:35], v[120:123], v[88:91]
    s_waitcnt lgkmcnt(7)
    v_mfma_f32_16x16x32_bf16 v[60:63], a[0:3], v[116:119], v[60:63]
    ds_read_b128 a[32:35], v3 offset:46080
    v_mfma_f32_16x16x32_bf16 v[92:95], a[0:3], v[120:123], v[92:95]
    s_waitcnt lgkmcnt(7)
    v_mfma_f32_16x16x32_bf16 v[56:59], a[4:7], v[124:127], v[56:59]
    ds_read_b128 a[0:3], v3 offset:47104
    v_mfma_f32_16x16x32_bf16 v[88:91], a[4:7], v[128:131], v[88:91]
    s_waitcnt lgkmcnt(7)
    v_mfma_f32_16x16x32_bf16 v[60:63], a[8:11], v[124:127], v[60:63]
    ds_read_b128 a[4:7], v3 offset:48128
    v_mfma_f32_16x16x32_bf16 v[92:95], a[8:11], v[128:131], v[92:95]
    s_waitcnt lgkmcnt(7)
    v_mfma_f32_16x16x32_bf16 v[48:51], a[12:15], v[152:155], v[48:51]
    s_barrier
    ds_read_b128 a[8:11], v4 offset:32768
    v_mfma_f32_16x16x32_bf16 v[80:83], a[12:15], v[156:159], v[80:83]
    s_waitcnt lgkmcnt(7)
    v_mfma_f32_16x16x32_bf16 v[52:55], a[16:19], v[152:155], v[52:55]
    ds_read_b128 a[12:15], v4 offset:33792
    v_mfma_f32_16x16x32_bf16 v[84:87], a[16:19], v[156:159], v[84:87]
    s_waitcnt lgkmcnt(7)
    v_mfma_f32_16x16x32_bf16 v[48:51], a[20:23], a[40:43], v[48:51]
    ds_read_b128 a[16:19], v4 offset:34816
    v_mul_f32 v56, v56, v30
    v_mul_f32 v57, v57, v30
    v_mfma_f32_16x16x32_bf16 v[80:83], a[20:23], a[44:47], v[80:83]
    v_mul_f32 v58, v58, v30
    s_waitcnt lgkmcnt(7)
    v_mfma_f32_16x16x32_bf16 v[52:55], a[24:27], a[40:43], v[52:55]
    ds_read_b128 a[20:23], v4 offset:35840
    v_mul_f32 v59, v59, v30
    v_mul_f32 v60, v60, v30
    v_mfma_f32_16x16x32_bf16 v[84:87], a[24:27], a[44:47], v[84:87]
    v_mul_f32 v61, v61, v30
    s_waitcnt lgkmcnt(7)
    v_mfma_f32_16x16x32_bf16 v[48:51], a[28:31], a[48:51], v[48:51]
    ds_read_b128 a[24:27], v4 offset:36864
    v_mul_f32 v62, v62, v30
    v_mul_f32 v63, v63, v30
    v_mfma_f32_16x16x32_bf16 v[80:83], a[28:31], a[52:55], v[80:83]
    v_cvt_pk_bf16_f32 v56, v56, v57
    s_waitcnt lgkmcnt(7)
    v_mfma_f32_16x16x32_bf16 v[52:55], a[32:35], a[48:51], v[52:55]
    ds_read_b128 a[28:31], v4 offset:37888
    v_cvt_pk_bf16_f32 v57, v58, v59
    v_cvt_pk_bf16_f32 v58, v60, v61
    v_mfma_f32_16x16x32_bf16 v[84:87], a[32:35], a[52:55], v[84:87]
    v_cvt_pk_bf16_f32 v59, v62, v63
    s_waitcnt lgkmcnt(7)
    v_mfma_f32_16x16x32_bf16 v[48:51], a[0:3], a[56:59], v[48:51]
    ds_read_b128 a[32:35], v4 offset:38912
    buffer_store_dwordx4 v[56:59], v15, s[4:7], s18 offen offset:0 sc1
    v_mul_f32 v88, v88, v32
    v_mfma_f32_16x16x32_bf16 v[80:83], a[0:3], a[60:63], v[80:83]
    v_mul_f32 v89, v89, v32
    s_waitcnt lgkmcnt(7)
    v_mfma_f32_16x16x32_bf16 v[52:55], a[4:7], a[56:59], v[52:55]
    ds_read_b128 a[0:3], v4 offset:39936
    v_mul_f32 v90, v90, v32
    v_mul_f32 v91, v91, v32
    v_mfma_f32_16x16x32_bf16 v[84:87], a[4:7], a[60:63], v[84:87]
    v_mul_f32 v92, v92, v32
    s_waitcnt lgkmcnt(7)
    v_mfma_f32_16x16x32_bf16 v[48:51], a[8:11], a[64:67], v[48:51]
    ds_read_b128 a[4:7], v4 offset:40960
    v_mul_f32 v93, v93, v32
    v_mul_f32 v94, v94, v32
    v_mfma_f32_16x16x32_bf16 v[80:83], a[8:11], a[68:71], v[80:83]
    v_mul_f32 v95, v95, v32
    s_waitcnt lgkmcnt(7)
    v_mfma_f32_16x16x32_bf16 v[52:55], a[12:15], a[64:67], v[52:55]
    ds_read_b128 a[8:11], v4 offset:41984
    v_cvt_pk_bf16_f32 v88, v88, v89
    v_cvt_pk_bf16_f32 v89, v90, v91
    v_mfma_f32_16x16x32_bf16 v[84:87], a[12:15], a[68:71], v[84:87]
    v_cvt_pk_bf16_f32 v90, v92, v93
    s_waitcnt lgkmcnt(7)
    v_mfma_f32_16x16x32_bf16 v[48:51], a[16:19], a[72:75], v[48:51]
    ds_read_b128 a[12:15], v4 offset:43008
    v_cvt_pk_bf16_f32 v91, v94, v95
    v_mfma_f32_16x16x32_bf16 v[80:83], a[16:19], a[76:79], v[80:83]
    buffer_store_dwordx4 v[88:91], v15, s[4:7], s18 offen offset:256 sc1
    s_waitcnt lgkmcnt(7)
    v_mfma_f32_16x16x32_bf16 v[52:55], a[20:23], a[72:75], v[52:55]
    ds_read_b128 a[16:19], v4 offset:44032
    v_mfma_f32_16x16x32_bf16 v[84:87], a[20:23], a[76:79], v[84:87]
    s_waitcnt lgkmcnt(7)
    v_mfma_f32_16x16x32_bf16 v[48:51], a[24:27], a[80:83], v[48:51]
    ds_read_b128 a[20:23], v4 offset:45056
    v_mfma_f32_16x16x32_bf16 v[80:83], a[24:27], a[84:87], v[80:83]
    s_waitcnt lgkmcnt(7)
    v_mfma_f32_16x16x32_bf16 v[52:55], a[28:31], a[80:83], v[52:55]
    ds_read_b128 a[24:27], v4 offset:46080
    v_mfma_f32_16x16x32_bf16 v[84:87], a[28:31], a[84:87], v[84:87]
    s_waitcnt lgkmcnt(7)
    v_mfma_f32_16x16x32_bf16 v[48:51], a[32:35], a[88:91], v[48:51]
    ds_read_b128 a[28:31], v4 offset:47104
    v_mfma_f32_16x16x32_bf16 v[80:83], a[32:35], a[92:95], v[80:83]
    s_waitcnt lgkmcnt(7)
    v_mfma_f32_16x16x32_bf16 v[52:55], a[0:3], a[88:91], v[52:55]
    ds_read_b128 a[32:35], v4 offset:48128
    v_mfma_f32_16x16x32_bf16 v[84:87], a[0:3], a[92:95], v[84:87]
    s_waitcnt lgkmcnt(7)
    v_mfma_f32_16x16x32_bf16 v[48:51], a[4:7], v[116:119], v[48:51]
    s_barrier
    ds_read_b128 a[0:3], v4 offset:49152
    v_mfma_f32_16x16x32_bf16 v[80:83], a[4:7], v[120:123], v[80:83]
    s_waitcnt lgkmcnt(7)
    v_mfma_f32_16x16x32_bf16 v[52:55], a[8:11], v[116:119], v[52:55]
    ds_read_b128 a[4:7], v4 offset:50176
    v_mfma_f32_16x16x32_bf16 v[84:87], a[8:11], v[120:123], v[84:87]
    s_waitcnt lgkmcnt(7)
    v_mfma_f32_16x16x32_bf16 v[48:51], a[12:15], v[124:127], v[48:51]
    ds_read_b128 a[8:11], v4 offset:51200
    v_mfma_f32_16x16x32_bf16 v[80:83], a[12:15], v[128:131], v[80:83]
    s_waitcnt lgkmcnt(7)
    v_mfma_f32_16x16x32_bf16 v[52:55], a[16:19], v[124:127], v[52:55]
    ds_read_b128 a[12:15], v4 offset:52224
    v_mfma_f32_16x16x32_bf16 v[84:87], a[16:19], v[128:131], v[84:87]
    s_waitcnt lgkmcnt(7)
    v_mfma_f32_16x16x32_bf16 v[64:67], a[20:23], v[152:155], v[64:67]
    ds_read_b128 a[16:19], v4 offset:53248
    v_mfma_f32_16x16x32_bf16 v[96:99], a[20:23], v[156:159], v[96:99]
    s_waitcnt lgkmcnt(7)
    v_mfma_f32_16x16x32_bf16 v[68:71], a[24:27], v[152:155], v[68:71]
    ds_read_b128 a[20:23], v4 offset:54272
    v_mfma_f32_16x16x32_bf16 v[100:103], a[24:27], v[156:159], v[100:103]
    s_waitcnt lgkmcnt(7)
    v_mfma_f32_16x16x32_bf16 v[64:67], a[28:31], a[40:43], v[64:67]
    ds_read_b128 a[24:27], v4 offset:55296
    v_mul_f32 v48, v48, v31
    v_mul_f32 v49, v49, v31
    v_mfma_f32_16x16x32_bf16 v[96:99], a[28:31], a[44:47], v[96:99]
    v_mul_f32 v50, v50, v31
    s_waitcnt lgkmcnt(7)
    v_mfma_f32_16x16x32_bf16 v[68:71], a[32:35], a[40:43], v[68:71]
    ds_read_b128 a[28:31], v4 offset:56320
    v_mul_f32 v51, v51, v31
    v_mul_f32 v52, v52, v31
    v_mfma_f32_16x16x32_bf16 v[100:103], a[32:35], a[44:47], v[100:103]
    v_mul_f32 v53, v53, v31
    s_waitcnt lgkmcnt(7)
    v_mfma_f32_16x16x32_bf16 v[64:67], a[0:3], a[48:51], v[64:67]
    ds_read_b128 a[32:35], v3 offset:49152
    v_mul_f32 v54, v54, v31
    v_mul_f32 v55, v55, v31
    v_mfma_f32_16x16x32_bf16 v[96:99], a[0:3], a[52:55], v[96:99]
    v_cvt_pk_bf16_f32 v48, v48, v49
    s_waitcnt lgkmcnt(7)
    v_mfma_f32_16x16x32_bf16 v[68:71], a[4:7], a[48:51], v[68:71]
    ds_read_b128 a[0:3], v3 offset:50176
    v_cvt_pk_bf16_f32 v49, v50, v51
    v_cvt_pk_bf16_f32 v50, v52, v53
    v_mfma_f32_16x16x32_bf16 v[100:103], a[4:7], a[52:55], v[100:103]
    v_cvt_pk_bf16_f32 v51, v54, v55
    s_waitcnt lgkmcnt(7)
    v_mfma_f32_16x16x32_bf16 v[64:67], a[8:11], a[56:59], v[64:67]
    ds_read_b128 a[4:7], v3 offset:51200
    v_cndmask_b32 v50, v50, v12, s[38:39]
    v_cndmask_b32 v51, v51, 0, s[38:39]
    v_mfma_f32_16x16x32_bf16 v[96:99], a[8:11], a[60:63], v[96:99]
    buffer_store_dwordx4 v[48:51], v6, s[4:7], s26 offen offset:0 sc1
    s_waitcnt lgkmcnt(7)
    v_mfma_f32_16x16x32_bf16 v[68:71], a[12:15], a[56:59], v[68:71]
    ds_read_b128 a[8:11], v3 offset:52224
    v_mul_f32 v80, v80, v33
    v_mul_f32 v81, v81, v33
    v_mfma_f32_16x16x32_bf16 v[100:103], a[12:15], a[60:63], v[100:103]
    v_mul_f32 v82, v82, v33
    s_waitcnt lgkmcnt(7)
    v_mfma_f32_16x16x32_bf16 v[64:67], a[16:19], a[64:67], v[64:67]
    ds_read_b128 a[12:15], v3 offset:53248
    v_mul_f32 v83, v83, v33
    v_mul_f32 v84, v84, v33
    v_mfma_f32_16x16x32_bf16 v[96:99], a[16:19], a[68:71], v[96:99]
    v_mul_f32 v85, v85, v33
    s_waitcnt lgkmcnt(7)
    v_mfma_f32_16x16x32_bf16 v[68:71], a[20:23], a[64:67], v[68:71]
    ds_read_b128 a[16:19], v3 offset:54272
    v_mul_f32 v86, v86, v33
    v_mul_f32 v87, v87, v33
    v_mfma_f32_16x16x32_bf16 v[100:103], a[20:23], a[68:71], v[100:103]
    v_cvt_pk_bf16_f32 v80, v80, v81
    s_waitcnt lgkmcnt(7)
    v_mfma_f32_16x16x32_bf16 v[64:67], a[24:27], a[72:75], v[64:67]
    ds_read_b128 a[20:23], v3 offset:55296
    v_cvt_pk_bf16_f32 v81, v82, v83
    v_cvt_pk_bf16_f32 v82, v84, v85
    v_mfma_f32_16x16x32_bf16 v[96:99], a[24:27], a[76:79], v[96:99]
    v_cvt_pk_bf16_f32 v83, v86, v87
    s_waitcnt lgkmcnt(7)
    v_mfma_f32_16x16x32_bf16 v[68:71], a[28:31], a[72:75], v[68:71]
    ds_read_b128 a[24:27], v3 offset:56320
    v_cndmask_b32 v82, v82, v12, s[38:39]
    v_cndmask_b32 v83, v83, 0, s[38:39]
    v_mfma_f32_16x16x32_bf16 v[100:103], a[28:31], a[76:79], v[100:103]
    buffer_store_dwordx4 v[80:83], v6, s[4:7], s26 offen offset:256 sc1
    s_waitcnt lgkmcnt(7)
    v_mfma_f32_16x16x32_bf16 v[64:67], a[32:35], a[80:83], v[64:67]
    v_mfma_f32_16x16x32_bf16 v[96:99], a[32:35], a[84:87], v[96:99]
    s_waitcnt lgkmcnt(6)
    v_mfma_f32_16x16x32_bf16 v[68:71], a[0:3], a[80:83], v[68:71]
    v_mfma_f32_16x16x32_bf16 v[100:103], a[0:3], a[84:87], v[100:103]
    s_waitcnt lgkmcnt(5)
    v_mfma_f32_16x16x32_bf16 v[64:67], a[4:7], a[88:91], v[64:67]
    v_mfma_f32_16x16x32_bf16 v[96:99], a[4:7], a[92:95], v[96:99]
    s_waitcnt lgkmcnt(4)
    v_mfma_f32_16x16x32_bf16 v[68:71], a[8:11], a[88:91], v[68:71]
    v_mfma_f32_16x16x32_bf16 v[100:103], a[8:11], a[92:95], v[100:103]
    s_waitcnt lgkmcnt(3)
    v_mfma_f32_16x16x32_bf16 v[64:67], a[12:15], v[116:119], v[64:67]
    v_mfma_f32_16x16x32_bf16 v[96:99], a[12:15], v[120:123], v[96:99]
    s_waitcnt lgkmcnt(2)
    v_mfma_f32_16x16x32_bf16 v[68:71], a[16:19], v[116:119], v[68:71]
    v_mfma_f32_16x16x32_bf16 v[100:103], a[16:19], v[120:123], v[100:103]
    s_waitcnt lgkmcnt(1)
    v_mfma_f32_16x16x32_bf16 v[64:67], a[20:23], v[124:127], v[64:67]
    v_mfma_f32_16x16x32_bf16 v[96:99], a[20:23], v[128:131], v[96:99]
    s_waitcnt lgkmcnt(0)
    v_mfma_f32_16x16x32_bf16 v[68:71], a[24:27], v[124:127], v[68:71]
    v_mfma_f32_16x16x32_bf16 v[100:103], a[24:27], v[128:131], v[100:103]
    s_waitcnt vmcnt(2)
    s_barrier
    s_nop 7
    v_mul_f32 v64, v64, v31
    v_mul_f32 v65, v65, v31
    v_mul_f32 v66, v66, v31
    v_mul_f32 v67, v67, v31
    v_mul_f32 v68, v68, v31
    v_mul_f32 v69, v69, v31
    v_mul_f32 v70, v70, v31
    v_mul_f32 v71, v71, v31
    v_cvt_pk_bf16_f32 v64, v64, v65
    v_cvt_pk_bf16_f32 v65, v66, v67
    v_cvt_pk_bf16_f32 v66, v68, v69
    v_cvt_pk_bf16_f32 v67, v70, v71
    v_cndmask_b32 v66, v66, v12, s[38:39]
    v_cndmask_b32 v67, v67, 0, s[38:39]
    buffer_store_dwordx4 v[64:67], v6, s[4:7], s27 offen offset:0 sc1
    v_mul_f32 v96, v96, v33
    v_mul_f32 v97, v97, v33
    v_mul_f32 v98, v98, v33
    v_mul_f32 v99, v99, v33
    v_mul_f32 v100, v100, v33
    v_mul_f32 v101, v101, v33
    v_mul_f32 v102, v102, v33
    v_mul_f32 v103, v103, v33
    v_cvt_pk_bf16_f32 v96, v96, v97
    v_cvt_pk_bf16_f32 v97, v98, v99
    v_cvt_pk_bf16_f32 v98, v100, v101
    v_cvt_pk_bf16_f32 v99, v102, v103
    v_cndmask_b32 v98, v98, v12, s[38:39]
    v_cndmask_b32 v99, v99, 0, s[38:39]
    buffer_store_dwordx4 v[96:99], v6, s[4:7], s27 offen offset:256 sc1
L_qkv_sig:
    s_branch L_mega_kernel_att_2
L_mega_kernel_final_55:
    v_mul_u32_u24 v10, 1280, v7
    v_lshl_add_u32 v11, v8, 4, v10
    v_lshrrev_b32 v12, 1, v8
    v_lshl_add_u32 v12, v12, 4, v10
    s_lshl_b32 s26, s24, 5
    s_lshr_b32 s27, s25, 4
    s_add_u32 s26, s26, s27
    s_mul_i32 s26, s26, 1280
    s_mul_i32 s27, s15, 160
    s_add_u32 s26, s26, s27
    buffer_store_dwordx4 v[16:19], v11, s[8:11], s26 offen
    buffer_store_dwordx4 v[20:23], v11, s[8:11], s26 offen offset:64
    s_mov_b64 exec, s[36:37]
    buffer_store_dwordx4 v[30:33], v12, s[8:11], s26 offen offset:128
    s_mov_b64 exec, -1
    s_endpgm
L_mega_kernel_L_4:
    s_setprio 0
    s_mul_i32 s28, s15, 276480
    s_add_u32 s28, s28, 53788672
    s_mul_i32 s29, s23, 30720
    s_add_u32 s29, s29, s28
    s_add_u32 s29, s29, 30720
    s_add_u32 s28, s28, s31
    s_add_u32 m0, s31, 149504
    s_nop 0
    buffer_load_dwordx4 v3, s[4:7], s28 offen sc1 lds
    s_add_u32 s28, s28, 4096
    s_add_u32 m0, s31, 153600
    s_nop 0
    buffer_load_dwordx4 v3, s[4:7], s28 offen sc1 lds
    s_add_u32 s28, s28, 4096
    buffer_load_dwordx4 v[16:19], v3, s[4:7], s29 offen offset:0 sc1
    buffer_load_dwordx4 v[20:23], v3, s[4:7], s29 offen offset:1024 sc1
    buffer_load_dwordx4 v[24:27], v3, s[4:7], s29 offen offset:2048 sc1
    buffer_load_dwordx4 v[28:31], v3, s[4:7], s29 offen offset:3072 sc1
    s_add_u32 s29, s29, 4096
    buffer_load_dwordx4 v[32:35], v3, s[4:7], s29 offen offset:0 sc1
    buffer_load_dwordx4 v[36:39], v3, s[4:7], s29 offen offset:1024 sc1
    s_nop 0
    s_barrier
    s_nop 0
    s_barrier
    s_lshl_b32 s24, s14, 1
    s_lshr_b32 s25, s23, 1
    s_add_u32 s24, s24, s25
    s_and_b32 s25, s23, 1
    s_lshl_b32 s25, s25, 8
    s_mul_i32 s20, s24, 40960
    s_add_u32 s20, s20, s25
    s_add_u32 s20, s20, s18
    s_add_u32 s20, s20, 11141120
    s_add_u32 s20, s20, 16384
    s_add_u32 m0, s31, 0
    s_nop 0
    buffer_load_dwordx4 v6, s[4:7], s20 offen sc1 lds
    s_add_u32 s20, s20, 2048
    s_add_u32 m0, s31, 4096
    s_nop 0
    buffer_load_dwordx4 v6, s[4:7], s20 offen sc1 lds
    s_add_u32 s20, s20, 2048
    s_add_u32 m0, s31, 8192
    s_nop 0
    buffer_load_dwordx4 v6, s[4:7], s20 offen sc1 lds
    s_add_u32 s20, s20, 2048
    s_add_u32 m0, s31, 12288
    s_nop 0
    buffer_load_dwordx4 v6, s[4:7], s20 offen sc1 lds
    s_add_u32 s20, s20, 2048
    s_add_u32 m0, s31, 16384
    s_nop 0
    buffer_load_dwordx4 v6, s[4:7], s20 offen sc1 lds
    s_add_u32 s20, s20, 2048
    s_add_u32 m0, s31, 20480
    s_nop 0
    buffer_load_dwordx4 v6, s[4:7], s20 offen sc1 lds
    s_add_u32 s20, s20, 2048
    s_add_u32 m0, s31, 73728
    s_nop 0
    buffer_load_dwordx4 v6, s[4:7], s20 offen sc1 lds
    s_add_u32 s20, s20, 2048
    s_add_u32 m0, s31, 77824
    s_nop 0
    buffer_load_dwordx4 v6, s[4:7], s20 offen sc1 lds
    s_add_u32 s20, s20, 2048
    s_mul_i32 s30, s15, 102400
    s_add_u32 s30, s30, 52920320
    s_add_u32 s30, s30, s31
    s_add_u32 m0, s31, 81920
    s_nop 0
    buffer_load_dwordx4 v3, s[4:7], s30 offen sc1 lds
    s_add_u32 s30, s30, 4096
    s_mul_i32 s30, s13, 286720
    s_add_u32 s30, s30, 48234496
    s_add_u32 s30, s30, s31
    s_add_u32 m0, s31, 86016
    s_nop 0
    buffer_load_dwordx4 v3, s[4:7], s30 offen sc1 lds
    s_add_u32 s30, s30, 4096
    s_add_u32 m0, s31, 90112
    s_nop 0
    buffer_load_dwordx4 v3, s[4:7], s30 offen sc1 lds
    s_add_u32 s30, s30, 4096
    s_add_u32 m0, s31, 94208
    s_nop 0
    buffer_load_dwordx4 v3, s[4:7], s30 offen sc1 lds
    s_add_u32 s30, s30, 4096
    s_waitcnt vmcnt(8)
    s_barrier
    s_add_u32 m0, s31, 24576
    s_nop 0
    buffer_load_dwordx4 v3, s[4:7], s30 offen sc1 lds
    s_add_u32 s30, s30, 4096
    s_add_u32 m0, s31, 28672
    s_nop 0
    buffer_load_dwordx4 v3, s[4:7], s30 offen sc1 lds
    s_add_u32 s30, s30, 4096
    s_add_u32 m0, s31, 32768
    s_nop 0
    buffer_load_dwordx4 v3, s[4:7], s30 offen sc1 lds
    s_add_u32 s30, s30, 4096
    s_waitcnt vmcnt(6)
    s_barrier
    s_lshr_b32 s50, s14, 1
    s_lshl_b32 s50, s50, 11
    s_add_u32 s50, s50, s18
    s_add_u32 s50, s50, 23953408
    v_lshlrev_b32 v10, 7, v1
    v_mov_b32 v11, 1
    s_nop 0
    s_barrier
    s_cmp_lg_u32 s22, 5
    s_cbranch_scc1 L_mega_kernel_es_76
    s_mov_b64 exec, 0xffff
    buffer_atomic_add v11, v10, s[4:7], s50 offen sc1
    s_mov_b64 exec, -1
L_mega_kernel_es_76:
    s_add_u32 m0, s31, 36864
    s_nop 0
    buffer_load_dwordx4 v3, s[4:7], s30 offen sc1 lds
    s_add_u32 s30, s30, 4096
    s_add_u32 m0, s31, 40960
    s_nop 0
    buffer_load_dwordx4 v3, s[4:7], s30 offen sc1 lds
    s_add_u32 s30, s30, 4096
    s_add_u32 m0, s31, 45056
    s_nop 0
    buffer_load_dwordx4 v3, s[4:7], s30 offen sc1 lds
    s_add_u32 s30, s30, 4096
    s_add_u32 m0, s31, 98304
    s_nop 0
    buffer_load_dwordx4 v3, s[4:7], s30 offen sc1 lds
    s_add_u32 s30, s30, 4096
    s_add_u32 m0, s31, 102400
    s_nop 0
    buffer_load_dwordx4 v3, s[4:7], s30 offen sc1 lds
    s_add_u32 s30, s30, 4096
    s_add_u32 m0, s31, 106496
    s_nop 0
    buffer_load_dwordx4 v3, s[4:7], s30 offen sc1 lds
    s_add_u32 s30, s30, 4096
    s_add_u32 m0, s31, 110592
    s_nop 0
    buffer_load_dwordx4 v3, s[4:7], s30 offen sc1 lds
    s_add_u32 s30, s30, 4096
    s_add_u32 m0, s31, 114688
    s_nop 0
    buffer_load_dwordx4 v3, s[4:7], s30 offen sc1 lds
    s_add_u32 s30, s30, 4096
    s_add_u32 m0, s31, 53248
    s_nop 0
    buffer_load_dwordx4 v3, s[4:7], s30 offen sc1 lds
    s_add_u32 s30, s30, 4096
    s_add_u32 m0, s31, 57344
    s_nop 0
    buffer_load_dwordx4 v3, s[4:7], s30 offen sc1 lds
    s_add_u32 s30, s30, 4096
    s_add_u32 m0, s31, 61440
    s_nop 0
    buffer_load_dwordx4 v3, s[4:7], s30 offen sc1 lds
    s_add_u32 s30, s30, 4096
    s_add_u32 m0, s31, 65536
    s_nop 0
    buffer_load_dwordx4 v3, s[4:7], s30 offen sc1 lds
    s_add_u32 s30, s30, 4096
    s_add_u32 m0, s31, 126976
    s_nop 0
    buffer_load_dwordx4 v3, s[4:7], s30 offen sc1 lds
    s_add_u32 s30, s30, 4096
    s_add_u32 m0, s31, 131072
    s_nop 0
    buffer_load_dwordx4 v3, s[4:7], s30 offen sc1 lds
    s_add_u32 s30, s30, 4096
    s_add_u32 m0, s31, 135168
    s_nop 0
    buffer_load_dwordx4 v3, s[4:7], s30 offen sc1 lds
    s_add_u32 s30, s30, 4096
    s_add_u32 m0, s31, 0
    s_nop 0
    buffer_load_dwordx4 v3, s[4:7], s30 offen sc1 lds
    s_add_u32 s30, s30, 4096
    s_nop 0
    s_barrier
    s_waitcnt vmcnt(8)
    s_barrier
    s_lshl_b32 s24, s12, 2
    s_add_u32 s24, s24, s23
    s_mul_i32 s20, s24, 40960
    s_add_u32 s20, s20, s18
    s_add_u32 s20, s20, 13762560
    s_add_u32 s20, s20, 8192
    s_add_u32 m0, s31, 118784
    s_nop 0
    buffer_load_dwordx4 v6, s[4:7], s20 offen sc1 lds
    s_add_u32 s20, s20, 256
    s_add_u32 m0, s31, 49152
    s_nop 0
    buffer_load_dwordx4 v6, s[4:7], s20 offen sc1 lds
    s_add_u32 s20, s20, 1792
    s_add_u32 m0, s31, 69632
    s_nop 0
    buffer_load_dwordx4 v6, s[4:7], s20 offen sc1 lds
    s_add_u32 s20, s20, 256
    s_add_u32 m0, s31, 122880
    s_nop 0
    buffer_load_dwordx4 v6, s[4:7], s20 offen sc1 lds
    s_add_u32 s20, s20, 1792
    s_add_u32 m0, s31, 139264
    s_nop 0
    buffer_load_dwordx4 v6, s[4:7], s20 offen sc1 lds
    s_add_u32 s20, s20, 256
    s_add_u32 m0, s31, 143360
    s_nop 0
    buffer_load_dwordx4 v6, s[4:7], s20 offen sc1 lds
    s_add_u32 s20, s20, 1792
    s_add_u32 m0, s31, 4096
    s_nop 0
    buffer_load_dwordx4 v3, s[4:7], s30 offen sc1 lds
    s_add_u32 s30, s30, 4096
    s_add_u32 m0, s31, 8192
    s_nop 0
    buffer_load_dwordx4 v3, s[4:7], s30 offen sc1 lds
    s_add_u32 s30, s30, 4096
    s_add_u32 m0, s31, 12288
    s_nop 0
    buffer_load_dwordx4 v3, s[4:7], s30 offen sc1 lds
    s_add_u32 s30, s30, 4096
    s_add_u32 m0, s31, 16384
    s_nop 0
    buffer_load_dwordx4 v6, s[4:7], s20 offen sc1 lds
    s_add_u32 s20, s20, 256
    s_add_u32 m0, s31, 20480
    s_nop 0
    buffer_load_dwordx4 v6, s[4:7], s20 offen sc1 lds
    s_add_u32 s20, s20, 1792
    s_add_u32 m0, s31, 73728
    s_nop 0
    buffer_load_dwordx4 v3, s[4:7], s30 offen sc1 lds
    s_add_u32 s30, s30, 4096
    s_add_u32 m0, s31, 77824
    s_nop 0
    buffer_load_dwordx4 v3, s[4:7], s30 offen sc1 lds
    s_add_u32 s30, s30, 4096
    s_add_u32 m0, s31, 81920
    s_nop 0
    buffer_load_dwordx4 v3, s[4:7], s30 offen sc1 lds
    s_add_u32 s30, s30, 4096
    s_waitcnt vmcnt(12)
    s_barrier
    s_add_u32 m0, s31, 86016
    s_nop 0
    buffer_load_dwordx4 v6, s[4:7], s20 offen sc1 lds
    s_add_u32 s20, s20, 256
    s_add_u32 m0, s31, 90112
    s_nop 0
    buffer_load_dwordx4 v6, s[4:7], s20 offen sc1 lds
    s_add_u32 s20, s20, 1792
    s_add_u32 m0, s31, 94208
    s_nop 0
    buffer_load_dwordx4 v3, s[4:7], s30 offen sc1 lds
    s_add_u32 s30, s30, 4096
    s_add_u32 m0, s31, 24576
    s_nop 0
    buffer_load_dwordx4 v3, s[4:7], s30 offen sc1 lds
    s_add_u32 s30, s30, 4096
    s_add_u32 m0, s31, 28672
    s_nop 0
    buffer_load_dwordx4 v3, s[4:7], s30 offen sc1 lds
    s_add_u32 s30, s30, 4096
    s_add_u32 m0, s31, 32768
    s_nop 0
    buffer_load_dwordx4 v3, s[4:7], s30 offen sc1 lds
    s_add_u32 s30, s30, 4096
    s_add_u32 m0, s31, 36864
    s_nop 0
    buffer_load_dwordx4 v6, s[4:7], s20 offen sc1 lds
    s_add_u32 s20, s20, 256
    s_add_u32 m0, s31, 40960
    s_nop 0
    buffer_load_dwordx4 v6, s[4:7], s20 offen sc1 lds
    s_add_u32 s20, s20, 1792
    s_add_u32 m0, s31, 45056
    s_nop 0
    buffer_load_dwordx4 v3, s[4:7], s30 offen sc1 lds
    s_add_u32 s30, s30, 4096
    s_waitcnt vmcnt(19)
    s_barrier
    s_add_u32 m0, s31, 98304
    s_nop 0
    buffer_load_dwordx4 v3, s[4:7], s30 offen sc1 lds
    s_add_u32 s30, s30, 4096
    s_add_u32 m0, s31, 102400
    s_nop 0
    buffer_load_dwordx4 v3, s[4:7], s30 offen sc1 lds
    s_add_u32 s30, s30, 4096
    s_add_u32 m0, s31, 106496
    s_nop 0
    buffer_load_dwordx4 v6, s[4:7], s20 offen sc1 lds
    s_add_u32 s20, s20, 256
    s_add_u32 m0, s31, 110592
    s_nop 0
    buffer_load_dwordx4 v6, s[4:7], s20 offen sc1 lds
    s_add_u32 s20, s20, 1792
    s_add_u32 m0, s31, 114688
    s_nop 0
    buffer_load_dwordx4 v3, s[4:7], s30 offen sc1 lds
    s_add_u32 s30, s30, 4096
    s_add_u32 m0, s31, 118784
    s_nop 0
    buffer_load_dwordx4 v3, s[4:7], s30 offen sc1 lds
    s_add_u32 s30, s30, 4096
    s_add_u32 m0, s31, 49152
    s_nop 0
    buffer_load_dwordx4 v3, s[4:7], s30 offen sc1 lds
    s_add_u32 s30, s30, 4096
    s_add_u32 m0, s31, 53248
    s_nop 0
    buffer_load_dwordx4 v3, s[4:7], s30 offen sc1 lds
    s_add_u32 s30, s30, 4096
    s_waitcnt vmcnt(22)
    s_barrier
    s_add_u32 m0, s31, 57344
    s_nop 0
    buffer_load_dwordx4 v6, s[4:7], s20 offen sc1 lds
    s_add_u32 s20, s20, 256
    s_add_u32 m0, s31, 61440
    s_nop 0
    buffer_load_dwordx4 v6, s[4:7], s20 offen sc1 lds
    s_add_u32 s20, s20, 1792
    s_add_u32 m0, s31, 65536
    s_nop 0
    buffer_load_dwordx4 v3, s[4:7], s30 offen sc1 lds
    s_add_u32 s30, s30, 4096
    s_add_u32 m0, s31, 69632
    s_nop 0
    buffer_load_dwordx4 v3, s[4:7], s30 offen sc1 lds
    s_add_u32 s30, s30, 4096
    s_add_u32 m0, s31, 122880
    s_nop 0
    buffer_load_dwordx4 v3, s[4:7], s30 offen sc1 lds
    s_add_u32 s30, s30, 4096
    s_add_u32 m0, s31, 126976
    s_nop 0
    buffer_load_dwordx4 v6, s[4:7], s20 offen sc1 lds
    s_add_u32 s20, s20, 256
    s_waitcnt vmcnt(23)
    s_barrier
    s_add_u32 m0, s31, 131072
    s_nop 0
    buffer_load_dwordx4 v6, s[4:7], s20 offen sc1 lds
    s_add_u32 s20, s20, 1792
    s_add_u32 m0, s31, 135168
    s_nop 0
    buffer_load_dwordx4 v3, s[4:7], s30 offen sc1 lds
    s_add_u32 s30, s30, 4096
    s_add_u32 m0, s31, 139264
    s_nop 0
    buffer_load_dwordx4 v3, s[4:7], s30 offen sc1 lds
    s_add_u32 s30, s30, 4096
    s_add_u32 m0, s31, 143360
    s_nop 0
    buffer_load_dwordx4 v3, s[4:7], s30 offen sc1 lds
    s_add_u32 s30, s30, 4096
    s_add_u32 m0, s31, 0
    s_nop 0
    buffer_load_dwordx4 v3, s[4:7], s30 offen sc1 lds
    s_add_u32 s30, s30, 4096
    s_waitcnt vmcnt(22)
    s_barrier
    s_add_u32 m0, s31, 4096
    s_nop 0
    buffer_load_dwordx4 v6, s[4:7], s20 offen sc1 lds
    s_add_u32 s20, s20, 256
    s_add_u32 m0, s31, 8192
    s_nop 0
    buffer_load_dwordx4 v6, s[4:7], s20 offen sc1 lds
    s_add_u32 s20, s20, 1792
    s_add_u32 m0, s31, 12288
    s_nop 0
    buffer_load_dwordx4 v3, s[4:7], s30 offen sc1 lds
    s_add_u32 s30, s30, 4096
    s_add_u32 m0, s31, 16384
    s_nop 0
    buffer_load_dwordx4 v3, s[4:7], s30 offen sc1 lds
    s_add_u32 s30, s30, 4096
    s_add_u32 m0, s31, 20480
    s_nop 0
    buffer_load_dwordx4 v3, s[4:7], s30 offen sc1 lds
    s_add_u32 s30, s30, 4096
    s_add_u32 m0, s31, 73728
    s_nop 0
    buffer_load_dwordx4 v6, s[4:7], s20 offen sc1 lds
    s_add_u32 s20, s20, 256
    s_waitcnt vmcnt(23)
    s_barrier
    s_add_u32 m0, s31, 77824
    s_nop 0
    buffer_load_dwordx4 v6, s[4:7], s20 offen sc1 lds
    s_add_u32 s20, s20, 1792
    s_add_u32 m0, s31, 81920
    s_nop 0
    buffer_load_dwordx4 v3, s[4:7], s30 offen sc1 lds
    s_add_u32 s30, s30, 4096
    s_add_u32 m0, s31, 86016
    s_nop 0
    buffer_load_dwordx4 v6, s[4:7], s20 offen sc1 lds
    s_add_u32 s20, s20, 256
    s_add_u32 m0, s31, 90112
    s_nop 0
    buffer_load_dwordx4 v6, s[4:7], s20 offen sc1 lds
    s_add_u32 s20, s20, 1792
    s_add_u32 m0, s31, 94208
    s_nop 0
    buffer_load_dwordx4 v3, s[4:7], s30 offen sc1 lds
    s_add_u32 s30, s30, 4096
    s_waitcnt vmcnt(22)
    s_barrier
    s_add_u32 m0, s31, 24576
    s_nop 0
    buffer_load_dwordx4 v6, s[4:7], s20 offen sc1 lds
    s_add_u32 s20, s20, 256
    s_add_u32 m0, s31, 28672
    s_nop 0
    buffer_load_dwordx4 v6, s[4:7], s20 offen sc1 lds
    s_add_u32 s20, s20, 1792
    s_add_u32 m0, s31, 32768
    s_nop 0
    buffer_load_dwordx4 v3, s[4:7], s30 offen sc1 lds
    s_add_u32 s30, s30, 4096
    s_add_u32 m0, s31, 36864
    s_nop 0
    buffer_load_dwordx4 v6, s[4:7], s20 offen sc1 lds
    s_add_u32 s20, s20, 256
    s_add_u32 m0, s31, 40960
    s_nop 0
    buffer_load_dwordx4 v6, s[4:7], s20 offen sc1 lds
    s_add_u32 s20, s20, 1792
    s_add_u32 m0, s31, 45056
    s_nop 0
    buffer_load_dwordx4 v3, s[4:7], s30 offen sc1 lds
    s_add_u32 s30, s30, 4096
    s_waitcnt vmcnt(23)
    s_barrier
    s_add_u32 m0, s31, 98304
    s_nop 0
    buffer_load_dwordx4 v6, s[4:7], s20 offen sc1 lds
    s_add_u32 s20, s20, 256
    s_add_u32 m0, s31, 102400
    s_nop 0
    buffer_load_dwordx4 v6, s[4:7], s20 offen sc1 lds
    s_add_u32 s20, s20, 1792
    s_add_u32 m0, s31, 106496
    s_nop 0
    buffer_load_dwordx4 v3, s[4:7], s30 offen sc1 lds
    s_add_u32 s30, s30, 4096
    s_add_u32 m0, s31, 110592
    s_nop 0
    buffer_load_dwordx4 v6, s[4:7], s20 offen sc1 lds
    s_add_u32 s20, s20, 256
    s_add_u32 m0, s31, 114688
    s_nop 0
    buffer_load_dwordx4 v6, s[4:7], s20 offen sc1 lds
    s_add_u32 s20, s20, 1792
    s_waitcnt vmcnt(22)
    s_barrier
    s_add_u32 m0, s31, 118784
    s_nop 0
    buffer_load_dwordx4 v3, s[4:7], s30 offen sc1 lds
    s_add_u32 s30, s30, 4096
    s_add_u32 m0, s31, 49152
    s_nop 0
    buffer_load_dwordx4 v3, s[4:7], s30 offen sc1 lds
    s_add_u32 s30, s30, 4096
    s_add_u32 m0, s31, 53248
    s_nop 0
    buffer_load_dwordx4 v3, s[4:7], s30 offen sc1 lds
    s_add_u32 s30, s30, 4096
    s_add_u32 m0, s31, 57344
    s_nop 0
    buffer_load_dwordx4 v3, s[4:7], s30 offen sc1 lds
    s_add_u32 s30, s30, 4096
    s_add_u32 m0, s31, 61440
    s_nop 0
    buffer_load_dwordx4 v3, s[4:7], s30 offen sc1 lds
    s_add_u32 s30, s30, 4096
    s_add_u32 m0, s31, 65536
    s_nop 0
    buffer_load_dwordx4 v3, s[4:7], s30 offen sc1 lds
    s_add_u32 s30, s30, 4096
    s_waitcnt vmcnt(23)
    s_barrier
    s_add_u32 m0, s31, 69632
    s_nop 0
    buffer_load_dwordx4 v3, s[4:7], s30 offen sc1 lds
    s_add_u32 s30, s30, 4096
    s_add_u32 m0, s31, 122880
    s_nop 0
    buffer_load_dwordx4 v3, s[4:7], s30 offen sc1 lds
    s_add_u32 s30, s30, 4096
    s_add_u32 m0, s31, 126976
    s_nop 0
    buffer_load_dwordx4 v3, s[4:7], s30 offen sc1 lds
    s_add_u32 s30, s30, 4096
    s_add_u32 m0, s31, 131072
    s_nop 0
    buffer_load_dwordx4 v3, s[4:7], s30 offen sc1 lds
    s_add_u32 s30, s30, 4096
    s_add_u32 m0, s31, 135168
    s_nop 0
    buffer_load_dwordx4 v3, s[4:7], s30 offen sc1 lds
    s_add_u32 s30, s30, 4096
    s_waitcnt vmcnt(16)
    s_barrier
    s_add_u32 m0, s31, 139264
    s_nop 0
    buffer_load_dwordx4 v3, s[4:7], s30 offen sc1 lds
    s_add_u32 s30, s30, 4096
    s_add_u32 m0, s31, 143360
    s_nop 0
    buffer_load_dwordx4 v3, s[4:7], s30 offen sc1 lds
    s_add_u32 s30, s30, 4096
    s_add_u32 m0, s31, 0
    s_nop 0
    buffer_load_dwordx4 v3, s[4:7], s30 offen sc1 lds
    s_add_u32 s30, s30, 4096
    s_add_u32 m0, s31, 4096
    s_nop 0
    buffer_load_dwordx4 v3, s[4:7], s30 offen sc1 lds
    s_add_u32 s30, s30, 4096
    s_add_u32 m0, s31, 8192
    s_nop 0
    buffer_load_dwordx4 v3, s[4:7], s30 offen sc1 lds
    s_add_u32 s30, s30, 4096
    s_waitcnt vmcnt(14)
    s_barrier
    s_mul_i32 s30, s15, 276480
    s_add_u32 s30, s30, 53641216
    s_add_u32 s30, s30, s31
    s_add_u32 m0, s31, 73728
    s_nop 0
    buffer_load_dwordx4 v3, s[4:7], s30 offen sc1 lds
    s_add_u32 s30, s30, 4096
    s_add_u32 m0, s31, 77824
    s_nop 0
    buffer_load_dwordx4 v3, s[4:7], s30 offen sc1 lds
    s_add_u32 s30, s30, 4096
    s_add_u32 m0, s31, 81920
    s_nop 0
    buffer_load_dwordx4 v3, s[4:7], s30 offen sc1 lds
    s_add_u32 s30, s30, 4096
    s_add_u32 m0, s31, 86016
    s_nop 0
    buffer_load_dwordx4 v3, s[4:7], s30 offen sc1 lds
    s_add_u32 s30, s30, 4096
    s_add_u32 m0, s31, 90112
    s_nop 0
    buffer_load_dwordx4 v3, s[4:7], s30 offen sc1 lds
    s_add_u32 s30, s30, 4096
    s_waitcnt vmcnt(15)
    s_barrier
    s_add_u32 m0, s31, 94208
    s_nop 0
    buffer_load_dwordx4 v3, s[4:7], s30 offen sc1 lds
    s_add_u32 s30, s30, 4096
    s_add_u32 m0, s31, 24576
    s_nop 0
    buffer_load_dwordx4 v3, s[4:7], s30 offen sc1 lds
    s_add_u32 s30, s30, 4096
    s_add_u32 m0, s31, 28672
    s_nop 0
    buffer_load_dwordx4 v3, s[4:7], s30 offen sc1 lds
    s_add_u32 s30, s30, 4096
    s_add_u32 m0, s31, 32768
    s_nop 0
    buffer_load_dwordx4 v3, s[4:7], s30 offen sc1 lds
    s_add_u32 s30, s30, 4096
    s_add_u32 m0, s31, 36864
    s_nop 0
    buffer_load_dwordx4 v3, s[4:7], s30 offen sc1 lds
    s_add_u32 s30, s30, 4096
    s_add_u32 m0, s31, 40960
    s_nop 0
    buffer_load_dwordx4 v3, s[4:7], s30 offen sc1 lds
    s_add_u32 s30, s30, 4096
    s_waitcnt vmcnt(18)
    s_barrier
    s_add_u32 m0, s31, 45056
    s_nop 0
    buffer_load_dwordx4 v3, s[4:7], s30 offen sc1 lds
    s_add_u32 s30, s30, 4096
    s_add_u32 m0, s31, 98304
    s_nop 0
    buffer_load_dwordx4 v3, s[4:7], s30 offen sc1 lds
    s_add_u32 s30, s30, 4096
    s_add_u32 m0, s31, 102400
    s_nop 0
    buffer_load_dwordx4 v3, s[4:7], s30 offen sc1 lds
    s_add_u32 s30, s30, 4096
    s_add_u32 m0, s31, 106496
    s_nop 0
    buffer_load_dwordx4 v3, s[4:7], s30 offen sc1 lds
    s_add_u32 s30, s30, 4096
    s_add_u32 m0, s31, 110592
    s_nop 0
    buffer_load_dwordx4 v3, s[4:7], s30 offen sc1 lds
    s_add_u32 s30, s30, 4096
    s_add_u32 m0, s31, 114688
    s_nop 0
    buffer_load_dwordx4 v3, s[4:7], s30 offen sc1 lds
    s_add_u32 s30, s30, 4096
    s_add_u32 m0, s31, 118784
    s_nop 0
    buffer_load_dwordx4 v3, s[4:7], s30 offen sc1 lds
    s_add_u32 s30, s30, 4096
    s_waitcnt vmcnt(21)
    s_barrier
    s_add_u32 m0, s31, 49152
    s_nop 0
    buffer_load_dwordx4 v3, s[4:7], s30 offen sc1 lds
    s_add_u32 s30, s30, 4096
    s_add_u32 m0, s31, 53248
    s_nop 0
    buffer_load_dwordx4 v3, s[4:7], s30 offen sc1 lds
    s_add_u32 s30, s30, 4096
    s_add_u32 m0, s31, 57344
    s_nop 0
    buffer_load_dwordx4 v3, s[4:7], s30 offen sc1 lds
    s_add_u32 s30, s30, 4096
    s_add_u32 m0, s31, 61440
    s_nop 0
    buffer_load_dwordx4 v3, s[4:7], s30 offen sc1 lds
    s_add_u32 s30, s30, 4096
    s_add_u32 m0, s31, 65536
    s_nop 0
    buffer_load_dwordx4 v3, s[4:7], s30 offen sc1 lds
    s_add_u32 s30, s30, 4096
    s_add_u32 m0, s31, 69632
    s_nop 0
    buffer_load_dwordx4 v3, s[4:7], s30 offen sc1 lds
    s_add_u32 s30, s30, 4096
    s_waitcnt vmcnt(24)
    s_barrier
    s_add_u32 m0, s31, 122880
    s_nop 0
    buffer_load_dwordx4 v3, s[4:7], s30 offen sc1 lds
    s_add_u32 s30, s30, 4096
    s_add_u32 m0, s31, 126976
    s_nop 0
    buffer_load_dwordx4 v3, s[4:7], s30 offen sc1 lds
    s_add_u32 s30, s30, 4096
    s_add_u32 m0, s31, 131072
    s_nop 0
    buffer_load_dwordx4 v3, s[4:7], s30 offen sc1 lds
    s_add_u32 s30, s30, 4096
    s_lshl_b32 s50, s12, 11
    s_add_u32 s50, s50, s18
    s_add_u32 s50, s50, 23953472
    v_lshlrev_b32 v10, 7, v1
    v_mov_b32 v11, 1
    s_nop 0
    s_barrier
    s_cmp_lg_u32 s22, 5
    s_cbranch_scc1 L_mega_kernel_es_77
    s_mov_b64 exec, 0xffff
    buffer_atomic_add v11, v10, s[4:7], s50 offen sc1
    s_mov_b64 exec, -1
L_mega_kernel_es_77:
    s_add_u32 m0, s31, 135168
    s_nop 0
    buffer_load_dwordx4 v3, s[4:7], s30 offen sc1 lds
    s_add_u32 s30, s30, 4096
    s_add_u32 m0, s31, 139264
    s_nop 0
    buffer_load_dwordx4 v3, s[4:7], s30 offen sc1 lds
    s_add_u32 s30, s30, 4096
    s_add_u32 m0, s31, 143360
    s_nop 0
    buffer_load_dwordx4 v3, s[4:7], s30 offen sc1 lds
    s_add_u32 s30, s30, 4096
    s_add_u32 m0, s31, 0
    s_nop 0
    buffer_load_dwordx4 v3, s[4:7], s30 offen sc1 lds
    s_add_u32 s30, s30, 4096
    s_add_u32 m0, s31, 4096
    s_nop 0
    buffer_load_dwordx4 v3, s[4:7], s30 offen sc1 lds
    s_add_u32 s30, s30, 4096
    s_add_u32 m0, s31, 8192
    s_nop 0
    buffer_load_dwordx4 v3, s[4:7], s30 offen sc1 lds
    s_add_u32 s30, s30, 4096
    s_add_u32 m0, s31, 12288
    s_nop 0
    buffer_load_dwordx4 v3, s[4:7], s30 offen sc1 lds
    s_add_u32 s30, s30, 4096
    s_add_u32 m0, s31, 16384
    s_nop 0
    buffer_load_dwordx4 v3, s[4:7], s30 offen sc1 lds
    s_add_u32 s30, s30, 4096
    s_add_u32 m0, s31, 20480
    s_nop 0
    buffer_load_dwordx4 v3, s[4:7], s30 offen sc1 lds
    s_add_u32 s30, s30, 4096
    s_mul_i32 s20, s14, 229376
    s_mul_i32 s21, s23, 12288
    s_add_u32 s20, s20, s21
    s_add_u32 s20, s20, s18
    s_add_u32 s20, s20, 16576512
    s_add_u32 s21, s20, 114688
    s_mov_b32 s50, 73728
    s_cmp_eq_u32 s23, 1
    s_cselect_b32 s50, 24576, s50
    s_cmp_eq_u32 s23, 2
    s_cselect_b32 s50, 98304, s50
    s_cmp_eq_u32 s23, 3
    s_cselect_b32 s50, 49152, s50
    v_add_u32 v10, s50, v3
    s_cmp_lg_u32 s22, 4
    s_cbranch_scc1 L_mega_kernel_ep_78
    s_lshl_b32 s53, s14, 3
    s_add_u32 s53, s53, s15
    s_lshl_b32 s50, s53, 7
    s_add_u32 s50, s50, s18
    s_add_u32 s50, s50, 23953472
    s_add_u32 s53, s3, 16
    s_mov_b32 s52, 0x400000
L_mega_kernel_sp_79:
    s_buffer_load_dword s51, s[4:7], s50 glc
    s_sub_u32 s52, s52, 1
    s_waitcnt lgkmcnt(0)
    s_cmp_lg_u32 s51, s53
    s_cbranch_scc0 L_mega_kernel_po_81
    s_and_b32 s51, s52, 31
    s_cbranch_scc1 L_mega_kernel_sp_79
    buffer_load_dword v9, off, s[4:7], s50 sc1
    s_cmp_eq_u32 s52, 0
    s_cbranch_scc1 L_mega_kernel_po_81
    s_waitcnt vmcnt(0)
    v_readfirstlane_b32 s51, v9
    s_cmp_lg_u32 s51, s53
    s_cbranch_scc1 L_mega_kernel_sp_79
L_mega_kernel_po_81:
L_mega_kernel_ep_78:
    s_setprio 1
    s_waitcnt vmcnt(0)
    s_barrier
    buffer_load_dwordx4 v[120:123], v6, s[4:7], s20 offen offset:0 sc1
    buffer_load_dwordx4 v[124:127], v6, s[4:7], s20 offen offset:256 sc1
    buffer_load_dwordx4 v[128:131], v6, s[4:7], s21 offen offset:0 sc1
    buffer_load_dwordx4 v[132:135], v6, s[4:7], s21 offen offset:256 sc1
    buffer_load_dwordx4 v[136:139], v6, s[4:7], s20 offen offset:2048 sc1
    buffer_load_dwordx4 v[140:143], v6, s[4:7], s20 offen offset:2304 sc1
    buffer_load_dwordx4 v[144:147], v6, s[4:7], s21 offen offset:2048 sc1
    buffer_load_dwordx4 v[148:151], v6, s[4:7], s21 offen offset:2304 sc1
    s_add_u32 s20, s20, 4096
    s_add_u32 s21, s21, 4096
    buffer_load_dwordx4 v[152:155], v6, s[4:7], s20 offen offset:0 sc1
    buffer_load_dwordx4 v[156:159], v6, s[4:7], s20 offen offset:256 sc1
    s_waitcnt vmcnt(9)
    v_mfma_f32_16x16x32_bf16 v[40:43], a[0:3], v[120:123], 0
    v_mfma_f32_16x16x32_bf16 v[44:47], a[4:7], v[120:123], 0
    v_mfma_f32_16x16x32_bf16 v[48:51], a[8:11], v[120:123], 0
    v_mfma_f32_16x16x32_bf16 v[52:55], a[12:15], v[120:123], 0
    v_mfma_f32_16x16x32_bf16 v[56:59], a[16:19], v[120:123], 0
    buffer_load_dwordx4 v[120:123], v6, s[4:7], s21 offen offset:0 sc1
    s_waitcnt vmcnt(9)
    v_mfma_f32_16x16x32_bf16 v[60:63], a[0:3], v[124:127], 0
    v_mfma_f32_16x16x32_bf16 v[64:67], a[4:7], v[124:127], 0
    v_mfma_f32_16x16x32_bf16 v[68:71], a[8:11], v[124:127], 0
    v_mfma_f32_16x16x32_bf16 v[72:75], a[12:15], v[124:127], 0
    v_mfma_f32_16x16x32_bf16 v[76:79], a[16:19], v[124:127], 0
    buffer_load_dwordx4 v[124:127], v6, s[4:7], s21 offen offset:256 sc1
    s_waitcnt vmcnt(9)
    v_mfma_f32_16x16x32_bf16 v[80:83], a[0:3], v[128:131], 0
    v_mfma_f32_16x16x32_bf16 v[84:87], a[4:7], v[128:131], 0
    v_mfma_f32_16x16x32_bf16 v[88:91], a[8:11], v[128:131], 0
    v_mfma_f32_16x16x32_bf16 v[92:95], a[12:15], v[128:131], 0
    v_mfma_f32_16x16x32_bf16 v[96:99], a[16:19], v[128:131], 0
    buffer_load_dwordx4 v[128:131], v6, s[4:7], s20 offen offset:2048 sc1
    s_waitcnt vmcnt(9)
    v_mfma_f32_16x16x32_bf16 v[100:103], a[0:3], v[132:135], 0
    v_mfma_f32_16x16x32_bf16 v[104:107], a[4:7], v[132:135], 0
    v_mfma_f32_16x16x32_bf16 v[108:111], a[8:11], v[132:135], 0
    v_mfma_f32_16x16x32_bf16 v[112:115], a[12:15], v[132:135], 0
    v_mfma_f32_16x16x32_bf16 v[116:119], a[16:19], v[132:135], 0
    buffer_load_dwordx4 v[132:135], v6, s[4:7], s20 offen offset:2304 sc1
    buffer_load_dwordx4 a[0:3], v6, s[4:7], s21 offen offset:2048 sc1
    buffer_load_dwordx4 a[4:7], v6, s[4:7], s21 offen offset:2304 sc1
    s_add_u32 s20, s20, 4096
    s_add_u32 s21, s21, 4096
    buffer_load_dwordx4 a[8:11], v6, s[4:7], s20 offen offset:0 sc1
    buffer_load_dwordx4 a[12:15], v6, s[4:7], s20 offen offset:256 sc1
    buffer_load_dwordx4 a[16:19], v6, s[4:7], s21 offen offset:0 sc1
    s_waitcnt vmcnt(14)
    v_mfma_f32_16x16x32_bf16 v[40:43], a[20:23], v[136:139], v[40:43]
    v_mfma_f32_16x16x32_bf16 v[44:47], a[24:27], v[136:139], v[44:47]
    v_mfma_f32_16x16x32_bf16 v[48:51], a[28:31], v[136:139], v[48:51]
    v_mfma_f32_16x16x32_bf16 v[52:55], a[32:35], v[136:139], v[52:55]
    v_mfma_f32_16x16x32_bf16 v[56:59], a[36:39], v[136:139], v[56:59]
    buffer_load_dwordx4 v[136:139], v6, s[4:7], s21 offen offset:256 sc1
    s_waitcnt vmcnt(14)
    v_mfma_f32_16x16x32_bf16 v[60:63], a[20:23], v[140:143], v[60:63]
    v_mfma_f32_16x16x32_bf16 v[64:67], a[24:27], v[140:143], v[64:67]
    v_mfma_f32_16x16x32_bf16 v[68:71], a[28:31], v[140:143], v[68:71]
    v_mfma_f32_16x16x32_bf16 v[72:75], a[32:35], v[140:143], v[72:75]
    v_mfma_f32_16x16x32_bf16 v[76:79], a[36:39], v[140:143], v[76:79]
    buffer_load_dwordx4 v[140:143], v6, s[4:7], s20 offen offset:2048 sc1
    s_waitcnt vmcnt(14)
    v_mfma_f32_16x16x32_bf16 v[80:83], a[20:23], v[144:147], v[80:83]
    v_mfma_f32_16x16x32_bf16 v[84:87], a[24:27], v[144:147], v[84:87]
    v_mfma_f32_16x16x32_bf16 v[88:91], a[28:31], v[144:147], v[88:91]
    v_mfma_f32_16x16x32_bf16 v[92:95], a[32:35], v[144:147], v[92:95]
    v_mfma_f32_16x16x32_bf16 v[96:99], a[36:39], v[144:147], v[96:99]
    buffer_load_dwordx4 v[144:147], v6, s[4:7], s20 offen offset:2304 sc1
    s_waitcnt vmcnt(14)
    v_mfma_f32_16x16x32_bf16 v[100:103], a[20:23], v[148:151], v[100:103]
    v_mfma_f32_16x16x32_bf16 v[104:107], a[24:27], v[148:151], v[104:107]
    v_mfma_f32_16x16x32_bf16 v[108:111], a[28:31], v[148:151], v[108:111]
    v_mfma_f32_16x16x32_bf16 v[112:115], a[32:35], v[148:151], v[112:115]
    v_mfma_f32_16x16x32_bf16 v[116:119], a[36:39], v[148:151], v[116:119]
    buffer_load_dwordx4 v[148:151], v6, s[4:7], s21 offen offset:2048 sc1
    buffer_load_dwordx4 a[20:23], v6, s[4:7], s21 offen offset:2304 sc1
    s_add_u32 s20, s20, 4096
    s_add_u32 s21, s21, 4096
    s_waitcnt vmcnt(15)
    v_mfma_f32_16x16x32_bf16 v[40:43], a[40:43], v[152:155], v[40:43]
    v_mfma_f32_16x16x32_bf16 v[44:47], a[44:47], v[152:155], v[44:47]
    v_mfma_f32_16x16x32_bf16 v[48:51], a[48:51], v[152:155], v[48:51]
    v_mfma_f32_16x16x32_bf16 v[52:55], a[52:55], v[152:155], v[52:55]
    v_mfma_f32_16x16x32_bf16 v[56:59], a[56:59], v[152:155], v[56:59]
    s_waitcnt vmcnt(14)
    v_mfma_f32_16x16x32_bf16 v[60:63], a[40:43], v[156:159], v[60:63]
    v_mfma_f32_16x16x32_bf16 v[64:67], a[44:47], v[156:159], v[64:67]
    v_mfma_f32_16x16x32_bf16 v[68:71], a[48:51], v[156:159], v[68:71]
    v_mfma_f32_16x16x32_bf16 v[72:75], a[52:55], v[156:159], v[72:75]
    v_mfma_f32_16x16x32_bf16 v[76:79], a[56:59], v[156:159], v[76:79]
    s_waitcnt vmcnt(13)
    v_mfma_f32_16x16x32_bf16 v[80:83], a[40:43], v[120:123], v[80:83]
    v_mfma_f32_16x16x32_bf16 v[84:87], a[44:47], v[120:123], v[84:87]
    v_mfma_f32_16x16x32_bf16 v[88:91], a[48:51], v[120:123], v[88:91]
    v_mfma_f32_16x16x32_bf16 v[92:95], a[52:55], v[120:123], v[92:95]
    v_mfma_f32_16x16x32_bf16 v[96:99], a[56:59], v[120:123], v[96:99]
    s_waitcnt vmcnt(12)
    v_mfma_f32_16x16x32_bf16 v[100:103], a[40:43], v[124:127], v[100:103]
    v_mfma_f32_16x16x32_bf16 v[104:107], a[44:47], v[124:127], v[104:107]
    v_mfma_f32_16x16x32_bf16 v[108:111], a[48:51], v[124:127], v[108:111]
    v_mfma_f32_16x16x32_bf16 v[112:115], a[52:55], v[124:127], v[112:115]
    v_mfma_f32_16x16x32_bf16 v[116:119], a[56:59], v[124:127], v[116:119]
    s_waitcnt vmcnt(11)
    v_mfma_f32_16x16x32_bf16 v[40:43], a[60:63], v[128:131], v[40:43]
    v_mfma_f32_16x16x32_bf16 v[44:47], a[64:67], v[128:131], v[44:47]
    v_mfma_f32_16x16x32_bf16 v[48:51], a[68:71], v[128:131], v[48:51]
    v_mfma_f32_16x16x32_bf16 v[52:55], a[72:75], v[128:131], v[52:55]
    v_mfma_f32_16x16x32_bf16 v[56:59], a[76:79], v[128:131], v[56:59]
    s_waitcnt vmcnt(10)
    v_mfma_f32_16x16x32_bf16 v[60:63], a[60:63], v[132:135], v[60:63]
    v_mfma_f32_16x16x32_bf16 v[64:67], a[64:67], v[132:135], v[64:67]
    v_mfma_f32_16x16x32_bf16 v[68:71], a[68:71], v[132:135], v[68:71]
    v_mfma_f32_16x16x32_bf16 v[72:75], a[72:75], v[132:135], v[72:75]
    v_mfma_f32_16x16x32_bf16 v[76:79], a[76:79], v[132:135], v[76:79]
    s_waitcnt vmcnt(9)
    v_mfma_f32_16x16x32_bf16 v[80:83], a[60:63], a[0:3], v[80:83]
    v_mfma_f32_16x16x32_bf16 v[84:87], a[64:67], a[0:3], v[84:87]
    v_mfma_f32_16x16x32_bf16 v[88:91], a[68:71], a[0:3], v[88:91]
    v_mfma_f32_16x16x32_bf16 v[92:95], a[72:75], a[0:3], v[92:95]
    v_mfma_f32_16x16x32_bf16 v[96:99], a[76:79], a[0:3], v[96:99]
    s_waitcnt vmcnt(8)
    v_mfma_f32_16x16x32_bf16 v[100:103], a[60:63], a[4:7], v[100:103]
    v_mfma_f32_16x16x32_bf16 v[104:107], a[64:67], a[4:7], v[104:107]
    v_mfma_f32_16x16x32_bf16 v[108:111], a[68:71], a[4:7], v[108:111]
    v_mfma_f32_16x16x32_bf16 v[112:115], a[72:75], a[4:7], v[112:115]
    v_mfma_f32_16x16x32_bf16 v[116:119], a[76:79], a[4:7], v[116:119]
    s_waitcnt vmcnt(7)
    v_mfma_f32_16x16x32_bf16 v[40:43], a[80:83], a[8:11], v[40:43]
    v_mfma_f32_16x16x32_bf16 v[44:47], a[84:87], a[8:11], v[44:47]
    v_mfma_f32_16x16x32_bf16 v[48:51], a[88:91], a[8:11], v[48:51]
    v_mfma_f32_16x16x32_bf16 v[52:55], a[92:95], a[8:11], v[52:55]
    v_mfma_f32_16x16x32_bf16 v[56:59], v[16:19], a[8:11], v[56:59]
    s_waitcnt vmcnt(6)
    v_mfma_f32_16x16x32_bf16 v[60:63], a[80:83], a[12:15], v[60:63]
    v_mfma_f32_16x16x32_bf16 v[64:67], a[84:87], a[12:15], v[64:67]
    v_mfma_f32_16x16x32_bf16 v[68:71], a[88:91], a[12:15], v[68:71]
    v_mfma_f32_16x16x32_bf16 v[72:75], a[92:95], a[12:15], v[72:75]
    v_mfma_f32_16x16x32_bf16 v[76:79], v[16:19], a[12:15], v[76:79]
    s_waitcnt vmcnt(5)
    v_mfma_f32_16x16x32_bf16 v[80:83], a[80:83], a[16:19], v[80:83]
    v_mfma_f32_16x16x32_bf16 v[84:87], a[84:87], a[16:19], v[84:87]
    v_mfma_f32_16x16x32_bf16 v[88:91], a[88:91], a[16:19], v[88:91]
    v_mfma_f32_16x16x32_bf16 v[92:95], a[92:95], a[16:19], v[92:95]
    v_mfma_f32_16x16x32_bf16 v[96:99], v[16:19], a[16:19], v[96:99]
    s_waitcnt vmcnt(4)
    v_mfma_f32_16x16x32_bf16 v[100:103], a[80:83], v[136:139], v[100:103]
    v_mfma_f32_16x16x32_bf16 v[104:107], a[84:87], v[136:139], v[104:107]
    v_mfma_f32_16x16x32_bf16 v[108:111], a[88:91], v[136:139], v[108:111]
    v_mfma_f32_16x16x32_bf16 v[112:115], a[92:95], v[136:139], v[112:115]
    v_mfma_f32_16x16x32_bf16 v[116:119], v[16:19], v[136:139], v[116:119]
    s_waitcnt vmcnt(3)
    v_mfma_f32_16x16x32_bf16 v[40:43], v[20:23], v[140:143], v[40:43]
    v_mfma_f32_16x16x32_bf16 v[44:47], v[24:27], v[140:143], v[44:47]
    v_mfma_f32_16x16x32_bf16 v[48:51], v[28:31], v[140:143], v[48:51]
    v_mfma_f32_16x16x32_bf16 v[52:55], v[32:35], v[140:143], v[52:55]
    v_mfma_f32_16x16x32_bf16 v[56:59], v[36:39], v[140:143], v[56:59]
    s_waitcnt vmcnt(2)
    v_mfma_f32_16x16x32_bf16 v[60:63], v[20:23], v[144:147], v[60:63]
    v_mfma_f32_16x16x32_bf16 v[64:67], v[24:27], v[144:147], v[64:67]
    v_mfma_f32_16x16x32_bf16 v[68:71], v[28:31], v[144:147], v[68:71]
    v_mfma_f32_16x16x32_bf16 v[72:75], v[32:35], v[144:147], v[72:75]
    v_mfma_f32_16x16x32_bf16 v[76:79], v[36:39], v[144:147], v[76:79]
    s_waitcnt vmcnt(1)
    v_mfma_f32_16x16x32_bf16 v[80:83], v[20:23], v[148:151], v[80:83]
    v_mfma_f32_16x16x32_bf16 v[84:87], v[24:27], v[148:151], v[84:87]
    v_mfma_f32_16x16x32_bf16 v[88:91], v[28:31], v[148:151], v[88:91]
    v_mfma_f32_16x16x32_bf16 v[92:95], v[32:35], v[148:151], v[92:95]
    v_mfma_f32_16x16x32_bf16 v[96:99], v[36:39], v[148:151], v[96:99]
    s_waitcnt vmcnt(0)
    v_mfma_f32_16x16x32_bf16 v[100:103], v[20:23], a[20:23], v[100:103]
    v_mfma_f32_16x16x32_bf16 v[104:107], v[24:27], a[20:23], v[104:107]
    v_mfma_f32_16x16x32_bf16 v[108:111], v[28:31], a[20:23], v[108:111]
    v_mfma_f32_16x16x32_bf16 v[112:115], v[32:35], a[20:23], v[112:115]
    v_mfma_f32_16x16x32_bf16 v[116:119], v[36:39], a[20:23], v[116:119]
    s_nop 7
    s_barrier
    ds_write_b128 v10, v[40:43] offset:0
    ds_write_b128 v10, v[44:47] offset:1024
    ds_write_b128 v10, v[48:51] offset:2048
    ds_write_b128 v10, v[52:55] offset:3072
    ds_write_b128 v10, v[56:59] offset:4096
    ds_write_b128 v10, v[60:63] offset:5120
    ds_write_b128 v10, v[64:67] offset:6144
    ds_write_b128 v10, v[68:71] offset:7168
    ds_write_b128 v10, v[72:75] offset:8192
    ds_write_b128 v10, v[76:79] offset:9216
    ds_write_b128 v10, v[80:83] offset:10240
    ds_write_b128 v10, v[84:87] offset:11264
    ds_write_b128 v10, v[88:91] offset:12288
    ds_write_b128 v10, v[92:95] offset:13312
    ds_write_b128 v10, v[96:99] offset:14336
    ds_write_b128 v10, v[100:103] offset:15360
    ds_write_b128 v10, v[104:107] offset:16384
    ds_write_b128 v10, v[108:111] offset:17408
    ds_write_b128 v10, v[112:115] offset:18432
    ds_write_b128 v10, v[116:119] offset:19456
    s_setprio 0
    s_waitcnt lgkmcnt(0)
    s_barrier
    s_cmp_eq_u32 s19, 0
    s_cbranch_scc1 L_mega_kernel_le_82
    s_nop 0
    s_branch L_mega_kernel_end_1
L_mega_kernel_le_82:
    s_mul_i32 s30, s13, 163840
    s_add_u32 s30, s30, 56360960
    s_add_u32 s30, s30, s31
    s_add_u32 m0, s31, 122880
    s_nop 0
    buffer_load_dwordx4 v3, s[4:7], s30 offen sc1 lds
    s_add_u32 s30, s30, 4096
    s_add_u32 m0, s31, 126976
    s_nop 0
    buffer_load_dwordx4 v3, s[4:7], s30 offen sc1 lds
    s_add_u32 s30, s30, 4096
    s_add_u32 m0, s31, 131072
    s_nop 0
    buffer_load_dwordx4 v3, s[4:7], s30 offen sc1 lds
    s_add_u32 s30, s30, 4096
    s_add_u32 m0, s31, 135168
    s_nop 0
    buffer_load_dwordx4 v3, s[4:7], s30 offen sc1 lds
    s_add_u32 s30, s30, 4096
    s_add_u32 m0, s31, 139264
    s_nop 0
    buffer_load_dwordx4 v3, s[4:7], s30 offen sc1 lds
    s_add_u32 s30, s30, 4096
    s_add_u32 m0, s31, 143360
    s_nop 0
    buffer_load_dwordx4 v3, s[4:7], s30 offen sc1 lds
    s_add_u32 s30, s30, 4096
    s_add_u32 m0, s31, 0
    s_nop 0
    buffer_load_dwordx4 v3, s[4:7], s30 offen sc1 lds
    s_add_u32 s30, s30, 4096
    s_add_u32 m0, s31, 4096
    s_nop 0
    buffer_load_dwordx4 v3, s[4:7], s30 offen sc1 lds
    s_add_u32 s30, s30, 4096
    s_add_u32 m0, s31, 8192
    s_nop 0
    buffer_load_dwordx4 v3, s[4:7], s30 offen sc1 lds
    s_add_u32 s30, s30, 4096
    s_add_u32 m0, s31, 12288
    s_nop 0
    buffer_load_dwordx4 v3, s[4:7], s30 offen sc1 lds
    s_add_u32 s30, s30, 4096
    s_add_u32 m0, s31, 16384
    s_nop 0
    buffer_load_dwordx4 v3, s[4:7], s30 offen sc1 lds
    s_add_u32 s30, s30, 4096
    s_add_u32 m0, s31, 20480
    s_nop 0
    buffer_load_dwordx4 v3, s[4:7], s30 offen sc1 lds
    s_add_u32 s30, s30, 4096
    s_cmp_eq_u32 s19, 0
    s_cbranch_scc1 L_mega_kernel_le_83
    s_nop 0
    s_branch L_mega_kernel_end_1
L_mega_kernel_le_83:
    s_lshr_b32 s50, s14, 1
    s_lshl_b32 s50, s50, 11
    s_add_u32 s50, s50, s18
    s_add_u32 s50, s50, 47972352
    v_lshlrev_b32 v10, 7, v1
    v_mov_b32 v11, 1
    s_nop 0
    s_barrier
    s_cmp_lg_u32 s22, 5
    s_cbranch_scc1 L_mega_kernel_es_84
    s_mov_b64 exec, 0xffff
    buffer_atomic_add v11, v10, s[4:7], s50 offen sc1
    s_mov_b64 exec, -1
L_mega_kernel_es_84:
    s_add_u32 m0, s31, 81920
    s_nop 0
    buffer_load_dwordx4 v3, s[4:7], s30 offen sc1 lds
    s_add_u32 s30, s30, 4096
    s_add_u32 m0, s31, 86016
    s_nop 0
    buffer_load_dwordx4 v3, s[4:7], s30 offen sc1 lds
    s_add_u32 s30, s30, 4096
    s_add_u32 m0, s31, 24576
    s_nop 0
    buffer_load_dwordx4 v3, s[4:7], s30 offen sc1 lds
    s_add_u32 s30, s30, 4096
    s_add_u32 m0, s31, 28672
    s_nop 0
    buffer_load_dwordx4 v3, s[4:7], s30 offen sc1 lds
    s_add_u32 s30, s30, 4096
    s_add_u32 m0, s31, 40960
    s_nop 0
    buffer_load_dwordx4 v3, s[4:7], s30 offen sc1 lds
    s_add_u32 s30, s30, 4096
    s_add_u32 m0, s31, 45056
    s_nop 0
    buffer_load_dwordx4 v3, s[4:7], s30 offen sc1 lds
    s_add_u32 s30, s30, 4096
    s_add_u32 m0, s31, 106496
    s_nop 0
    buffer_load_dwordx4 v3, s[4:7], s30 offen sc1 lds
    s_add_u32 s30, s30, 4096
    s_add_u32 m0, s31, 110592
    s_nop 0
    buffer_load_dwordx4 v3, s[4:7], s30 offen sc1 lds
    s_add_u32 s30, s30, 4096
    s_add_u32 m0, s31, 49152
    s_nop 0
    buffer_load_dwordx4 v3, s[4:7], s30 offen sc1 lds
    s_add_u32 s30, s30, 4096
    s_add_u32 m0, s31, 69632
    s_nop 0
    buffer_load_dwordx4 v3, s[4:7], s30 offen sc1 lds
    s_add_u32 s30, s30, 4096
    s_add_u32 s18, s18, 24117248
    s_add_u32 s19, s19, 1
    s_nop 0
    s_barrier
    s_waitcnt vmcnt(10)
    s_barrier
    s_lshl_b32 s24, s12, 2
    s_add_u32 s24, s24, s23
    s_mul_i32 s20, s24, 40960
    s_add_u32 s20, s20, s18
    s_add_u32 s20, s20, 0
    s_add_u32 s20, s20, 12288
    s_add_u32 m0, s31, 73728
    s_nop 0
    buffer_load_dwordx4 v6, s[4:7], s20 offen sc1 lds
    s_add_u32 s20, s20, 256
    s_add_u32 m0, s31, 77824
    s_nop 0
    buffer_load_dwordx4 v6, s[4:7], s20 offen sc1 lds
    s_add_u32 s20, s20, 1792
    s_add_u32 m0, s31, 90112
    s_nop 0
    buffer_load_dwordx4 v6, s[4:7], s20 offen sc1 lds
    s_add_u32 s20, s20, 256
    s_add_u32 m0, s31, 94208
    s_nop 0
    buffer_load_dwordx4 v6, s[4:7], s20 offen sc1 lds
    s_add_u32 s20, s20, 1792
    s_add_u32 m0, s31, 32768
    s_nop 0
    buffer_load_dwordx4 v6, s[4:7], s20 offen sc1 lds
    s_add_u32 s20, s20, 256
    s_add_u32 m0, s31, 36864
    s_nop 0
    buffer_load_dwordx4 v6, s[4:7], s20 offen sc1 lds
    s_add_u32 s20, s20, 1792
    s_add_u32 m0, s31, 98304
    s_nop 0
    buffer_load_dwordx4 v6, s[4:7], s20 offen sc1 lds
    s_add_u32 s20, s20, 256
    s_add_u32 m0, s31, 102400
    s_nop 0
    buffer_load_dwordx4 v6, s[4:7], s20 offen sc1 lds
    s_add_u32 s20, s20, 1792
    s_add_u32 m0, s31, 114688
    s_nop 0
    buffer_load_dwordx4 v6, s[4:7], s20 offen sc1 lds
    s_add_u32 s20, s20, 256
    s_add_u32 m0, s31, 118784
    s_nop 0
    buffer_load_dwordx4 v6, s[4:7], s20 offen sc1 lds
    s_add_u32 s20, s20, 1792
    s_add_u32 m0, s31, 53248
    s_nop 0
    buffer_load_dwordx4 v6, s[4:7], s20 offen sc1 lds
    s_add_u32 s20, s20, 256
    s_add_u32 m0, s31, 57344
    s_nop 0
    buffer_load_dwordx4 v6, s[4:7], s20 offen sc1 lds
    s_add_u32 s20, s20, 1792
    s_add_u32 m0, s31, 61440
    s_nop 0
    buffer_load_dwordx4 v6, s[4:7], s20 offen sc1 lds
    s_add_u32 s20, s20, 256
    s_add_u32 m0, s31, 65536
    s_nop 0
    buffer_load_dwordx4 v6, s[4:7], s20 offen sc1 lds
    s_add_u32 s20, s20, 1792
    s_waitcnt vmcnt(10)
    s_barrier
    s_add_u32 m0, s31, 122880
    s_nop 0
    buffer_load_dwordx4 v6, s[4:7], s20 offen sc1 lds
    s_add_u32 s20, s20, 256
    s_add_u32 m0, s31, 126976
    s_nop 0
    buffer_load_dwordx4 v6, s[4:7], s20 offen sc1 lds
    s_add_u32 s20, s20, 1792
    s_add_u32 m0, s31, 131072
    s_nop 0
    buffer_load_dwordx4 v6, s[4:7], s20 offen sc1 lds
    s_add_u32 s20, s20, 256
    s_add_u32 m0, s31, 135168
    s_nop 0
    buffer_load_dwordx4 v6, s[4:7], s20 offen sc1 lds
    s_add_u32 s20, s20, 1792
    s_add_u32 m0, s31, 139264
    s_nop 0
    buffer_load_dwordx4 v3, s[4:7], s30 offen sc1 lds
    s_add_u32 s30, s30, 4096
    s_add_u32 m0, s31, 143360
    s_nop 0
    buffer_load_dwordx4 v6, s[4:7], s20 offen sc1 lds
    s_add_u32 s20, s20, 256
    s_add_u32 m0, s31, 0
    s_nop 0
    buffer_load_dwordx4 v6, s[4:7], s20 offen sc1 lds
    s_add_u32 s20, s20, 1792
    s_add_u32 m0, s31, 4096
    s_nop 0
    buffer_load_dwordx4 v6, s[4:7], s20 offen sc1 lds
    s_add_u32 s20, s20, 256
    s_add_u32 m0, s31, 8192
    s_nop 0
    buffer_load_dwordx4 v6, s[4:7], s20 offen sc1 lds
    s_add_u32 s20, s20, 1792
    s_add_u32 m0, s31, 12288
    s_nop 0
    buffer_load_dwordx4 v3, s[4:7], s30 offen sc1 lds
    s_add_u32 s30, s30, 4096
    s_waitcnt vmcnt(16)
    s_barrier
    s_add_u32 m0, s31, 16384
    s_nop 0
    buffer_load_dwordx4 v6, s[4:7], s20 offen sc1 lds
    s_add_u32 s20, s20, 256
    s_add_u32 m0, s31, 20480
    s_nop 0
    buffer_load_dwordx4 v6, s[4:7], s20 offen sc1 lds
    s_add_u32 s20, s20, 1792
    s_add_u32 m0, s31, 73728
    s_nop 0
    buffer_load_dwordx4 v6, s[4:7], s20 offen sc1 lds
    s_add_u32 s20, s20, 256
    s_add_u32 m0, s31, 77824
    s_nop 0
    buffer_load_dwordx4 v6, s[4:7], s20 offen sc1 lds
    s_add_u32 s20, s20, 1792
    s_add_u32 m0, s31, 81920
    s_nop 0
    buffer_load_dwordx4 v3, s[4:7], s30 offen sc1 lds
    s_add_u32 s30, s30, 4096
    s_add_u32 m0, s31, 86016
    s_nop 0
    buffer_load_dwordx4 v6, s[4:7], s20 offen sc1 lds
    s_add_u32 s20, s20, 256
    s_add_u32 m0, s31, 90112
    s_nop 0
    buffer_load_dwordx4 v6, s[4:7], s20 offen sc1 lds
    s_add_u32 s20, s20, 1792
    s_add_u32 m0, s31, 94208
    s_nop 0
    buffer_load_dwordx4 v3, s[4:7], s30 offen sc1 lds
    s_add_u32 s30, s30, 4096
    s_waitcnt vmcnt(6)
    s_barrier
    s_add_u32 m0, s31, 24576
    s_nop 0
    buffer_load_dwordx4 v3, s[4:7], s30 offen sc1 lds
    s_add_u32 s30, s30, 4096
    s_add_u32 m0, s31, 28672
    s_nop 0
    buffer_load_dwordx4 v3, s[4:7], s30 offen sc1 lds
    s_add_u32 s30, s30, 4096
    s_add_u32 m0, s31, 32768
    s_nop 0
    buffer_load_dwordx4 v3, s[4:7], s30 offen sc1 lds
    s_add_u32 s30, s30, 4096
    s_add_u32 m0, s31, 36864
    s_nop 0
    buffer_load_dwordx4 v3, s[4:7], s30 offen sc1 lds
    s_add_u32 s30, s30, 4096
    s_add_u32 m0, s31, 40960
    s_nop 0
    buffer_load_dwordx4 v3, s[4:7], s30 offen sc1 lds
    s_add_u32 s30, s30, 4096
    s_add_u32 m0, s31, 45056
    s_nop 0
    buffer_load_dwordx4 v3, s[4:7], s30 offen sc1 lds
    s_add_u32 s30, s30, 4096
    s_add_u32 m0, s31, 98304
    s_nop 0
    buffer_load_dwordx4 v3, s[4:7], s30 offen sc1 lds
    s_add_u32 s30, s30, 4096
    s_add_u32 m0, s31, 102400
    s_nop 0
    buffer_load_dwordx4 v3, s[4:7], s30 offen sc1 lds
    s_add_u32 s30, s30, 4096
    s_waitcnt vmcnt(6)
    s_barrier
    s_add_u32 m0, s31, 106496
    s_nop 0
    buffer_load_dwordx4 v3, s[4:7], s30 offen sc1 lds
    s_add_u32 s30, s30, 4096
    s_add_u32 m0, s31, 110592
    s_nop 0
    buffer_load_dwordx4 v3, s[4:7], s30 offen sc1 lds
    s_add_u32 s30, s30, 4096
    s_add_u32 m0, s31, 114688
    s_nop 0
    buffer_load_dwordx4 v3, s[4:7], s30 offen sc1 lds
    s_add_u32 s30, s30, 4096
    s_add_u32 m0, s31, 118784
    s_nop 0
    buffer_load_dwordx4 v3, s[4:7], s30 offen sc1 lds
    s_add_u32 s30, s30, 4096
    s_add_u32 m0, s31, 49152
    s_nop 0
    buffer_load_dwordx4 v3, s[4:7], s30 offen sc1 lds
    s_add_u32 s30, s30, 4096
    s_add_u32 m0, s31, 53248
    s_nop 0
    buffer_load_dwordx4 v3, s[4:7], s30 offen sc1 lds
    s_add_u32 s30, s30, 4096
    s_waitcnt vmcnt(8)
    s_barrier
    s_waitcnt vmcnt(4)
    s_barrier
    s_waitcnt vmcnt(0)
    s_barrier
    s_lshl_b32 s50, s13, 11
    s_add_u32 s50, s50, s18
    s_add_u32 s50, s50, 23920704
    v_lshlrev_b32 v10, 7, v1
    v_mov_b32 v11, 1
    s_nop 0
    s_barrier
    s_cmp_lg_u32 s22, 5
    s_cbranch_scc1 L_mega_kernel_es_85
    s_mov_b64 exec, 0xffff
    buffer_atomic_add v11, v10, s[4:7], s50 offen sc1
    s_mov_b64 exec, -1
L_mega_kernel_es_85:
    s_branch L_mega_kernel_att_2
L_mega_kernel_end_1:
    s_waitcnt vmcnt(0)
    s_endpgm
L_mega_kernel_ool_36:
    s_call_b64 s[46:47], L_cv_touch
    s_branch L_mega_kernel_back_37
L_mega_kernel_ool_38:
    s_call_b64 s[46:47], L_cv_conv
    s_branch L_mega_kernel_back_39
L_mega_kernel_ool_40:
    v_mov_b32 v35, 1
    s_mov_b64 exec, 1
    s_lshl_b32 s50, s13, 11
    s_add_u32 s50, s50, 23887936
    buffer_atomic_add v35, off, s[4:7], s50 sc1
    s_mov_b64 exec, -1
    s_branch L_mega_kernel_back_41
L_mega_kernel_ool_42:
    s_mov_b32 s52, 0x100000
    s_mov_b32 s50, 23887936
    s_add_u32 s51, s3, 16
L_mega_kernel_cp_86:
    buffer_load_dword v35, v36, s[4:7], s50 offen sc1
    s_sub_u32 s52, s52, 1
    s_cbranch_scc1 L_mega_kernel_back_43
    s_waitcnt vmcnt(0)
    v_cmp_ne_u32 vcc, s51, v35
    s_cbranch_vccnz L_mega_kernel_cp_86
    s_branch L_mega_kernel_back_43
L_mega_kernel_ool_44:
    s_mul_i32 s50, s15, 276480
    s_mul_i32 s51, s23, 30720
    s_add_u32 s50, s50, s51
    s_add_u32 s50, s50, 53794816
    buffer_load_dwordx4 a[0:3], v3, s[4:7], s50 offen offset:0 sc1
    buffer_load_dwordx4 a[4:7], v3, s[4:7], s50 offen offset:1024 sc1
    buffer_load_dwordx4 a[8:11], v3, s[4:7], s50 offen offset:2048 sc1
    buffer_load_dwordx4 a[12:15], v3, s[4:7], s50 offen offset:3072 sc1
    s_add_u32 s50, s50, 4096
    buffer_load_dwordx4 a[16:19], v3, s[4:7], s50 offen offset:0 sc1
    buffer_load_dwordx4 a[20:23], v3, s[4:7], s50 offen offset:1024 sc1
    buffer_load_dwordx4 a[24:27], v3, s[4:7], s50 offen offset:2048 sc1
    buffer_load_dwordx4 a[28:31], v3, s[4:7], s50 offen offset:3072 sc1
    s_add_u32 s50, s50, 4096
    buffer_load_dwordx4 a[32:35], v3, s[4:7], s50 offen offset:0 sc1
    buffer_load_dwordx4 a[36:39], v3, s[4:7], s50 offen offset:1024 sc1
    buffer_load_dwordx4 a[40:43], v3, s[4:7], s50 offen offset:2048 sc1
    buffer_load_dwordx4 a[44:47], v3, s[4:7], s50 offen offset:3072 sc1
    s_add_u32 s50, s50, 4096
    buffer_load_dwordx4 a[48:51], v3, s[4:7], s50 offen offset:0 sc1
    buffer_load_dwordx4 a[52:55], v3, s[4:7], s50 offen offset:1024 sc1
    buffer_load_dwordx4 a[56:59], v3, s[4:7], s50 offen offset:2048 sc1
    buffer_load_dwordx4 a[60:63], v3, s[4:7], s50 offen offset:3072 sc1
    s_add_u32 s50, s50, 4096
    buffer_load_dwordx4 a[64:67], v3, s[4:7], s50 offen offset:0 sc1
    buffer_load_dwordx4 a[68:71], v3, s[4:7], s50 offen offset:1024 sc1
    buffer_load_dwordx4 a[72:75], v3, s[4:7], s50 offen offset:2048 sc1
    buffer_load_dwordx4 a[76:79], v3, s[4:7], s50 offen offset:3072 sc1
    s_add_u32 s50, s50, 4096
    buffer_load_dwordx4 a[80:83], v3, s[4:7], s50 offen offset:0 sc1
    buffer_load_dwordx4 a[84:87], v3, s[4:7], s50 offen offset:1024 sc1
    buffer_load_dwordx4 a[88:91], v3, s[4:7], s50 offen offset:2048 sc1
    buffer_load_dwordx4 a[92:95], v3, s[4:7], s50 offen offset:3072 sc1
    s_add_u32 s50, s50, 4096
    s_branch L_mega_kernel_back_45
L_mega_kernel_ool_46:
    s_lshr_b32 s50, s2, 3
    s_getpc_b64 s[56:57]
L_mega_kernel_pc_87:
    s_add_u32 s56, s56, mega_kernel-L_mega_kernel_pc_87
    s_addc_u32 s57, s57, -1
    s_and_b32 s57, s57, 0xffff
    s_mov_b32 s58, mega_end-mega_kernel
    s_mov_b32 s59, 0x00020000
    s_mul_i32 s62, s50, 3072
    buffer_load_dwordx4 a[0:3], v3, s[56:59], s62 offen offset:0
    buffer_load_dwordx4 a[4:7], v3, s[56:59], s62 offen offset:1024
    buffer_load_dwordx4 a[8:11], v3, s[56:59], s62 offen offset:2048
    s_branch L_mega_kernel_back_47
L_mega_kernel_slow_51:
    s_mov_b32 s54, 1
    v_mov_b32 v120, v126
    v_mov_b32 v121, v127
    v_mov_b32 v122, v128
    v_mov_b32 v123, v129
    v_mov_b32 v124, v130
    v_mov_b32 v125, v131
    s_mov_b64 exec, s[34:35]
    v_mov_b32 v124, 0
    s_mov_b64 exec, -1
    v_add_u32 v28, s28, v32
    v_add_u32 v30, s28, v33
    v_mov_b32 v112, 0xff800000
    s_mov_b32 s21, s26
    s_mov_b32 s55, 64
L_mega_kernel_p1_88:
    s_mov_b32 m0, s28
    s_nop 0
    buffer_load_dwordx4 v3, s[4:7], s21 offen offset:0 sc1 lds
    buffer_load_dwordx4 v3, s[4:7], s21 offen offset:1024 sc1 lds
    buffer_load_dwordx4 v3, s[4:7], s21 offen offset:2048 sc1 lds
    s_waitcnt vmcnt(0)
    ds_read_b64 v[136:137], v28
    ds_read_b128 v[132:135], v11
    s_waitcnt lgkmcnt(0)
    v_mfma_f32_32x32x16_bf16 v[40:55], v[132:135], v[120:123], 0
    v_mfma_f32_32x32x8_bf16 v[40:55], v[136:137], v[124:125], v[40:55]
    s_nop 15
    v_max3_f32 v104, v40, v41, v42
    v_max3_f32 v104, v104, v43, v44
    v_max3_f32 v104, v104, v45, v46
    v_max3_f32 v104, v104, v47, v48
    v_max3_f32 v104, v104, v49, v50
    v_max3_f32 v104, v104, v51, v52
    v_max3_f32 v104, v104, v53, v54
    v_max_f32 v104, v104, v55
    v_max_f32 v112, v112, v104
    s_add_u32 s21, s21, 3072
    s_sub_u32 s55, s55, 1
    s_cmp_lg_u32 s55, 0
    s_cbranch_scc1 L_mega_kernel_p1_88
    v_mov_b32 v104, v112
    s_nop 1
    v_permlane32_swap_b32 v104, v112
    s_nop 0
    v_max_f32 v112, v112, v104
    v_mov_b32 v72, 0
    v_mov_b32 v73, 0
    v_mov_b32 v74, 0
    v_mov_b32 v75, 0
    v_mov_b32 v76, 0
    v_mov_b32 v77, 0
    v_mov_b32 v78, 0
    v_mov_b32 v79, 0
    v_mov_b32 v80, 0
    v_mov_b32 v81, 0
    v_mov_b32 v82, 0
    v_mov_b32 v83, 0
    v_mov_b32 v84, 0
    v_mov_b32 v85, 0
    v_mov_b32 v86, 0
    v_mov_b32 v87, 0
    s_mov_b32 s21, s26
    s_mov_b32 s55, 64
L_mega_kernel_p2_89:
    s_mov_b32 m0, s28
    s_nop 0
    buffer_load_dwordx4 v3, s[4:7], s21 offen offset:0 sc1 lds
    buffer_load_dwordx4 v3, s[4:7], s21 offen offset:1024 sc1 lds
    buffer_load_dwordx4 v3, s[4:7], s21 offen offset:2048 sc1 lds
    s_waitcnt vmcnt(0)
    ds_read_b64 v[136:137], v28
    ds_read_b128 v[132:135], v11
    ds_read_b64_tr_b16 v[144:145], v30 offset:0
    ds_read_b64_tr_b16 v[146:147], v30 offset:128
    ds_read_b64_tr_b16 v[148:149], v30 offset:256
    ds_read_b64_tr_b16 v[150:151], v30 offset:384
    s_waitcnt lgkmcnt(0)
    v_mfma_f32_32x32x16_bf16 v[40:55], v[132:135], v[120:123], 0
    v_mfma_f32_32x32x8_bf16 v[40:55], v[136:137], v[124:125], v[40:55]
    s_nop 15
    v_sub_f32 v40, v40, v112
    v_sub_f32 v41, v41, v112
    v_sub_f32 v42, v42, v112
    v_sub_f32 v43, v43, v112
    v_sub_f32 v44, v44, v112
    v_sub_f32 v45, v45, v112
    v_sub_f32 v46, v46, v112
    v_sub_f32 v47, v47, v112
    v_sub_f32 v48, v48, v112
    v_sub_f32 v49, v49, v112
    v_sub_f32 v50, v50, v112
    v_sub_f32 v51, v51, v112
    v_sub_f32 v52, v52, v112
    v_sub_f32 v53, v53, v112
    v_sub_f32 v54, v54, v112
    v_sub_f32 v55, v55, v112
    v_exp_f32 v40, v40
    v_exp_f32 v41, v41
    v_exp_f32 v42, v42
    v_exp_f32 v43, v43
    v_cvt_pk_bf16_f32 v104, v40, v41
    v_exp_f32 v44, v44
    v_exp_f32 v45, v45
    v_cvt_pk_bf16_f32 v105, v42, v43
    v_exp_f32 v46, v46
    v_exp_f32 v47, v47
    v_cvt_pk_bf16_f32 v106, v44, v45
    v_exp_f32 v48, v48
    v_exp_f32 v49, v49
    v_cvt_pk_bf16_f32 v107, v46, v47
    v_exp_f32 v50, v50
    v_exp_f32 v51, v51
    v_cvt_pk_bf16_f32 v108, v48, v49
    v_exp_f32 v52, v52
    v_exp_f32 v53, v53
    v_cvt_pk_bf16_f32 v109, v50, v51
    v_exp_f32 v54, v54
    v_exp_f32 v55, v55
    v_cvt_pk_bf16_f32 v110, v52, v53
    v_cvt_pk_bf16_f32 v111, v54, v55
    s_nop 1
    v_mfma_f32_32x32x16_bf16 v[72:87], v[144:147], v[104:107], v[72:87]
    v_mfma_f32_32x32x16_bf16 v[72:87], v[148:151], v[108:111], v[72:87]
    s_add_u32 s21, s21, 3072
    s_sub_u32 s55, s55, 1
    s_cmp_lg_u32 s55, 0
    s_cbranch_scc1 L_mega_kernel_p2_89
    s_nop 15
    s_branch L_mega_kernel_fin_50
L_cv_touch:
    buffer_load_dword v23, v22, s[56:59], s96 offen offset:0
    buffer_load_dword v23, v22, s[56:59], s96 offen offset:128
    buffer_load_dword v23, v22, s[56:59], s96 offen offset:156
    buffer_load_dword v23, v22, s[56:59], s96 offen offset:220
    s_setpc_b64 s[46:47]
L_cv_conv:
    s_mov_b32 s60, 0
    s_mov_b32 m0, s97
    s_mov_b64 exec, s[98:99]
    s_add_u32 s52, s100, 4096
    s_add_u32 s53, s100, 8192
    s_cmp_eq_u32 s61, 1
    s_cbranch_scc1 L_mega_kernel_cg_90
    s_cmp_eq_u32 s61, 3
    s_cbranch_scc1 L_mega_kernel_lw_91
    s_sub_u32 s63, s30, 48
    s_mul_i32 s50, s63, 5462
    s_lshr_b32 s50, s50, 16
    s_lshl_b32 s50, s50, 4
    s_add_u32 s50, s50, s63
    s_add_u32 s50, s50, 16
    s_sub_u32 s51, s30, 180
    s_cmp_lt_u32 s30, 48
    s_cselect_b32 s51, s30, s51
    s_lshr_b32 s62, s51, 4
    s_mul_i32 s62, s62, 12
    s_add_u32 s51, s51, s62
    s_cmp_lt_u32 s63, 180
    s_cselect_b32 s51, s50, s51
    s_mul_i32 s51, s51, 5120
    s_add_u32 s51, s51, s96
    buffer_load_dwordx4 v16, s[56:59], s51 offen lds
    s_add_u32 m0, m0, 640
    s_add_u32 s30, s30, 1
    s_sub_u32 s63, s30, 48
    s_mul_i32 s50, s63, 5462
    s_lshr_b32 s50, s50, 16
    s_lshl_b32 s50, s50, 4
    s_add_u32 s50, s50, s63
    s_add_u32 s50, s50, 16
    s_sub_u32 s51, s30, 180
    s_cmp_lt_u32 s30, 48
    s_cselect_b32 s51, s30, s51
    s_lshr_b32 s62, s51, 4
    s_mul_i32 s62, s62, 12
    s_add_u32 s51, s51, s62
    s_cmp_lt_u32 s63, 180
    s_cselect_b32 s51, s50, s51
    s_mul_i32 s51, s51, 5120
    s_add_u32 s51, s51, s96
    buffer_load_dwordx4 v16, s[56:59], s51 offen lds
    s_add_u32 m0, m0, 640
    s_add_u32 s30, s30, 1
    s_sub_u32 s63, s30, 48
    s_mul_i32 s50, s63, 5462
    s_lshr_b32 s50, s50, 16
    s_lshl_b32 s50, s50, 4
    s_add_u32 s50, s50, s63
    s_add_u32 s50, s50, 16
    s_sub_u32 s51, s30, 180
    s_cmp_lt_u32 s30, 48
    s_cselect_b32 s51, s30, s51
    s_lshr_b32 s62, s51, 4
    s_mul_i32 s62, s62, 12
    s_add_u32 s51, s51, s62
    s_cmp_lt_u32 s63, 180
    s_cselect_b32 s51, s50, s51
    s_mul_i32 s51, s51, 5120
    s_add_u32 s51, s51, s96
    buffer_load_dwordx4 v16, s[56:59], s51 offen lds
    s_add_u32 m0, m0, 640
    s_add_u32 s30, s30, 1
    s_sub_u32 s63, s30, 48
    s_mul_i32 s50, s63, 5462
    s_lshr_b32 s50, s50, 16
    s_lshl_b32 s50, s50, 4
    s_add_u32 s50, s50, s63
    s_add_u32 s50, s50, 16
    s_sub_u32 s51, s30, 180
    s_cmp_lt_u32 s30, 48
    s_cselect_b32 s51, s30, s51
    s_lshr_b32 s62, s51, 4
    s_mul_i32 s62, s62, 12
    s_add_u32 s51, s51, s62
    s_cmp_lt_u32 s63, 180
    s_cselect_b32 s51, s50, s51
    s_mul_i32 s51, s51, 5120
    s_add_u32 s51, s51, s96
    buffer_load_dwordx4 v16, s[56:59], s51 offen lds
    s_add_u32 m0, m0, 640
    s_add_u32 s30, s30, 1
    s_sub_u32 s63, s30, 48
    s_mul_i32 s50, s63, 5462
    s_lshr_b32 s50, s50, 16
    s_lshl_b32 s50, s50, 4
    s_add_u32 s50, s50, s63
    s_add_u32 s50, s50, 16
    s_sub_u32 s51, s30, 180
    s_cmp_lt_u32 s30, 48
    s_cselect_b32 s51, s30, s51
    s_lshr_b32 s62, s51, 4
    s_mul_i32 s62, s62, 12
    s_add_u32 s51, s51, s62
    s_cmp_lt_u32 s63, 180
    s_cselect_b32 s51, s50, s51
    s_mul_i32 s51, s51, 5120
    s_add_u32 s51, s51, s96
    buffer_load_dwordx4 v16, s[56:59], s51 offen lds
    s_add_u32 m0, m0, 640
    s_add_u32 s30, s30, 1
    s_sub_u32 s63, s30, 48
    s_mul_i32 s50, s63, 5462
    s_lshr_b32 s50, s50, 16
    s_lshl_b32 s50, s50, 4
    s_add_u32 s50, s50, s63
    s_add_u32 s50, s50, 16
    s_sub_u32 s51, s30, 180
    s_cmp_lt_u32 s30, 48
    s_cselect_b32 s51, s30, s51
    s_lshr_b32 s62, s51, 4
    s_mul_i32 s62, s62, 12
    s_add_u32 s51, s51, s62
    s_cmp_lt_u32 s63, 180
    s_cselect_b32 s51, s50, s51
    s_mul_i32 s51, s51, 5120
    s_add_u32 s51, s51, s96
    buffer_load_dwordx4 v16, s[56:59], s51 offen lds
    s_add_u32 m0, m0, 640
    s_add_u32 s30, s30, 1
    s_sub_u32 s63, s30, 48
    s_mul_i32 s50, s63, 5462
    s_lshr_b32 s50, s50, 16
    s_lshl_b32 s50, s50, 4
    s_add_u32 s50, s50, s63
    s_add_u32 s50, s50, 16
    s_sub_u32 s51, s30, 180
    s_cmp_lt_u32 s30, 48
    s_cselect_b32 s51, s30, s51
    s_lshr_b32 s62, s51, 4
    s_mul_i32 s62, s62, 12
    s_add_u32 s51, s51, s62
    s_cmp_lt_u32 s63, 180
    s_cselect_b32 s51, s50, s51
    s_mul_i32 s51, s51, 5120
    s_add_u32 s51, s51, s96
    buffer_load_dwordx4 v16, s[56:59], s51 offen lds
    s_add_u32 m0, m0, 640
    s_add_u32 s30, s30, 1
    s_sub_u32 s63, s30, 48
    s_mul_i32 s50, s63, 5462
    s_lshr_b32 s50, s50, 16
    s_lshl_b32 s50, s50, 4
    s_add_u32 s50, s50, s63
    s_add_u32 s50, s50, 16
    s_sub_u32 s51, s30, 180
    s_cmp_lt_u32 s30, 48
    s_cselect_b32 s51, s30, s51
    s_lshr_b32 s62, s51, 4
    s_mul_i32 s62, s62, 12
    s_add_u32 s51, s51, s62
    s_cmp_lt_u32 s63, 180
    s_cselect_b32 s51, s50, s51
    s_mul_i32 s51, s51, 5120
    s_add_u32 s51, s51, s96
    buffer_load_dwordx4 v16, s[56:59], s51 offen lds
    s_add_u32 m0, m0, 640
    s_add_u32 s30, s30, 1
    s_sub_u32 s63, s30, 48
    s_mul_i32 s50, s63, 5462
    s_lshr_b32 s50, s50, 16
    s_lshl_b32 s50, s50, 4
    s_add_u32 s50, s50, s63
    s_add_u32 s50, s50, 16
    s_sub_u32 s51, s30, 180
    s_cmp_lt_u32 s30, 48
    s_cselect_b32 s51, s30, s51
    s_lshr_b32 s62, s51, 4
    s_mul_i32 s62, s62, 12
    s_add_u32 s51, s51, s62
    s_cmp_lt_u32 s63, 180
    s_cselect_b32 s51, s50, s51
    s_mul_i32 s51, s51, 5120
    s_add_u32 s51, s51, s96
    buffer_load_dwordx4 v16, s[56:59], s51 offen lds
    s_add_u32 m0, m0, 640
    s_add_u32 s30, s30, 1
    s_sub_u32 s63, s30, 48
    s_mul_i32 s50, s63, 5462
    s_lshr_b32 s50, s50, 16
    s_lshl_b32 s50, s50, 4
    s_add_u32 s50, s50, s63
    s_add_u32 s50, s50, 16
    s_sub_u32 s51, s30, 180
    s_cmp_lt_u32 s30, 48
    s_cselect_b32 s51, s30, s51
    s_lshr_b32 s62, s51, 4
    s_mul_i32 s62, s62, 12
    s_add_u32 s51, s51, s62
    s_cmp_lt_u32 s63, 180
    s_cselect_b32 s51, s50, s51
    s_mul_i32 s51, s51, 5120
    s_add_u32 s51, s51, s96
    buffer_load_dwordx4 v16, s[56:59], s51 offen lds
    s_add_u32 m0, m0, 640
    s_add_u32 s30, s30, 1
    s_sub_u32 s63, s30, 48
    s_mul_i32 s50, s63, 5462
    s_lshr_b32 s50, s50, 16
    s_lshl_b32 s50, s50, 4
    s_add_u32 s50, s50, s63
    s_add_u32 s50, s50, 16
    s_sub_u32 s51, s30, 180
    s_cmp_lt_u32 s30, 48
    s_cselect_b32 s51, s30, s51
    s_lshr_b32 s62, s51, 4
    s_mul_i32 s62, s62, 12
    s_add_u32 s51, s51, s62
    s_cmp_lt_u32 s63, 180
    s_cselect_b32 s51, s50, s51
    s_mul_i32 s51, s51, 5120
    s_add_u32 s51, s51, s96
    buffer_load_dwordx4 v16, s[56:59], s51 offen lds
    s_add_u32 m0, m0, 640
    s_add_u32 s30, s30, 1
    s_sub_u32 s63, s30, 48
    s_mul_i32 s50, s63, 5462
    s_lshr_b32 s50, s50, 16
    s_lshl_b32 s50, s50, 4
    s_add_u32 s50, s50, s63
    s_add_u32 s50, s50, 16
    s_sub_u32 s51, s30, 180
    s_cmp_lt_u32 s30, 48
    s_cselect_b32 s51, s30, s51
    s_lshr_b32 s62, s51, 4
    s_mul_i32 s62, s62, 12
    s_add_u32 s51, s51, s62
    s_cmp_lt_u32 s63, 180
    s_cselect_b32 s51, s50, s51
    s_mul_i32 s51, s51, 5120
    s_add_u32 s51, s51, s96
    buffer_load_dwordx4 v16, s[56:59], s51 offen lds
    s_add_u32 m0, m0, 640
    s_add_u32 s30, s30, 1
    s_sub_u32 s63, s30, 48
    s_mul_i32 s50, s63, 5462
    s_lshr_b32 s50, s50, 16
    s_lshl_b32 s50, s50, 4
    s_add_u32 s50, s50, s63
    s_add_u32 s50, s50, 16
    s_sub_u32 s51, s30, 180
    s_cmp_lt_u32 s30, 48
    s_cselect_b32 s51, s30, s51
    s_lshr_b32 s62, s51, 4
    s_mul_i32 s62, s62, 12
    s_add_u32 s51, s51, s62
    s_cmp_lt_u32 s63, 180
    s_cselect_b32 s51, s50, s51
    s_mul_i32 s51, s51, 5120
    s_add_u32 s51, s51, s96
    buffer_load_dwordx4 v16, s[56:59], s51 offen lds
    s_add_u32 m0, m0, 640
    s_add_u32 s30, s30, 1
    s_sub_u32 s63, s30, 48
    s_mul_i32 s50, s63, 5462
    s_lshr_b32 s50, s50, 16
    s_lshl_b32 s50, s50, 4
    s_add_u32 s50, s50, s63
    s_add_u32 s50, s50, 16
    s_sub_u32 s51, s30, 180
    s_cmp_lt_u32 s30, 48
    s_cselect_b32 s51, s30, s51
    s_lshr_b32 s62, s51, 4
    s_mul_i32 s62, s62, 12
    s_add_u32 s51, s51, s62
    s_cmp_lt_u32 s63, 180
    s_cselect_b32 s51, s50, s51
    s_mul_i32 s51, s51, 5120
    s_add_u32 s51, s51, s96
    buffer_load_dwordx4 v16, s[56:59], s51 offen lds
    s_add_u32 m0, m0, 640
    s_add_u32 s30, s30, 1
    s_sub_u32 s63, s30, 48
    s_mul_i32 s50, s63, 5462
    s_lshr_b32 s50, s50, 16
    s_lshl_b32 s50, s50, 4
    s_add_u32 s50, s50, s63
    s_add_u32 s50, s50, 16
    s_sub_u32 s51, s30, 180
    s_cmp_lt_u32 s30, 48
    s_cselect_b32 s51, s30, s51
    s_lshr_b32 s62, s51, 4
    s_mul_i32 s62, s62, 12
    s_add_u32 s51, s51, s62
    s_cmp_lt_u32 s63, 180
    s_cselect_b32 s51, s50, s51
    s_mul_i32 s51, s51, 5120
    s_add_u32 s51, s51, s96
    buffer_load_dwordx4 v16, s[56:59], s51 offen lds
    s_add_u32 m0, m0, 640
    s_add_u32 s30, s30, 1
    s_sub_u32 s63, s30, 48
    s_mul_i32 s50, s63, 5462
    s_lshr_b32 s50, s50, 16
    s_lshl_b32 s50, s50, 4
    s_add_u32 s50, s50, s63
    s_add_u32 s50, s50, 16
    s_sub_u32 s51, s30, 180
    s_cmp_lt_u32 s30, 48
    s_cselect_b32 s51, s30, s51
    s_lshr_b32 s62, s51, 4
    s_mul_i32 s62, s62, 12
    s_add_u32 s51, s51, s62
    s_cmp_lt_u32 s63, 180
    s_cselect_b32 s51, s50, s51
    s_mul_i32 s51, s51, 5120
    s_add_u32 s51, s51, s96
    buffer_load_dwordx4 v16, s[56:59], s51 offen lds
    s_add_u32 m0, m0, 640
    s_add_u32 s30, s30, 1
L_mega_kernel_lc_92:
    s_mov_b64 exec, -1
    s_waitcnt vmcnt(8)
    ds_read_b64_tr_b16 a[0:1], v17 offset:0
    ds_read_b64_tr_b16 a[2:3], v17 offset:640
    ds_read_b64_tr_b16 a[4:5], v17 offset:8
    ds_read_b64_tr_b16 a[6:7], v17 offset:648
    ds_read_b64_tr_b16 a[8:9], v17 offset:64
    ds_read_b64_tr_b16 a[10:11], v17 offset:704
    ds_read_b64_tr_b16 a[12:13], v17 offset:72
    ds_read_b64_tr_b16 a[14:15], v17 offset:712
    ds_read_b64_tr_b16 a[16:17], v18 offset:128
    ds_read_b64_tr_b16 a[18:19], v18 offset:768
    s_waitcnt lgkmcnt(0)
    buffer_store_dwordx4 a[0:3], v3, s[4:7], s100 offen offset:0 sc1
    buffer_store_dwordx4 a[4:7], v3, s[4:7], s100 offen offset:1024 sc1
    buffer_store_dwordx4 a[8:11], v3, s[4:7], s100 offen offset:2048 sc1
    buffer_store_dwordx4 a[12:15], v3, s[4:7], s100 offen offset:3072 sc1
    buffer_store_dwordx4 a[16:19], v3, s[4:7], s52 offen offset:0 sc1
    s_waitcnt vmcnt(5)
    ds_read_b64_tr_b16 a[20:21], v17 offset:5120
    ds_read_b64_tr_b16 a[22:23], v17 offset:5760
    ds_read_b64_tr_b16 a[24:25], v17 offset:5128
    ds_read_b64_tr_b16 a[26:27], v17 offset:5768
    ds_read_b64_tr_b16 a[28:29], v17 offset:5184
    ds_read_b64_tr_b16 a[30:31], v17 offset:5824
    ds_read_b64_tr_b16 a[32:33], v17 offset:5192
    ds_read_b64_tr_b16 a[34:35], v17 offset:5832
    ds_read_b64_tr_b16 a[36:37], v18 offset:5248
    ds_read_b64_tr_b16 a[38:39], v18 offset:5888
    s_waitcnt lgkmcnt(0)
    buffer_store_dwordx4 a[20:23], v3, s[4:7], s52 offen offset:1024 sc1
    buffer_store_dwordx4 a[24:27], v3, s[4:7], s52 offen offset:2048 sc1
    buffer_store_dwordx4 a[28:31], v3, s[4:7], s52 offen offset:3072 sc1
    buffer_store_dwordx4 a[32:35], v3, s[4:7], s53 offen offset:0 sc1
    buffer_store_dwordx4 a[36:39], v3, s[4:7], s53 offen offset:1024 sc1
    s_setpc_b64 s[46:47]
L_mega_kernel_lw_91:
    s_lshr_b32 s50, s30, 2
    s_add_u32 s50, s50, s30
    s_sub_u32 s50, s50, 40
    s_mul_i32 s51, s30, 5
    s_add_u32 s51, s51, 4
    s_cmp_lt_u32 s30, 32
    s_cselect_b32 s51, s51, s50
    s_mul_i32 s51, s51, 5120
    s_add_u32 s51, s51, s96
    buffer_load_dwordx4 v16, s[56:59], s51 offen lds
    s_add_u32 m0, m0, 640
    s_add_u32 s30, s30, 1
    s_lshr_b32 s50, s30, 2
    s_add_u32 s50, s50, s30
    s_sub_u32 s50, s50, 40
    s_mul_i32 s51, s30, 5
    s_add_u32 s51, s51, 4
    s_cmp_lt_u32 s30, 32
    s_cselect_b32 s51, s51, s50
    s_mul_i32 s51, s51, 5120
    s_add_u32 s51, s51, s96
    buffer_load_dwordx4 v16, s[56:59], s51 offen lds
    s_add_u32 m0, m0, 640
    s_add_u32 s30, s30, 1
    s_lshr_b32 s50, s30, 2
    s_add_u32 s50, s50, s30
    s_sub_u32 s50, s50, 40
    s_mul_i32 s51, s30, 5
    s_add_u32 s51, s51, 4
    s_cmp_lt_u32 s30, 32
    s_cselect_b32 s51, s51, s50
    s_mul_i32 s51, s51, 5120
    s_add_u32 s51, s51, s96
    buffer_load_dwordx4 v16, s[56:59], s51 offen lds
    s_add_u32 m0, m0, 640
    s_add_u32 s30, s30, 1
    s_lshr_b32 s50, s30, 2
    s_add_u32 s50, s50, s30
    s_sub_u32 s50, s50, 40
    s_mul_i32 s51, s30, 5
    s_add_u32 s51, s51, 4
    s_cmp_lt_u32 s30, 32
    s_cselect_b32 s51, s51, s50
    s_mul_i32 s51, s51, 5120
    s_add_u32 s51, s51, s96
    buffer_load_dwordx4 v16, s[56:59], s51 offen lds
    s_add_u32 m0, m0, 640
    s_add_u32 s30, s30, 1
    s_lshr_b32 s50, s30, 2
    s_add_u32 s50, s50, s30
    s_sub_u32 s50, s50, 40
    s_mul_i32 s51, s30, 5
    s_add_u32 s51, s51, 4
    s_cmp_lt_u32 s30, 32
    s_cselect_b32 s51, s51, s50
    s_mul_i32 s51, s51, 5120
    s_add_u32 s51, s51, s96
    buffer_load_dwordx4 v16, s[56:59], s51 offen lds
    s_add_u32 m0, m0, 640
    s_add_u32 s30, s30, 1
    s_lshr_b32 s50, s30, 2
    s_add_u32 s50, s50, s30
    s_sub_u32 s50, s50, 40
    s_mul_i32 s51, s30, 5
    s_add_u32 s51, s51, 4
    s_cmp_lt_u32 s30, 32
    s_cselect_b32 s51, s51, s50
    s_mul_i32 s51, s51, 5120
    s_add_u32 s51, s51, s96
    buffer_load_dwordx4 v16, s[56:59], s51 offen lds
    s_add_u32 m0, m0, 640
    s_add_u32 s30, s30, 1
    s_lshr_b32 s50, s30, 2
    s_add_u32 s50, s50, s30
    s_sub_u32 s50, s50, 40
    s_mul_i32 s51, s30, 5
    s_add_u32 s51, s51, 4
    s_cmp_lt_u32 s30, 32
    s_cselect_b32 s51, s51, s50
    s_mul_i32 s51, s51, 5120
    s_add_u32 s51, s51, s96
    buffer_load_dwordx4 v16, s[56:59], s51 offen lds
    s_add_u32 m0, m0, 640
    s_add_u32 s30, s30, 1
    s_lshr_b32 s50, s30, 2
    s_add_u32 s50, s50, s30
    s_sub_u32 s50, s50, 40
    s_mul_i32 s51, s30, 5
    s_add_u32 s51, s51, 4
    s_cmp_lt_u32 s30, 32
    s_cselect_b32 s51, s51, s50
    s_mul_i32 s51, s51, 5120
    s_add_u32 s51, s51, s96
    buffer_load_dwordx4 v16, s[56:59], s51 offen lds
    s_add_u32 m0, m0, 640
    s_add_u32 s30, s30, 1
    s_lshr_b32 s50, s30, 2
    s_add_u32 s50, s50, s30
    s_sub_u32 s50, s50, 40
    s_mul_i32 s51, s30, 5
    s_add_u32 s51, s51, 4
    s_cmp_lt_u32 s30, 32
    s_cselect_b32 s51, s51, s50
    s_mul_i32 s51, s51, 5120
    s_add_u32 s51, s51, s96
    buffer_load_dwordx4 v16, s[56:59], s51 offen lds
    s_add_u32 m0, m0, 640
    s_add_u32 s30, s30, 1
    s_lshr_b32 s50, s30, 2
    s_add_u32 s50, s50, s30
    s_sub_u32 s50, s50, 40
    s_mul_i32 s51, s30, 5
    s_add_u32 s51, s51, 4
    s_cmp_lt_u32 s30, 32
    s_cselect_b32 s51, s51, s50
    s_mul_i32 s51, s51, 5120
    s_add_u32 s51, s51, s96
    buffer_load_dwordx4 v16, s[56:59], s51 offen lds
    s_add_u32 m0, m0, 640
    s_add_u32 s30, s30, 1
    s_lshr_b32 s50, s30, 2
    s_add_u32 s50, s50, s30
    s_sub_u32 s50, s50, 40
    s_mul_i32 s51, s30, 5
    s_add_u32 s51, s51, 4
    s_cmp_lt_u32 s30, 32
    s_cselect_b32 s51, s51, s50
    s_mul_i32 s51, s51, 5120
    s_add_u32 s51, s51, s96
    buffer_load_dwordx4 v16, s[56:59], s51 offen lds
    s_add_u32 m0, m0, 640
    s_add_u32 s30, s30, 1
    s_lshr_b32 s50, s30, 2
    s_add_u32 s50, s50, s30
    s_sub_u32 s50, s50, 40
    s_mul_i32 s51, s30, 5
    s_add_u32 s51, s51, 4
    s_cmp_lt_u32 s30, 32
    s_cselect_b32 s51, s51, s50
    s_mul_i32 s51, s51, 5120
    s_add_u32 s51, s51, s96
    buffer_load_dwordx4 v16, s[56:59], s51 offen lds
    s_add_u32 m0, m0, 640
    s_add_u32 s30, s30, 1
    s_lshr_b32 s50, s30, 2
    s_add_u32 s50, s50, s30
    s_sub_u32 s50, s50, 40
    s_mul_i32 s51, s30, 5
    s_add_u32 s51, s51, 4
    s_cmp_lt_u32 s30, 32
    s_cselect_b32 s51, s51, s50
    s_mul_i32 s51, s51, 5120
    s_add_u32 s51, s51, s96
    buffer_load_dwordx4 v16, s[56:59], s51 offen lds
    s_add_u32 m0, m0, 640
    s_add_u32 s30, s30, 1
    s_lshr_b32 s50, s30, 2
    s_add_u32 s50, s50, s30
    s_sub_u32 s50, s50, 40
    s_mul_i32 s51, s30, 5
    s_add_u32 s51, s51, 4
    s_cmp_lt_u32 s30, 32
    s_cselect_b32 s51, s51, s50
    s_mul_i32 s51, s51, 5120
    s_add_u32 s51, s51, s96
    buffer_load_dwordx4 v16, s[56:59], s51 offen lds
    s_add_u32 m0, m0, 640
    s_add_u32 s30, s30, 1
    s_lshr_b32 s50, s30, 2
    s_add_u32 s50, s50, s30
    s_sub_u32 s50, s50, 40
    s_mul_i32 s51, s30, 5
    s_add_u32 s51, s51, 4
    s_cmp_lt_u32 s30, 32
    s_cselect_b32 s51, s51, s50
    s_mul_i32 s51, s51, 5120
    s_add_u32 s51, s51, s96
    buffer_load_dwordx4 v16, s[56:59], s51 offen lds
    s_add_u32 m0, m0, 640
    s_add_u32 s30, s30, 1
    s_lshr_b32 s50, s30, 2
    s_add_u32 s50, s50, s30
    s_sub_u32 s50, s50, 40
    s_mul_i32 s51, s30, 5
    s_add_u32 s51, s51, 4
    s_cmp_lt_u32 s30, 32
    s_cselect_b32 s51, s51, s50
    s_mul_i32 s51, s51, 5120
    s_add_u32 s51, s51, s96
    buffer_load_dwordx4 v16, s[56:59], s51 offen lds
    s_add_u32 m0, m0, 640
    s_add_u32 s30, s30, 1
    s_branch L_mega_kernel_lc_92
L_mega_kernel_cg_90:
    s_mul_i32 s51, s30, 13824
    s_add_u32 s51, s51, s96
    buffer_load_dwordx4 v16, s[56:59], s51 offen lds
    s_add_u32 m0, m0, 896
    s_add_u32 s51, s51, 13824
    buffer_load_dwordx4 v16, s[56:59], s51 offen lds
    s_add_u32 m0, m0, 896
    s_add_u32 s51, s51, 13824
    buffer_load_dwordx4 v16, s[56:59], s51 offen lds
    s_add_u32 m0, m0, 896
    s_add_u32 s51, s51, 13824
    buffer_load_dwordx4 v16, s[56:59], s51 offen lds
    s_add_u32 m0, m0, 896
    s_add_u32 s51, s51, 13824
    buffer_load_dwordx4 v16, s[56:59], s51 offen lds
    s_add_u32 m0, m0, 896
    s_add_u32 s51, s51, 13824
    buffer_load_dwordx4 v16, s[56:59], s51 offen lds
    s_add_u32 m0, m0, 896
    s_add_u32 s51, s51, 13824
    buffer_load_dwordx4 v16, s[56:59], s51 offen lds
    s_add_u32 m0, m0, 896
    s_add_u32 s51, s51, 13824
    buffer_load_dwordx4 v16, s[56:59], s51 offen lds
    s_add_u32 m0, m0, 896
    s_add_u32 s51, s51, 13824
    s_mov_b64 exec, -1
    s_waitcnt vmcnt(0)
    ds_read_b64_tr_b16 a[0:1], v17 offset:0
    ds_read_b64_tr_b16 a[2:3], v17 offset:896
    ds_read_b64_tr_b16 a[4:5], v17 offset:8
    ds_read_b64_tr_b16 a[6:7], v17 offset:904
    ds_read_b64_tr_b16 a[8:9], v17 offset:64
    ds_read_b64_tr_b16 a[10:11], v17 offset:960
    ds_read_b64_tr_b16 a[12:13], v17 offset:72
    ds_read_b64_tr_b16 a[14:15], v17 offset:968
    ds_read_b64_tr_b16 a[16:17], v17 offset:128
    ds_read_b64_tr_b16 a[18:19], v17 offset:1024
    ds_read_b64_tr_b16 a[20:21], v17 offset:136
    ds_read_b64_tr_b16 a[22:23], v17 offset:1032
    ds_read_b64_tr_b16 a[24:25], v18 offset:192
    ds_read_b64_tr_b16 a[26:27], v18 offset:1088
    s_waitcnt lgkmcnt(0)
    s_and_b32 s50, s100, 0x3ff
    s_cbranch_scc1 L_mega_kernel_tl_97
    buffer_store_dwordx4 a[0:3], v3, s[4:7], s100 offen offset:0 sc1
    buffer_store_dwordx4 a[4:7], v3, s[4:7], s100 offen offset:1024 sc1
    buffer_store_dwordx4 a[8:11], v3, s[4:7], s100 offen offset:2048 sc1
    buffer_store_dwordx4 a[12:15], v3, s[4:7], s100 offen offset:3072 sc1
    buffer_store_dwordx4 a[16:19], v3, s[4:7], s52 offen offset:0 sc1
    buffer_store_dwordx4 a[20:23], v3, s[4:7], s52 offen offset:1024 sc1
    buffer_store_dwordx4 a[24:27], v3, s[4:7], s52 offen offset:2048 sc1
    s_branch L_mega_kernel_td_98
L_mega_kernel_tl_97:
    s_sub_u32 s100, s100, s50
    s_lshl_b32 s50, s50, 10
    s_add_u32 s52, s100, s50
    s_add_u32 s53, s52, s50
    s_add_u32 s51, s53, 143360
    buffer_store_dwordx4 a[0:3], v3, s[4:7], s51 offen offset:0 sc1
    buffer_store_dwordx4 a[4:7], v3, s[4:7], s51 offen offset:1024 sc1
    s_add_u32 s51, s53, 167936
    buffer_store_dwordx4 a[8:11], v3, s[4:7], s51 offen offset:0 sc1
    buffer_store_dwordx4 a[12:15], v3, s[4:7], s51 offen offset:1024 sc1
    s_add_u32 s51, s53, 192512
    buffer_store_dwordx4 a[16:19], v3, s[4:7], s51 offen offset:0 sc1
    buffer_store_dwordx4 a[20:23], v3, s[4:7], s51 offen offset:1024 sc1
    s_add_u32 s51, s52, 245760
    buffer_store_dwordx4 a[24:27], v3, s[4:7], s51 offen offset:0 sc1
L_mega_kernel_td_98:
    v_mfma_f32_16x16x32_bf16 a[40:43], a[0:3], a[44:47], 0
    v_mfma_f32_16x16x32_bf16 a[40:43], a[4:7], a[48:51], a[40:43]
    v_mfma_f32_16x16x32_bf16 a[40:43], a[8:11], a[52:55], a[40:43]
    v_mfma_f32_16x16x32_bf16 a[40:43], a[12:15], a[56:59], a[40:43]
    v_mfma_f32_16x16x32_bf16 a[40:43], a[16:19], a[60:63], a[40:43]
    v_mfma_f32_16x16x32_bf16 a[40:43], a[20:23], a[64:67], a[40:43]
    v_mfma_f32_16x16x32_bf16 a[40:43], a[24:27], a[68:71], a[40:43]
    s_mov_b32 exec_lo, 0x7f007f
    s_mov_b32 exec_hi, 0x7f007f
    s_nop 7
    buffer_store_dwordx4 a[40:43], v19, s[4:7], s101 offen sc1
    s_mov_b64 exec, -1
    s_setpc_b64 s[46:47]
mega_end:
.section .rodata,"a"
.p2align 6
.amdhsa_kernel mega_kernel
  .amdhsa_next_free_vgpr 256
  .amdhsa_next_free_sgpr 102
  .amdhsa_accum_offset 160
  .amdhsa_group_segment_fixed_size 0
  .amdhsa_kernarg_size 80
  .amdhsa_user_sgpr_count 2
  .amdhsa_user_sgpr_kernarg_segment_ptr 1
  .amdhsa_system_sgpr_workgroup_id_x 1
  .amdhsa_float_denorm_mode_32 3
.end_amdhsa_kernel
```
